```python
import torch

def _softmax(x, axis=-1):
    return torch.softmax(x, dim=axis)
def _gelu(x):
    return torch.nn.functional.gelu(x, approximate="tanh")
def _silu(x):
    return torch.nn.functional.silu(x)
def _sigmoid(x):
    return torch.sigmoid(x)
def _layernorm(x, axis=-1, eps=1e-5):
    m = x.mean(dim=axis, keepdim=True)
    v = x.var(dim=axis, keepdim=True, unbiased=False)
    return (x - m) / torch.sqrt(v + eps)
def _scatter_add(tgt, idx, src, axis=0):
    return tgt.clone().index_add_(axis, idx, src)
def _segment_sum(src, seg, n):
    out = torch.zeros((n,) + src.shape[1:], dtype=src.dtype)
    return out.index_add_(0, seg, src)
def _pad(x, pw):
    flat = tuple(v for pair in reversed(pw) for v in pair)
    return torch.nn.functional.pad(x, flat)

kernel_name = 'gated_mix__mha_block__glu_gated_geglu__prompt'

def setup_inputs():

    _w = (lambda a: (lambda t: t.to(torch.bfloat16) if t.is_floating_point() else t)(torch.as_tensor(a)))
    def _A_setup():
        B, S, D, H = 1, 2048, 448, 16
        return {
            "x": _w((lambda *s: torch.randn(*s, dtype=torch.bfloat16) * 0.05)(B, S, D)),
            "wqkv": _w((lambda *s: torch.randn(*s, dtype=torch.bfloat16) * 0.8)(D, 3 * D)),
            "wo": _w((lambda *s: torch.randn(*s, dtype=torch.bfloat16) * 0.05)(D, D)),
        }
    _A_in = _A_setup()

    def _B_setup():
        B, S, Dm, Df = 1, 2048, 448, 1792
        return {
            "x": _w((lambda *s: torch.randn(*s, dtype=torch.bfloat16) * 0.05)(B, S, Dm)),
            "w_gate": _w((lambda *s: torch.randn(*s, dtype=torch.bfloat16) * 1.6)(Dm, Df) * (Dm ** -0.5)),
            "w_up": _w((lambda *s: torch.randn(*s, dtype=torch.bfloat16) * 1.6)(Dm, Df) * (Dm ** -0.5)),
            "w_down": _w((lambda *s: torch.randn(*s, dtype=torch.bfloat16) * 1.6)(Df, Dm) * (Df ** -0.5)),
        }
    _B_in = _B_setup()

    return {
        "A_x": _A_in["x"],
        "A_wqkv": _A_in["wqkv"],
        "A_wo": _A_in["wo"],
        "B_x": _B_in["x"],
        "B_w_gate": _B_in["w_gate"],
        "B_w_up": _B_in["w_up"],
        "B_w_down": _B_in["w_down"],
        "gate_w": _w((lambda *s: torch.randn(*s, dtype=torch.bfloat16) * 0.05)(448) * 16.0),
    }

def reference(A_x, A_wqkv, A_wo, B_x, B_w_gate, B_w_up, B_w_down, gate_w):
    def _A_ref(x, wqkv, wo):
        B, S, D = x.shape
        H = 16
        Dh = D // H
        qkv = (lambda x, *d: x.permute(*d))((x @ wqkv).reshape(B, S, 3, H, Dh), 2, 0, 3, 1, 4)
        q, k, v = qkv[0], qkv[1], qkv[2]
        scores = torch.einsum("bhqd,bhkd->bhqk", q, k) * (Dh ** -0.5)
        p = _softmax(scores, axis=-1)
        o = torch.einsum("bhqk,bhkd->bhqd", p, v)
        return (lambda x, *d: x.permute(*d))(o, 0, 2, 1, 3).reshape(B, S, D) @ wo

    def _B_ref(x, w_gate, w_up, w_down):
        g = torch.einsum("bsd,df->bsf", x, w_gate)
        u = torch.einsum("bsd,df->bsf", x, w_up)
        h = _gelu(g) * u
        return torch.einsum("bsf,fd->bsd", h, w_down)

    x = A_x
    g = _sigmoid((x * gate_w).sum(-1, keepdims=True))
    a = _A_ref(x, A_wqkv, A_wo)
    b = _B_ref(x, B_w_gate, B_w_up, B_w_down)
    return g * a + (1 - g) * b
```

```asm
; @launch grid=(256,1,1) block=(512,1,1) lds=163840
.amdgcn_target "amdgcn-amd-amdhsa--gfx950"
.text
.globl gated_mix__mha_block__glu_gated_geglu__prompt_kernel
.p2align 8
.type gated_mix__mha_block__glu_gated_geglu__prompt_kernel,@function
gated_mix__mha_block__glu_gated_geglu__prompt_kernel:
    s_cmp_ge_u32 s2, 256
    s_cbranch_scc1 gated_mix__mha_block__glu_gated_geglu__prompt_kernel_exit
    s_load_dwordx2 s[32:33], s[0:1], 0
    s_load_dwordx2 s[28:29], s[0:1], 80
    s_load_dwordx2 s[36:37], s[0:1], 8
    s_load_dwordx2 s[40:41], s[0:1], 32
    s_load_dwordx2 s[44:45], s[0:1], 40
    s_load_dwordx2 s[48:49], s[0:1], 56
    s_getpc_b64 s[4:5]
gated_mix__mha_block__glu_gated_geglu__prompt_kernel_pc1:
    s_lshr_b32 s6, s2, 3
    s_mul_i32 s6, s6, 3072
    v_lshrrev_b32 v2, 6, v0
    v_mul_u32_u24 v2, 61, v2
    v_sub_u32 v2, v0, v2
    s_sub_u32 s4, s4, gated_mix__mha_block__glu_gated_geglu__prompt_kernel_pc1-gated_mix__mha_block__glu_gated_geglu__prompt_kernel
    s_subb_u32 s5, s5, 0
    v_lshl_add_u32 v2, v2, 7, s6
    v_min_u32 v2, gated_mix__mha_block__glu_gated_geglu__prompt_kernel_exit-gated_mix__mha_block__glu_gated_geglu__prompt_kernel, v2
    s_mov_b64 exec, 7
    global_load_dword v12, v2, s[4:5]
    s_mov_b64 exec, -1
    v_lshrrev_b32 v1, 6, v0
    v_and_b32 v0, 63, v0
    v_readfirstlane_b32 s26, v1
    s_bfe_u32 s59, s2, 0x20001
    s_lshl_b32 s59, s59, 2
    s_lshr_b32 s53, s2, 6
    s_add_u32 s53, s53, s59
    s_cmp_ge_u32 s53, 14
    s_cbranch_scc1 gated_mix__mha_block__glu_gated_geglu__prompt_kernel_q
    s_bfe_u32 s52, s2, 0x30003
    s_bitcmp1_b32 s2, 0
    s_cselect_b32 s59, 8, 0
    s_or_b32 s52, s52, s59
    v_lshrrev_b32 v2, 3, v0
    v_and_b32 v3, 7, v0
    v_lshrrev_b32 v5, 4, v0
    s_lshl_b32 s59, s52, 3
    v_mul_u32_u24 v6, 896, v2
    s_add_u32 s59, s59, s26
    v_xor_b32 v7, v3, v5
    s_mul_i32 s54, s59, 14336
    v_lshl_add_u32 v120, v7, 4, v6
    s_lshl_b32 s58, s26, 11
    v_xor_b32 v121, 64, v120
    v_add_u32 v121, 6144, v121
    v_and_b32 v4, 1, v5
    s_lshl_b32 s59, s26, 3
    v_add_u32 v6, s59, v2
    s_lshl_b32 s57, s26, 10
    v_mul_u32_u24 v8, 2688, v6
    s_lshr_b32 s59, s59, 1
    s_and_b32 s59, s59, 4
    v_lshl_or_b32 v7, v4, 1, s59
    v_xor_b32 v7, v3, v7
    v_lshl_add_u32 v122, v7, 4, v8
    s_lshl_b32 s55, s53, 7
    s_add_u32 s55, s55, 896
    v_mul_u32_u24 v8, 3584, v6
    v_lshl_add_u32 v123, v7, 4, v8
    s_lshl_b32 s56, s53, 8
    s_mov_b32 s42, 1605632
    s_mov_b32 s43, 0x00020000
    s_mov_b32 s46, 1605632
    s_mov_b32 s47, 0x00020000
    s_mov_b32 s34, 1835008
    s_mov_b32 s35, 0x00020000
    s_mov_b32 s38, 1204224
    s_mov_b32 s39, 0x00020000
    s_add_u32 m0, s58, 0
    s_waitcnt lgkmcnt(0)
    buffer_load_dwordx4 v120, s[32:35], s54 offen lds
    buffer_load_dwordx4 v121, s[32:35], s54 offen offset:1024 lds
    s_add_u32 m0, s57, 65536
    s_nop 0
    buffer_load_dwordx4 v122, s[36:39], s55 offen lds
    s_add_u32 m0, s57, 98304
    s_nop 0
    buffer_load_dwordx4 v123, s[40:43], s56 offen lds
    s_add_u32 m0, s57, 106496
    s_nop 0
    buffer_load_dwordx4 v123, s[44:47], s56 offen lds
    s_load_dwordx2 s[8:9], s[0:1], 16
    s_load_dwordx2 s[16:17], s[0:1], 48
    s_load_dwordx4 s[20:23], s[0:1], 64
    s_mov_b32 s50, 896
    s_mov_b32 s51, 0x00020000
    s_mov_b32 s30, 16777216
    s_mov_b32 s31, 0x00020000
    v_lshlrev_b32 v134, 4, v0
    s_and_b32 s60, s26, 3
    s_lshr_b32 s61, s26, 2
    s_cselect_b32 s71, 1, 0
    s_waitcnt lgkmcnt(0)
    s_cmp_lg_u32 s26, 7
    s_cbranch_scc1 gated_mix__mha_block__glu_gated_geglu__prompt_kernel_skip3
    v_lshlrev_b32 v10, 7, v0
    s_mov_b64 exec, 0x7f
    buffer_load_dword v11, v10, s[48:51], 0 offen
    s_mov_b64 exec, -1
gated_mix__mha_block__glu_gated_geglu__prompt_kernel_skip3:
    s_lshl_b32 s27, s52, 4
    s_add_u32 s27, s27, s53
    s_lshl_b32 s27, s27, 7
    s_add_u32 s27, s27, 15728640
    s_cmp_lg_u32 s26, 0
    s_cbranch_scc1 gated_mix__mha_block__glu_gated_geglu__prompt_kernel_skip4
    s_and_b32 s59, s2, 7
    s_lshl_b32 s59, s59, 1
    s_lshr_b32 s64, s2, 7
    s_add_u32 s59, s59, s64
    s_bfe_u32 s64, s2, 0x40003
    s_lshl_b32 s64, s64, 6
    s_add_u32 s59, s59, s64
    s_lshl_b32 s59, s59, 7
    s_add_u32 s59, s59, 15761408
    v_mov_b32 v10, 0
    v_lshlrev_b32 v9, 11, v0
    s_mov_b64 exec, 15
    buffer_store_dword v10, v9, s[28:31], s59 offen sc1
    s_mov_b64 exec, 1
    buffer_store_dword v10, off, s[28:31], s27 sc1
    s_mov_b64 exec, -1
gated_mix__mha_block__glu_gated_geglu__prompt_kernel_skip4:
    s_barrier
    s_add_u32 m0, s58, 16384
    s_add_u32 s64, s54, 128
    buffer_load_dwordx4 v120, s[32:35], s64 offen lds
    buffer_load_dwordx4 v121, s[32:35], s64 offen offset:1024 lds
    s_add_u32 m0, s57, 73728
    s_add_u32 s64, s55, 172032
    buffer_load_dwordx4 v122, s[36:39], s64 offen lds
    s_add_u32 m0, s57, 114688
    s_add_u32 s64, s56, 229376
    buffer_load_dwordx4 v123, s[40:43], s64 offen lds
    s_add_u32 m0, s57, 122880
    s_add_u32 s64, s56, 229376
    buffer_load_dwordx4 v123, s[44:47], s64 offen lds
    s_lshl_b32 s18, s2, 3
    s_add_u32 s18, s18, s26
    s_lshl_b32 s19, s18, 7
    v_lshl_add_u32 v13, v0, 18, s19
    s_mov_b32 s42, 1605632
    s_mov_b32 s43, 0x00020000
    s_mov_b32 s46, 1605632
    s_mov_b32 s47, 0x00020000
    s_mul_i32 s18, s18, 896
    v_lshl_add_u32 v14, v0, 7, s18
    s_mov_b32 s18, 688128
    s_mov_b32 s19, 516096
    s_mov_b64 exec, 15
    buffer_load_dword v11, v14, s[32:35], 0 offen offset:384
    buffer_load_dword v11, v13, s[36:39], s19 offen
    s_mov_b64 exec, 0x7f
    buffer_load_dword v11, v13, s[40:43], s18 offen
    buffer_load_dword v11, v13, s[44:47], s18 offen
    s_mov_b64 exec, -1
    s_lshl_b32 s10, s52, 7
    s_lshl_b32 s11, s53, 3
    s_add_u32 s10, s10, s11
    s_add_u32 s3, s10, s26
    s_mul_i32 s10, s3, 896
    v_mov_b64 v[136:137], 0
    v_mov_b64 v[138:139], 0
    v_mov_b64 v[140:141], 0
    v_mov_b64 v[142:143], 0
    s_mov_b32 exec_hi, 0x00ffffff
    buffer_load_dwordx4 v[136:139], v134, s[32:35], s10 offen
    buffer_load_dwordx4 v[140:143], v134, s[48:51], 0 offen
    s_mov_b64 exec, -1
    v_and_b32 v2, 15, v0
    v_lshrrev_b32 v3, 4, v0
    s_lshl_b32 s59, s60, 12
    v_lshl_add_u32 v4, v2, 7, s59
    v_lshrrev_b32 v5, 1, v2
    v_xor_b32 v5, v5, v3
    v_lshl_add_u32 v125, v5, 4, v4
    v_xor_b32 v126, 64, v125
    v_and_b32 v2, 3, v0
    v_bfe_u32 v4, v0, 2, 2
    v_lshl_add_u32 v5, v3, 3, v4
    v_bfe_u32 v6, v0, 3, 2
    s_lshl_b32 s59, s61, 1
    v_xor_b32 v6, s59, v6
    v_lshlrev_b32 v6, 5, v6
    v_lshl_add_u32 v5, v5, 7, v6
    v_lshl_add_u32 v6, v2, 3, v5
    v_add_u32 v129, 65536, v6
    v_xor_b32 v127, 32, v129
    v_lshrrev_b32 v6, 1, v2
    v_and_b32 v7, 1, v2
    v_lshl_or_b32 v6, v7, 1, v6
    v_lshl_add_u32 v6, v6, 3, v5
    v_add_u32 v130, 98304, v6
    v_xor_b32 v131, 32, v130
    v_mov_b32 v132, v6
    v_xor_b32 v133, 32, v6
    v_mov_b32 v15, 0xc0135761
    s_waitcnt vmcnt(11)
    s_barrier
    ds_read_b128 v[144:147], v125 offset:0
    ds_read_b128 v[148:151], v125 offset:2048
    ds_read_b64_tr_b16 v[108:109], v129 offset:0
    ds_read_b64_tr_b16 v[110:111], v129 offset:512
    ds_read_b64_tr_b16 v[112:113], v130 offset:0
    ds_read_b64_tr_b16 v[114:115], v130 offset:512
    ds_read_b64_tr_b16 v[116:117], v131 offset:0
    ds_read_b64_tr_b16 v[118:119], v131 offset:512
    ds_read_b64_tr_b16 v[64:65], v127 offset:0
    ds_read_b64_tr_b16 v[66:67], v127 offset:512
    ds_read_b64_tr_b16 v[68:69], v130 offset:8192
    ds_read_b64_tr_b16 v[70:71], v130 offset:8704
    ds_read_b64_tr_b16 v[72:73], v131 offset:8192
    ds_read_b64_tr_b16 v[74:75], v131 offset:8704
    s_cmp_ge_u32 s53, 7
    s_cbranch_scc0 gated_mix__mha_block__glu_gated_geglu__prompt_kernel_isv9
    s_cmp_eq_u32 s71, 0
    s_cbranch_scc1 gated_mix__mha_block__glu_gated_geglu__prompt_kernel_V0_7
    s_branch gated_mix__mha_block__glu_gated_geglu__prompt_kernel_V1_8
gated_mix__mha_block__glu_gated_geglu__prompt_kernel_isv9:
    s_cmp_eq_u32 s71, 0
    s_cbranch_scc0 gated_mix__mha_block__glu_gated_geglu__prompt_kernel_K1_6
    s_waitcnt lgkmcnt(10)
    v_mfma_f32_16x16x32_bf16 v[16:19], v[108:111], v[144:147], 0
    v_mfma_f32_16x16x32_bf16 v[20:23], v[108:111], v[148:151], 0
    ds_read_b128 v[152:155], v126 offset:0
    ds_read_b128 v[156:159], v126 offset:2048
    ds_read_b64_tr_b16 v[96:97], v129 offset:4096
    ds_read_b64_tr_b16 v[98:99], v129 offset:4608
    s_add_u32 m0, s58, 32768
    s_add_u32 s64, s54, 256
    buffer_load_dwordx4 v120, s[32:35], s64 offen lds
    buffer_load_dwordx4 v121, s[32:35], s64 offen offset:1024 lds
    s_waitcnt lgkmcnt(12)
    v_mfma_f32_16x16x32_bf16 v[32:35], v[112:115], v[144:147], 0
    v_mfma_f32_16x16x32_bf16 v[36:39], v[112:115], v[148:151], 0
    ds_read_b64_tr_b16 v[100:101], v130 offset:4096
    ds_read_b64_tr_b16 v[102:103], v130 offset:4608
    s_add_u32 m0, s58, 40960
    s_add_u32 s64, s54, 57600
    buffer_load_dwordx4 v120, s[32:35], s64 offen lds
    buffer_load_dwordx4 v121, s[32:35], s64 offen offset:1024 lds
    s_add_u32 m0, s57, 81920
    s_add_u32 s64, s55, 344064
    buffer_load_dwordx4 v122, s[36:39], s64 offen lds
    s_waitcnt lgkmcnt(12)
    v_mfma_f32_16x16x32_bf16 v[48:51], v[116:119], v[144:147], 0
    v_mfma_f32_16x16x32_bf16 v[52:55], v[116:119], v[148:151], 0
    ds_read_b64_tr_b16 v[104:105], v131 offset:4096
    ds_read_b64_tr_b16 v[106:107], v131 offset:4608
    s_add_u32 m0, s57, 86016
    s_add_u32 s64, s55, 430080
    buffer_load_dwordx4 v122, s[36:39], s64 offen lds
    s_waitcnt lgkmcnt(12)
    v_mfma_f32_16x16x32_bf16 v[24:27], v[64:67], v[144:147], 0
    v_mfma_f32_16x16x32_bf16 v[28:31], v[64:67], v[148:151], 0
    ds_read_b64_tr_b16 v[108:109], v127 offset:4096
    ds_read_b64_tr_b16 v[110:111], v127 offset:4608
    s_add_u32 m0, s57, 131072
    s_add_u32 s64, s56, 458752
    buffer_load_dwordx4 v123, s[40:43], s64 offen lds
    s_waitcnt lgkmcnt(12)
    v_mfma_f32_16x16x32_bf16 v[40:43], v[68:71], v[144:147], 0
    v_mfma_f32_16x16x32_bf16 v[44:47], v[68:71], v[148:151], 0
    ds_read_b64_tr_b16 v[112:113], v130 offset:12288
    ds_read_b64_tr_b16 v[114:115], v130 offset:12800
    s_add_u32 m0, s57, 135168
    s_add_u32 s64, s56, 573440
    buffer_load_dwordx4 v123, s[40:43], s64 offen lds
    s_add_u32 m0, s57, 139264
    s_add_u32 s64, s56, 458752
    buffer_load_dwordx4 v123, s[44:47], s64 offen lds
    s_waitcnt lgkmcnt(12)
    v_mfma_f32_16x16x32_bf16 v[56:59], v[72:75], v[144:147], 0
    v_mfma_f32_16x16x32_bf16 v[60:63], v[72:75], v[148:151], 0
    ds_read_b64_tr_b16 v[116:117], v131 offset:12288
    ds_read_b64_tr_b16 v[118:119], v131 offset:12800
    s_add_u32 m0, s57, 143360
    s_add_u32 s64, s56, 573440
    buffer_load_dwordx4 v123, s[44:47], s64 offen lds
    s_waitcnt lgkmcnt(0)
    v_mfma_f32_16x16x32_bf16 v[16:19], v[96:99], v[152:155], v[16:19]
    v_mfma_f32_16x16x32_bf16 v[20:23], v[96:99], v[156:159], v[20:23]
    s_waitcnt vmcnt(16)
    s_barrier
    ds_read_b128 v[160:163], v125 offset:16384
    ds_read_b128 v[164:167], v125 offset:18432
    ds_read_b64_tr_b16 v[64:65], v129 offset:8192
    ds_read_b64_tr_b16 v[66:67], v129 offset:8704
    v_mfma_f32_16x16x32_bf16 v[32:35], v[100:103], v[152:155], v[32:35]
    v_mfma_f32_16x16x32_bf16 v[36:39], v[100:103], v[156:159], v[36:39]
    ds_read_b64_tr_b16 v[68:69], v130 offset:16384
    ds_read_b64_tr_b16 v[70:71], v130 offset:16896
    s_add_u32 m0, s58, 49152
    s_add_u32 s64, s54, 384
    buffer_load_dwordx4 v120, s[32:35], s64 offen lds
    buffer_load_dwordx4 v121, s[32:35], s64 offen offset:1024 lds
    v_mfma_f32_16x16x32_bf16 v[48:51], v[104:107], v[152:155], v[48:51]
    v_mfma_f32_16x16x32_bf16 v[52:55], v[104:107], v[156:159], v[52:55]
    ds_read_b64_tr_b16 v[72:73], v131 offset:16384
    ds_read_b64_tr_b16 v[74:75], v131 offset:16896
    s_add_u32 m0, s58, 57344
    s_add_u32 s64, s54, 57728
    buffer_load_dwordx4 v120, s[32:35], s64 offen lds
    buffer_load_dwordx4 v121, s[32:35], s64 offen offset:1024 lds
    v_mfma_f32_16x16x32_bf16 v[24:27], v[108:111], v[152:155], v[24:27]
    v_mfma_f32_16x16x32_bf16 v[28:31], v[108:111], v[156:159], v[28:31]
    ds_read_b64_tr_b16 v[96:97], v127 offset:8192
    ds_read_b64_tr_b16 v[98:99], v127 offset:8704
    v_mfma_f32_16x16x32_bf16 v[40:43], v[112:115], v[152:155], v[40:43]
    v_mfma_f32_16x16x32_bf16 v[44:47], v[112:115], v[156:159], v[44:47]
    ds_read_b64_tr_b16 v[100:101], v130 offset:24576
    ds_read_b64_tr_b16 v[102:103], v130 offset:25088
    s_add_u32 m0, s57, 90112
    s_add_u32 s64, s55, 516096
    buffer_load_dwordx4 v122, s[36:39], s64 offen lds
    v_mfma_f32_16x16x32_bf16 v[56:59], v[116:119], v[152:155], v[56:59]
    v_mfma_f32_16x16x32_bf16 v[60:63], v[116:119], v[156:159], v[60:63]
    ds_read_b64_tr_b16 v[104:105], v131 offset:24576
    ds_read_b64_tr_b16 v[106:107], v131 offset:25088
    s_add_u32 m0, s57, 94208
    s_add_u32 s64, s55, 602112
    buffer_load_dwordx4 v122, s[36:39], s64 offen lds
    s_waitcnt lgkmcnt(6)
    v_mfma_f32_16x16x32_bf16 v[16:19], v[64:67], v[160:163], v[16:19]
    v_mfma_f32_16x16x32_bf16 v[20:23], v[64:67], v[164:167], v[20:23]
    ds_read_b128 v[168:171], v126 offset:16384
    ds_read_b128 v[172:175], v126 offset:18432
    ds_read_b64_tr_b16 v[108:109], v129 offset:12288
    ds_read_b64_tr_b16 v[110:111], v129 offset:12800
    v_mfma_f32_16x16x32_bf16 v[32:35], v[68:71], v[160:163], v[32:35]
    v_mfma_f32_16x16x32_bf16 v[36:39], v[68:71], v[164:167], v[36:39]
    ds_read_b64_tr_b16 v[112:113], v130 offset:20480
    ds_read_b64_tr_b16 v[114:115], v130 offset:20992
    s_add_u32 m0, s57, 147456
    s_add_u32 s64, s56, 688128
    buffer_load_dwordx4 v123, s[40:43], s64 offen lds
    v_mfma_f32_16x16x32_bf16 v[48:51], v[72:75], v[160:163], v[48:51]
    v_mfma_f32_16x16x32_bf16 v[52:55], v[72:75], v[164:167], v[52:55]
    ds_read_b64_tr_b16 v[116:117], v131 offset:20480
    ds_read_b64_tr_b16 v[118:119], v131 offset:20992
    s_add_u32 m0, s57, 151552
    s_add_u32 s64, s56, 802816
    buffer_load_dwordx4 v123, s[40:43], s64 offen lds
    s_waitcnt lgkmcnt(8)
    v_mfma_f32_16x16x32_bf16 v[24:27], v[96:99], v[160:163], v[24:27]
    v_mfma_f32_16x16x32_bf16 v[28:31], v[96:99], v[164:167], v[28:31]
    ds_read_b64_tr_b16 v[64:65], v127 offset:12288
    ds_read_b64_tr_b16 v[66:67], v127 offset:12800
    v_mfma_f32_16x16x32_bf16 v[40:43], v[100:103], v[160:163], v[40:43]
    v_mfma_f32_16x16x32_bf16 v[44:47], v[100:103], v[164:167], v[44:47]
    ds_read_b64_tr_b16 v[68:69], v130 offset:28672
    ds_read_b64_tr_b16 v[70:71], v130 offset:29184
    s_add_u32 m0, s57, 155648
    s_add_u32 s64, s56, 688128
    buffer_load_dwordx4 v123, s[44:47], s64 offen lds
    v_mfma_f32_16x16x32_bf16 v[56:59], v[104:107], v[160:163], v[56:59]
    v_mfma_f32_16x16x32_bf16 v[60:63], v[104:107], v[164:167], v[60:63]
    ds_read_b64_tr_b16 v[72:73], v131 offset:28672
    ds_read_b64_tr_b16 v[74:75], v131 offset:29184
    s_add_u32 m0, s57, 159744
    s_add_u32 s64, s56, 802816
    buffer_load_dwordx4 v123, s[44:47], s64 offen lds
    s_waitcnt lgkmcnt(0)
    v_mfma_f32_16x16x32_bf16 v[16:19], v[108:111], v[168:171], v[16:19]
    v_mfma_f32_16x16x32_bf16 v[20:23], v[108:111], v[172:175], v[20:23]
    s_waitcnt vmcnt(10)
    s_barrier
    ds_read_b128 v[176:179], v125 offset:32768
    ds_read_b128 v[180:183], v125 offset:34816
    ds_read_b64_tr_b16 v[96:97], v129 offset:16384
    ds_read_b64_tr_b16 v[98:99], v129 offset:16896
    v_mfma_f32_16x16x32_bf16 v[32:35], v[112:115], v[168:171], v[32:35]
    v_mfma_f32_16x16x32_bf16 v[36:39], v[112:115], v[172:175], v[36:39]
    ds_read_b64_tr_b16 v[100:101], v130 offset:32768
    ds_read_b64_tr_b16 v[102:103], v130 offset:33280
    s_add_u32 m0, s58, 0
    s_add_u32 s64, s54, 512
    buffer_load_dwordx4 v120, s[32:35], s64 offen lds
    buffer_load_dwordx4 v121, s[32:35], s64 offen offset:1024 lds
    v_mfma_f32_16x16x32_bf16 v[48:51], v[116:119], v[168:171], v[48:51]
    v_mfma_f32_16x16x32_bf16 v[52:55], v[116:119], v[172:175], v[52:55]
    ds_read_b64_tr_b16 v[104:105], v131 offset:32768
    ds_read_b64_tr_b16 v[106:107], v131 offset:33280
    s_add_u32 m0, s58, 8192
    s_add_u32 s64, s54, 57856
    buffer_load_dwordx4 v120, s[32:35], s64 offen lds
    buffer_load_dwordx4 v121, s[32:35], s64 offen offset:1024 lds
    v_mfma_f32_16x16x32_bf16 v[24:27], v[64:67], v[168:171], v[24:27]
    v_mfma_f32_16x16x32_bf16 v[28:31], v[64:67], v[172:175], v[28:31]
    ds_read_b64_tr_b16 v[108:109], v127 offset:16384
    ds_read_b64_tr_b16 v[110:111], v127 offset:16896
    v_mfma_f32_16x16x32_bf16 v[40:43], v[68:71], v[168:171], v[40:43]
    v_mfma_f32_16x16x32_bf16 v[44:47], v[68:71], v[172:175], v[44:47]
    ds_read_b64_tr_b16 v[112:113], v130 offset:40960
    ds_read_b64_tr_b16 v[114:115], v130 offset:41472
    s_add_u32 m0, s57, 65536
    s_add_u32 s64, s55, 688128
    buffer_load_dwordx4 v122, s[36:39], s64 offen lds
    v_mfma_f32_16x16x32_bf16 v[56:59], v[72:75], v[168:171], v[56:59]
    v_mfma_f32_16x16x32_bf16 v[60:63], v[72:75], v[172:175], v[60:63]
    ds_read_b64_tr_b16 v[116:117], v131 offset:40960
    ds_read_b64_tr_b16 v[118:119], v131 offset:41472
    s_add_u32 m0, s57, 69632
    s_add_u32 s64, s55, 774144
    buffer_load_dwordx4 v122, s[36:39], s64 offen lds
    s_waitcnt lgkmcnt(6)
    v_mfma_f32_16x16x32_bf16 v[16:19], v[96:99], v[176:179], v[16:19]
    v_mfma_f32_16x16x32_bf16 v[20:23], v[96:99], v[180:183], v[20:23]
    ds_read_b128 v[184:187], v126 offset:32768
    ds_read_b128 v[188:191], v126 offset:34816
    ds_read_b64_tr_b16 v[64:65], v129 offset:20480
    ds_read_b64_tr_b16 v[66:67], v129 offset:20992
    v_mfma_f32_16x16x32_bf16 v[32:35], v[100:103], v[176:179], v[32:35]
    v_mfma_f32_16x16x32_bf16 v[36:39], v[100:103], v[180:183], v[36:39]
    ds_read_b64_tr_b16 v[68:69], v130 offset:36864
    ds_read_b64_tr_b16 v[70:71], v130 offset:37376
    s_add_u32 m0, s57, 98304
    s_add_u32 s64, s56, 917504
    buffer_load_dwordx4 v123, s[40:43], s64 offen lds
    v_mfma_f32_16x16x32_bf16 v[48:51], v[104:107], v[176:179], v[48:51]
    v_mfma_f32_16x16x32_bf16 v[52:55], v[104:107], v[180:183], v[52:55]
    ds_read_b64_tr_b16 v[72:73], v131 offset:36864
    ds_read_b64_tr_b16 v[74:75], v131 offset:37376
    s_add_u32 m0, s57, 102400
    s_add_u32 s64, s56, 1032192
    buffer_load_dwordx4 v123, s[40:43], s64 offen lds
    s_waitcnt lgkmcnt(8)
    v_mfma_f32_16x16x32_bf16 v[24:27], v[108:111], v[176:179], v[24:27]
    v_mfma_f32_16x16x32_bf16 v[28:31], v[108:111], v[180:183], v[28:31]
    ds_read_b64_tr_b16 v[96:97], v127 offset:20480
    ds_read_b64_tr_b16 v[98:99], v127 offset:20992
    v_mov_b32 v1, 0
    v_mfma_f32_16x16x32_bf16 v[40:43], v[112:115], v[176:179], v[40:43]
    v_mfma_f32_16x16x32_bf16 v[44:47], v[112:115], v[180:183], v[44:47]
    ds_read_b64_tr_b16 v[100:101], v130 offset:45056
    ds_read_b64_tr_b16 v[102:103], v130 offset:45568
    s_add_u32 m0, s57, 106496
    s_add_u32 s64, s56, 917504
    buffer_load_dwordx4 v123, s[44:47], s64 offen lds
    v_dot2_f32_bf16 v1, v136, v140, v1
    v_mfma_f32_16x16x32_bf16 v[56:59], v[116:119], v[176:179], v[56:59]
    v_mfma_f32_16x16x32_bf16 v[60:63], v[116:119], v[180:183], v[60:63]
    ds_read_b64_tr_b16 v[104:105], v131 offset:45056
    ds_read_b64_tr_b16 v[106:107], v131 offset:45568
    s_add_u32 m0, s57, 110592
    s_add_u32 s64, s56, 1032192
    buffer_load_dwordx4 v123, s[44:47], s64 offen lds
    v_dot2_f32_bf16 v1, v137, v141, v1
    s_waitcnt lgkmcnt(0)
    v_mfma_f32_16x16x32_bf16 v[16:19], v[64:67], v[184:187], v[16:19]
    v_mfma_f32_16x16x32_bf16 v[20:23], v[64:67], v[188:191], v[20:23]
    s_waitcnt vmcnt(10)
    s_barrier
    ds_read_b128 v[192:195], v125 offset:49152
    ds_read_b128 v[196:199], v125 offset:51200
    ds_read_b64_tr_b16 v[108:109], v129 offset:24576
    ds_read_b64_tr_b16 v[110:111], v129 offset:25088
    v_dot2_f32_bf16 v1, v138, v142, v1
    v_mfma_f32_16x16x32_bf16 v[32:35], v[68:71], v[184:187], v[32:35]
    v_mfma_f32_16x16x32_bf16 v[36:39], v[68:71], v[188:191], v[36:39]
    ds_read_b64_tr_b16 v[112:113], v130 offset:49152
    ds_read_b64_tr_b16 v[114:115], v130 offset:49664
    s_add_u32 m0, s58, 16384
    s_add_u32 s64, s54, 640
    buffer_load_dwordx4 v120, s[32:35], s64 offen lds
    buffer_load_dwordx4 v121, s[32:35], s64 offen offset:1024 lds
    v_dot2_f32_bf16 v1, v139, v143, v1
    s_nop 2
    v_add_f32_dpp v1, v1, v1 row_shr:1 row_mask:0xf bank_mask:0xf
    v_mfma_f32_16x16x32_bf16 v[48:51], v[72:75], v[184:187], v[48:51]
    v_mfma_f32_16x16x32_bf16 v[52:55], v[72:75], v[188:191], v[52:55]
    ds_read_b64_tr_b16 v[116:117], v131 offset:49152
    ds_read_b64_tr_b16 v[118:119], v131 offset:49664
    s_add_u32 m0, s58, 24576
    s_add_u32 s64, s54, 57984
    buffer_load_dwordx4 v120, s[32:35], s64 offen lds
    buffer_load_dwordx4 v121, s[32:35], s64 offen offset:1024 lds
    v_add_f32_dpp v1, v1, v1 row_shr:2 row_mask:0xf bank_mask:0xf
    v_mfma_f32_16x16x32_bf16 v[24:27], v[96:99], v[184:187], v[24:27]
    v_mfma_f32_16x16x32_bf16 v[28:31], v[96:99], v[188:191], v[28:31]
    ds_read_b64_tr_b16 v[64:65], v127 offset:24576
    ds_read_b64_tr_b16 v[66:67], v127 offset:25088
    v_add_f32_dpp v1, v1, v1 row_shr:4 row_mask:0xf bank_mask:0xf
    v_mfma_f32_16x16x32_bf16 v[40:43], v[100:103], v[184:187], v[40:43]
    v_mfma_f32_16x16x32_bf16 v[44:47], v[100:103], v[188:191], v[44:47]
    ds_read_b64_tr_b16 v[68:69], v130 offset:57344
    ds_read_b64_tr_b16 v[70:71], v130 offset:57856
    s_add_u32 m0, s57, 73728
    s_add_u32 s64, s55, 860160
    buffer_load_dwordx4 v122, s[36:39], s64 offen lds
    v_add_f32_dpp v1, v1, v1 row_shr:8 row_mask:0xf bank_mask:0xf
    v_mfma_f32_16x16x32_bf16 v[56:59], v[104:107], v[184:187], v[56:59]
    v_mfma_f32_16x16x32_bf16 v[60:63], v[104:107], v[188:191], v[60:63]
    ds_read_b64_tr_b16 v[72:73], v131 offset:57344
    ds_read_b64_tr_b16 v[74:75], v131 offset:57856
    s_add_u32 m0, s57, 77824
    s_add_u32 s64, s55, 946176
    buffer_load_dwordx4 v122, s[36:39], s64 offen lds
    v_add_f32_dpp v1, v1, v1 row_bcast:15 row_mask:0xa bank_mask:0xf
    s_waitcnt lgkmcnt(6)
    v_mfma_f32_16x16x32_bf16 v[16:19], v[108:111], v[192:195], v[16:19]
    v_mfma_f32_16x16x32_bf16 v[20:23], v[108:111], v[196:199], v[20:23]
    ds_read_b128 v[200:203], v126 offset:49152
    ds_read_b128 v[204:207], v126 offset:51200
    ds_read_b64_tr_b16 v[96:97], v129 offset:28672
    ds_read_b64_tr_b16 v[98:99], v129 offset:29184
    v_add_f32_dpp v1, v1, v1 row_bcast:31 row_mask:0xc bank_mask:0xf
    v_mul_f32 v1, 0xbfb8aa3b, v1
    v_mfma_f32_16x16x32_bf16 v[32:35], v[112:115], v[192:195], v[32:35]
    v_mfma_f32_16x16x32_bf16 v[36:39], v[112:115], v[196:199], v[36:39]
    ds_read_b64_tr_b16 v[100:101], v130 offset:53248
    ds_read_b64_tr_b16 v[102:103], v130 offset:53760
    s_add_u32 m0, s57, 114688
    s_add_u32 s64, s56, 1146880
    buffer_load_dwordx4 v123, s[40:43], s64 offen lds
    v_exp_f32 v1, v1
    v_mfma_f32_16x16x32_bf16 v[48:51], v[116:119], v[192:195], v[48:51]
    v_mfma_f32_16x16x32_bf16 v[52:55], v[116:119], v[196:199], v[52:55]
    ds_read_b64_tr_b16 v[104:105], v131 offset:53248
    ds_read_b64_tr_b16 v[106:107], v131 offset:53760
    s_add_u32 m0, s57, 118784
    s_add_u32 s64, s56, 1261568
    buffer_load_dwordx4 v123, s[40:43], s64 offen lds
    s_lshl_b32 s3, s3, 2
    s_waitcnt lgkmcnt(8)
    v_mfma_f32_16x16x32_bf16 v[24:27], v[64:67], v[192:195], v[24:27]
    v_mfma_f32_16x16x32_bf16 v[28:31], v[64:67], v[196:199], v[28:31]
    ds_read_b64_tr_b16 v[108:109], v127 offset:28672
    ds_read_b64_tr_b16 v[110:111], v127 offset:29184
    v_add_f32 v1, 1.0, v1
    v_mfma_f32_16x16x32_bf16 v[40:43], v[68:71], v[192:195], v[40:43]
    v_mfma_f32_16x16x32_bf16 v[44:47], v[68:71], v[196:199], v[44:47]
    ds_read_b64_tr_b16 v[112:113], v130 offset:61440
    ds_read_b64_tr_b16 v[114:115], v130 offset:61952
    s_add_u32 m0, s57, 122880
    s_add_u32 s64, s56, 1146880
    buffer_load_dwordx4 v123, s[44:47], s64 offen lds
    v_rcp_f32 v1, v1
    v_mfma_f32_16x16x32_bf16 v[56:59], v[72:75], v[192:195], v[56:59]
    v_mfma_f32_16x16x32_bf16 v[60:63], v[72:75], v[196:199], v[60:63]
    ds_read_b64_tr_b16 v[116:117], v131 offset:61440
    ds_read_b64_tr_b16 v[118:119], v131 offset:61952
    s_add_u32 m0, s57, 126976
    s_add_u32 s64, s56, 1261568
    buffer_load_dwordx4 v123, s[44:47], s64 offen lds
    s_add_u32 s3, s3, 14942208
    s_mov_b32 exec_lo, 0
    s_mov_b32 exec_hi, 0x80000000
    buffer_store_dword v1, off, s[28:31], s3 sc1
    s_mov_b64 exec, -1
    s_waitcnt lgkmcnt(0)
    v_mfma_f32_16x16x32_bf16 v[16:19], v[96:99], v[200:203], v[16:19]
    v_mfma_f32_16x16x32_bf16 v[20:23], v[96:99], v[204:207], v[20:23]
    s_waitcnt vmcnt(11)
    s_barrier
    ds_read_b128 v[208:211], v125 offset:0
    ds_read_b128 v[212:215], v125 offset:2048
    ds_read_b64_tr_b16 v[64:65], v129 offset:0
    ds_read_b64_tr_b16 v[66:67], v129 offset:512
    s_lshl_b32 s0, s52, 2
    s_add_u32 s0, s0, s60
    v_mfma_f32_16x16x32_bf16 v[32:35], v[100:103], v[200:203], v[32:35]
    v_mfma_f32_16x16x32_bf16 v[36:39], v[100:103], v[204:207], v[36:39]
    ds_read_b64_tr_b16 v[68:69], v130 offset:0
    ds_read_b64_tr_b16 v[70:71], v130 offset:512
    s_add_u32 m0, s58, 32768
    s_add_u32 s64, s54, 768
    buffer_load_dwordx4 v120, s[32:35], s64 offen lds
    buffer_load_dwordx4 v121, s[32:35], s64 offen offset:1024 lds
    s_mul_i32 s62, s0, 28672
    s_mul_i32 s63, s0, 114688
    s_lshl_b32 s0, s53, 13
    v_mfma_f32_16x16x32_bf16 v[48:51], v[104:107], v[200:203], v[48:51]
    v_mfma_f32_16x16x32_bf16 v[52:55], v[104:107], v[204:207], v[52:55]
    ds_read_b64_tr_b16 v[72:73], v131 offset:0
    ds_read_b64_tr_b16 v[74:75], v131 offset:512
    s_add_u32 m0, s58, 40960
    s_add_u32 s64, s54, 58112
    buffer_load_dwordx4 v120, s[32:35], s64 offen lds
    buffer_load_dwordx4 v121, s[32:35], s64 offen offset:1024 lds
    s_add_u32 s63, s63, s0
    s_add_u32 s63, s63, 5505024
    s_lshl_b32 s0, s53, 12
    v_mfma_f32_16x16x32_bf16 v[24:27], v[108:111], v[200:203], v[24:27]
    v_mfma_f32_16x16x32_bf16 v[28:31], v[108:111], v[204:207], v[28:31]
    ds_read_b64_tr_b16 v[96:97], v127 offset:0
    ds_read_b64_tr_b16 v[98:99], v127 offset:512
    s_add_u32 s62, s62, s0
    s_add_u32 s62, s62, 1835008
    s_and_b32 s0, s2, 7
    v_mfma_f32_16x16x32_bf16 v[40:43], v[112:115], v[200:203], v[40:43]
    v_mfma_f32_16x16x32_bf16 v[44:47], v[112:115], v[204:207], v[44:47]
    ds_read_b64_tr_b16 v[100:101], v130 offset:8192
    ds_read_b64_tr_b16 v[102:103], v130 offset:8704
    s_add_u32 m0, s57, 81920
    s_add_u32 s64, s55, 1032192
    buffer_load_dwordx4 v122, s[36:39], s64 offen lds
    s_lshr_b32 s1, s2, 3
    s_lshl_b32 s66, s0, 1
    s_lshr_b32 s67, s2, 7
    v_mfma_f32_16x16x32_bf16 v[56:59], v[116:119], v[200:203], v[56:59]
    v_mfma_f32_16x16x32_bf16 v[60:63], v[116:119], v[204:207], v[60:63]
    ds_read_b64_tr_b16 v[104:105], v131 offset:8192
    ds_read_b64_tr_b16 v[106:107], v131 offset:8704
    s_add_u32 m0, s57, 86016
    s_add_u32 s64, s55, 1118208
    buffer_load_dwordx4 v122, s[36:39], s64 offen lds
    s_add_u32 s66, s66, s67
    s_and_b32 s67, s1, 15
    s_and_b32 s70, s26, 3
    s_waitcnt lgkmcnt(6)
    v_mfma_f32_16x16x32_bf16 v[16:19], v[64:67], v[208:211], v[16:19]
    v_mfma_f32_16x16x32_bf16 v[20:23], v[64:67], v[212:215], v[20:23]
    ds_read_b128 v[216:219], v126 offset:0
    ds_read_b128 v[220:223], v126 offset:2048
    ds_read_b64_tr_b16 v[108:109], v129 offset:4096
    ds_read_b64_tr_b16 v[110:111], v129 offset:4608
    s_lshl_b32 s0, s26, 8
    s_add_u32 s0, s0, 155648
    v_lshl_add_u32 v14, v0, 2, s0
    v_mfma_f32_16x16x32_bf16 v[32:35], v[68:71], v[208:211], v[32:35]
    v_mfma_f32_16x16x32_bf16 v[36:39], v[68:71], v[212:215], v[36:39]
    ds_read_b64_tr_b16 v[112:113], v130 offset:4096
    ds_read_b64_tr_b16 v[114:115], v130 offset:4608
    s_add_u32 m0, s57, 131072
    s_add_u32 s64, s56, 1376256
    buffer_load_dwordx4 v123, s[40:43], s64 offen lds
    s_lshr_b32 s0, s2, 3
    s_bitcmp1_b32 s2, 0
    s_cselect_b32 s1, 32, 0
    s_cselect_b32 s69, 24, 32
    s_cmp_ge_u32 s0, s69
    s_cselect_b32 s69, 7, 0
    v_mfma_f32_16x16x32_bf16 v[48:51], v[72:75], v[208:211], v[48:51]
    v_mfma_f32_16x16x32_bf16 v[52:55], v[72:75], v[212:215], v[52:55]
    ds_read_b64_tr_b16 v[116:117], v131 offset:4096
    ds_read_b64_tr_b16 v[118:119], v131 offset:4608
    s_add_u32 m0, s57, 135168
    s_add_u32 s64, s56, 1490944
    buffer_load_dwordx4 v123, s[40:43], s64 offen lds
    s_add_u32 s0, s0, s1
    s_mul_i32 s68, s0, 9363
    s_lshr_b32 s68, s68, 16
    s_waitcnt lgkmcnt(8)
    v_mfma_f32_16x16x32_bf16 v[24:27], v[96:99], v[208:211], v[24:27]
    v_mfma_f32_16x16x32_bf16 v[28:31], v[96:99], v[212:215], v[28:31]
    ds_read_b64_tr_b16 v[64:65], v127 offset:4096
    ds_read_b64_tr_b16 v[66:67], v127 offset:4608
    s_mul_i32 s1, s68, 7
    s_sub_u32 s0, s0, s1
    v_mfma_f32_16x16x32_bf16 v[40:43], v[100:103], v[208:211], v[40:43]
    v_mfma_f32_16x16x32_bf16 v[44:47], v[100:103], v[212:215], v[44:47]
    ds_read_b64_tr_b16 v[68:69], v130 offset:12288
    ds_read_b64_tr_b16 v[70:71], v130 offset:12800
    s_add_u32 m0, s57, 139264
    s_add_u32 s64, s56, 1376256
    buffer_load_dwordx4 v123, s[44:47], s64 offen lds
    s_or_b32 s69, s69, s0
    s_min_u32 s68, s68, 7
    s_bfe_u32 s0, s2, 0x20001
    v_mfma_f32_16x16x32_bf16 v[56:59], v[104:107], v[208:211], v[56:59]
    v_mfma_f32_16x16x32_bf16 v[60:63], v[104:107], v[212:215], v[60:63]
    ds_read_b64_tr_b16 v[72:73], v131 offset:12288
    ds_read_b64_tr_b16 v[74:75], v131 offset:12800
    s_add_u32 m0, s57, 143360
    s_add_u32 s64, s56, 1490944
    buffer_load_dwordx4 v123, s[44:47], s64 offen lds
    s_lshl_b32 s0, s0, 3
    s_add_u32 s68, s68, s0
    s_mul_i32 s0, s66, 28
    s_waitcnt lgkmcnt(0)
    v_mfma_f32_16x16x32_bf16 v[16:19], v[108:111], v[216:219], v[16:19]
    v_mfma_f32_16x16x32_bf16 v[20:23], v[108:111], v[220:223], v[20:23]
    s_waitcnt vmcnt(11)
    s_barrier
    ds_read_b128 v[224:227], v125 offset:16384
    ds_read_b128 v[228:231], v125 offset:18432
    ds_read_b64_tr_b16 v[96:97], v129 offset:8192
    ds_read_b64_tr_b16 v[98:99], v129 offset:8704
    s_add_u32 s1, s0, 27
    s_lshr_b32 s80, s0, 6
    s_lshr_b32 s81, s1, 6
    v_mfma_f32_16x16x32_bf16 v[32:35], v[112:115], v[216:219], v[32:35]
    v_mfma_f32_16x16x32_bf16 v[36:39], v[112:115], v[220:223], v[36:39]
    ds_read_b64_tr_b16 v[100:101], v130 offset:16384
    ds_read_b64_tr_b16 v[102:103], v130 offset:16896
    s_add_u32 m0, s57, 49152
    s_add_u32 s64, s56, 128
    buffer_load_dwordx4 v123, s[40:43], s64 offen lds
    s_sub_u32 s81, s81, s80
    v_and_b32 v5, 1, v0
    v_mul_u32_u24 v5, s81, v5
    v_mfma_f32_16x16x32_bf16 v[48:51], v[116:119], v[216:219], v[48:51]
    v_mfma_f32_16x16x32_bf16 v[52:55], v[116:119], v[220:223], v[52:55]
    ds_read_b64_tr_b16 v[104:105], v131 offset:16384
    ds_read_b64_tr_b16 v[106:107], v131 offset:16896
    s_add_u32 m0, s57, 53248
    s_add_u32 s64, s56, 114816
    buffer_load_dwordx4 v123, s[40:43], s64 offen lds
    v_bfe_u32 v6, v0, 1, 1
    v_mad_u32_u24 v5, v6, 7, v5
    v_bfe_u32 v6, v0, 2, 2
    v_mfma_f32_16x16x32_bf16 v[24:27], v[64:67], v[216:219], v[24:27]
    v_mfma_f32_16x16x32_bf16 v[28:31], v[64:67], v[220:223], v[28:31]
    ds_read_b64_tr_b16 v[108:109], v127 offset:8192
    ds_read_b64_tr_b16 v[110:111], v127 offset:8704
    v_lshl_add_u32 v5, v6, 4, v5
    s_lshl_b32 s81, s70, 6
    s_add_u32 s81, s81, s80
    v_mfma_f32_16x16x32_bf16 v[40:43], v[68:71], v[216:219], v[40:43]
    v_mfma_f32_16x16x32_bf16 v[44:47], v[68:71], v[220:223], v[44:47]
    ds_read_b64_tr_b16 v[112:113], v130 offset:24576
    ds_read_b64_tr_b16 v[114:115], v130 offset:25088
    s_add_u32 m0, s57, 57344
    s_add_u32 s64, s56, 128
    buffer_load_dwordx4 v123, s[44:47], s64 offen lds
    v_add_u32 v5, s81, v5
    s_lshl_b32 s81, s67, 4
    s_lshr_b32 s0, s66, 3
    v_mfma_f32_16x16x32_bf16 v[56:59], v[72:75], v[216:219], v[56:59]
    v_mfma_f32_16x16x32_bf16 v[60:63], v[72:75], v[220:223], v[60:63]
    ds_read_b64_tr_b16 v[116:117], v131 offset:24576
    ds_read_b64_tr_b16 v[118:119], v131 offset:25088
    s_add_u32 m0, s57, 61440
    s_add_u32 s64, s56, 114816
    buffer_load_dwordx4 v123, s[44:47], s64 offen lds
    s_add_u32 s0, s0, s81
    s_add_u32 s0, s0, 14
    v_writelane_b32 v5, s0, 16
    s_waitcnt lgkmcnt(6)
    v_mfma_f32_16x16x32_bf16 v[16:19], v[96:99], v[224:227], v[16:19]
    v_mfma_f32_16x16x32_bf16 v[20:23], v[96:99], v[228:231], v[20:23]
    ds_read_b128 v[232:235], v126 offset:16384
    ds_read_b128 v[236:239], v126 offset:18432
    ds_read_b64_tr_b16 v[64:65], v129 offset:12288
    ds_read_b64_tr_b16 v[66:67], v129 offset:12800
    v_lshlrev_b32 v5, 7, v5
    v_add_u32 v12, 15728640, v5
    v_mfma_f32_16x16x32_bf16 v[32:35], v[100:103], v[224:227], v[32:35]
    v_mfma_f32_16x16x32_bf16 v[36:39], v[100:103], v[228:231], v[36:39]
    ds_read_b64_tr_b16 v[68:69], v130 offset:20480
    ds_read_b64_tr_b16 v[70:71], v130 offset:20992
    s_add_u32 m0, s57, 147456
    s_add_u32 s64, s56, 229504
    buffer_load_dwordx4 v123, s[40:43], s64 offen lds
    v_lshrrev_b32 v5, 5, v0
    v_mul_u32_u24 v5, 6656, v5
    v_add_u32 v10, v5, v134
    v_mfma_f32_16x16x32_bf16 v[48:51], v[104:107], v[224:227], v[48:51]
    v_mfma_f32_16x16x32_bf16 v[52:55], v[104:107], v[228:231], v[52:55]
    ds_read_b64_tr_b16 v[72:73], v131 offset:20480
    ds_read_b64_tr_b16 v[74:75], v131 offset:20992
    s_add_u32 m0, s57, 151552
    s_add_u32 s64, s56, 344192
    buffer_load_dwordx4 v123, s[40:43], s64 offen lds
    s_mul_i32 s86, s66, 7
    s_lshr_b32 s86, s86, 1
    s_lshl_b32 s86, s86, 9
    s_waitcnt lgkmcnt(8)
    v_mfma_f32_16x16x32_bf16 v[24:27], v[108:111], v[224:227], v[24:27]
    v_mfma_f32_16x16x32_bf16 v[28:31], v[108:111], v[228:231], v[28:31]
    ds_read_b64_tr_b16 v[96:97], v127 offset:12288
    ds_read_b64_tr_b16 v[98:99], v127 offset:12800
    s_mul_i32 s1, s70, 458752
    s_add_u32 s0, s1, s86
    s_add_u32 s0, s0, 1835008
    v_mfma_f32_16x16x32_bf16 v[40:43], v[112:115], v[224:227], v[40:43]
    v_mfma_f32_16x16x32_bf16 v[44:47], v[112:115], v[228:231], v[44:47]
    ds_read_b64_tr_b16 v[100:101], v130 offset:28672
    ds_read_b64_tr_b16 v[102:103], v130 offset:29184
    s_add_u32 m0, s57, 155648
    s_add_u32 s64, s56, 229504
    buffer_load_dwordx4 v123, s[44:47], s64 offen lds
    s_add_u32 s72, s28, s0
    s_addc_u32 s73, s29, 0
    s_mov_b32 s74, 458752
    s_mov_b32 s75, 0x00020000
    v_mfma_f32_16x16x32_bf16 v[56:59], v[116:119], v[224:227], v[56:59]
    v_mfma_f32_16x16x32_bf16 v[60:63], v[116:119], v[228:231], v[60:63]
    ds_read_b64_tr_b16 v[104:105], v131 offset:28672
    ds_read_b64_tr_b16 v[106:107], v131 offset:29184
    s_add_u32 m0, s57, 159744
    s_add_u32 s64, s56, 344192
    buffer_load_dwordx4 v123, s[44:47], s64 offen lds
    s_mul_i32 s0, s66, 448
    s_add_u32 s0, s0, s1
    s_add_u32 s0, s0, 3670016
    s_lshl_b32 s18, s2, 3
    s_add_u32 s18, s18, s26
    s_lshl_b32 s19, s18, 7
    v_lshl_add_u32 v13, v0, 18, s19
    s_mov_b32 s4, s16
    s_mov_b32 s5, s17
    s_mov_b32 s6, 1605632
    s_mov_b32 s7, 0x00020000
    s_mov_b32 s12, s8
    s_mov_b32 s13, s9
    s_mov_b32 s14, 401408
    s_mov_b32 s15, 0x00020000
    s_mov_b64 exec, 0x7f
    buffer_load_dword v11, v13, s[4:7], 0 offen
    buffer_load_dword v11, v13, s[12:15], 0 offen
    s_mov_b64 exec, -1
    s_waitcnt lgkmcnt(0)
    v_mfma_f32_16x16x32_bf16 v[16:19], v[64:67], v[232:235], v[16:19]
    v_mfma_f32_16x16x32_bf16 v[20:23], v[64:67], v[236:239], v[20:23]
    s_waitcnt vmcnt(10)
    s_barrier
    s_mov_b32 s48, s22
    s_mov_b32 s49, s23
    s_mov_b32 s50, 256
    s_mov_b32 s51, 0x00020000
    s_cmp_lg_u32 s26, 0
    s_cbranch_scc1 gated_mix__mha_block__glu_gated_geglu__prompt_kernel_skip10
    s_and_b32 s3, s2, 3
    s_lshl_b32 s3, s3, 6
    v_mov_b32 v13, 1
    s_mov_b64 exec, 1
    buffer_atomic_add v13, off, s[48:51], s3 sc1
    s_mov_b64 exec, -1
gated_mix__mha_block__glu_gated_geglu__prompt_kernel_skip10:
    ds_read_b128 v[240:243], v125 offset:32768
    ds_read_b128 v[244:247], v125 offset:34816
    ds_read_b64_tr_b16 v[108:109], v129 offset:16384
    ds_read_b64_tr_b16 v[110:111], v129 offset:16896
    s_add_u32 s76, s28, s0
    s_addc_u32 s77, s29, 0
    s_mov_b32 s78, 458752
    s_mov_b32 s79, 0x00020000
    v_mfma_f32_16x16x32_bf16 v[32:35], v[68:71], v[232:235], v[32:35]
    v_mfma_f32_16x16x32_bf16 v[36:39], v[68:71], v[236:239], v[36:39]
    ds_read_b64_tr_b16 v[112:113], v130 offset:32768
    ds_read_b64_tr_b16 v[114:115], v130 offset:33280
    s_add_u32 m0, s57, 0
    s_add_u32 s64, s56, 458880
    buffer_load_dwordx4 v123, s[40:43], s64 offen lds
    s_lshl_b32 s1, s67, 2
    s_add_u32 s0, s70, 1
    s_and_b32 s0, s0, 3
    v_mfma_f32_16x16x32_bf16 v[48:51], v[72:75], v[232:235], v[48:51]
    v_mfma_f32_16x16x32_bf16 v[52:55], v[72:75], v[236:239], v[52:55]
    ds_read_b64_tr_b16 v[116:117], v131 offset:32768
    ds_read_b64_tr_b16 v[118:119], v131 offset:33280
    s_add_u32 m0, s57, 4096
    s_add_u32 s64, s56, 573568
    buffer_load_dwordx4 v123, s[40:43], s64 offen lds
    s_add_u32 s0, s0, s1
    s_mul_i32 s0, s0, 28672
    s_add_u32 s80, s0, s86
    v_mfma_f32_16x16x32_bf16 v[24:27], v[96:99], v[232:235], v[24:27]
    v_mfma_f32_16x16x32_bf16 v[28:31], v[96:99], v[236:239], v[28:31]
    ds_read_b64_tr_b16 v[64:65], v127 offset:16384
    ds_read_b64_tr_b16 v[66:67], v127 offset:16896
    s_add_u32 s0, s70, 2
    s_and_b32 s0, s0, 3
    v_mfma_f32_16x16x32_bf16 v[40:43], v[100:103], v[232:235], v[40:43]
    v_mfma_f32_16x16x32_bf16 v[44:47], v[100:103], v[236:239], v[44:47]
    ds_read_b64_tr_b16 v[68:69], v130 offset:40960
    ds_read_b64_tr_b16 v[70:71], v130 offset:41472
    s_add_u32 m0, s57, 8192
    s_add_u32 s64, s56, 458880
    buffer_load_dwordx4 v123, s[44:47], s64 offen lds
    s_add_u32 s0, s0, s1
    s_mul_i32 s0, s0, 28672
    s_add_u32 s81, s0, s86
    v_mfma_f32_16x16x32_bf16 v[56:59], v[104:107], v[232:235], v[56:59]
    v_mfma_f32_16x16x32_bf16 v[60:63], v[104:107], v[236:239], v[60:63]
    ds_read_b64_tr_b16 v[72:73], v131 offset:40960
    ds_read_b64_tr_b16 v[74:75], v131 offset:41472
    s_add_u32 m0, s57, 12288
    s_add_u32 s64, s56, 573568
    buffer_load_dwordx4 v123, s[44:47], s64 offen lds
    s_add_u32 s0, s70, 3
    s_and_b32 s0, s0, 3
    s_add_u32 s0, s0, s1
    s_waitcnt lgkmcnt(6)
    v_mfma_f32_16x16x32_bf16 v[16:19], v[108:111], v[240:243], v[16:19]
    v_mfma_f32_16x16x32_bf16 v[20:23], v[108:111], v[244:247], v[20:23]
    ds_read_b128 v[248:251], v126 offset:32768
    ds_read_b128 v[252:255], v126 offset:34816
    ds_read_b64_tr_b16 v[96:97], v129 offset:20480
    ds_read_b64_tr_b16 v[98:99], v129 offset:20992
    s_mul_i32 s0, s0, 28672
    s_add_u32 s82, s0, s86
    s_add_u32 s0, s70, 4
    v_mfma_f32_16x16x32_bf16 v[32:35], v[112:115], v[240:243], v[32:35]
    v_mfma_f32_16x16x32_bf16 v[36:39], v[112:115], v[244:247], v[36:39]
    ds_read_b64_tr_b16 v[100:101], v130 offset:36864
    ds_read_b64_tr_b16 v[102:103], v130 offset:37376
    s_add_u32 m0, s57, 98304
    s_add_u32 s64, s56, 688256
    buffer_load_dwordx4 v123, s[40:43], s64 offen lds
    s_and_b32 s0, s0, 3
    s_add_u32 s0, s0, s1
    s_mul_i32 s0, s0, 28672
    v_mfma_f32_16x16x32_bf16 v[48:51], v[116:119], v[240:243], v[48:51]
    v_mfma_f32_16x16x32_bf16 v[52:55], v[116:119], v[244:247], v[52:55]
    ds_read_b64_tr_b16 v[104:105], v131 offset:36864
    ds_read_b64_tr_b16 v[106:107], v131 offset:37376
    s_add_u32 m0, s57, 102400
    s_add_u32 s64, s56, 802944
    buffer_load_dwordx4 v123, s[40:43], s64 offen lds
    s_add_u32 s83, s0, s86
    s_add_u32 s0, s1, s70
    s_lshl_b32 s60, s0, 7
    s_waitcnt lgkmcnt(8)
    v_mfma_f32_16x16x32_bf16 v[24:27], v[64:67], v[240:243], v[24:27]
    v_mfma_f32_16x16x32_bf16 v[28:31], v[64:67], v[244:247], v[28:31]
    ds_read_b64_tr_b16 v[108:109], v127 offset:20480
    ds_read_b64_tr_b16 v[110:111], v127 offset:20992
    s_add_u32 s61, s60, 14942208
    s_lshl_b32 s0, s0, 4
    s_add_u32 s0, s0, s66
    v_mfma_f32_16x16x32_bf16 v[40:43], v[68:71], v[240:243], v[40:43]
    v_mfma_f32_16x16x32_bf16 v[44:47], v[68:71], v[244:247], v[44:47]
    ds_read_b64_tr_b16 v[112:113], v130 offset:45056
    ds_read_b64_tr_b16 v[114:115], v130 offset:45568
    s_add_u32 m0, s57, 106496
    s_add_u32 s64, s56, 688256
    buffer_load_dwordx4 v123, s[44:47], s64 offen lds
    s_lshl_b32 s86, s0, 11
    s_add_u32 s86, s86, 12845056
    s_lshl_b32 s87, s0, 7
    v_mfma_f32_16x16x32_bf16 v[56:59], v[72:75], v[240:243], v[56:59]
    v_mfma_f32_16x16x32_bf16 v[60:63], v[72:75], v[244:247], v[60:63]
    ds_read_b64_tr_b16 v[116:117], v131 offset:45056
    ds_read_b64_tr_b16 v[118:119], v131 offset:45568
    s_add_u32 m0, s57, 110592
    s_add_u32 s64, s56, 802944
    buffer_load_dwordx4 v123, s[44:47], s64 offen lds
    s_add_u32 s87, s87, 15761408
    s_mov_b32 s84, 0x0fffffff
    s_mov_b32 s85, 0x0fffffff
    s_waitcnt lgkmcnt(6)
    v_mfma_f32_16x16x32_bf16 v[16:19], v[96:99], v[248:251], v[16:19]
    v_mfma_f32_16x16x32_bf16 v[20:23], v[96:99], v[252:255], v[20:23]
    v_mfma_f32_16x16x32_bf16 v[32:35], v[100:103], v[248:251], v[32:35]
    v_mfma_f32_16x16x32_bf16 v[36:39], v[100:103], v[252:255], v[36:39]
    v_mfma_f32_16x16x32_bf16 v[48:51], v[104:107], v[248:251], v[48:51]
    v_mfma_f32_16x16x32_bf16 v[52:55], v[104:107], v[252:255], v[52:55]
    s_waitcnt lgkmcnt(0)
    v_mfma_f32_16x16x32_bf16 v[24:27], v[108:111], v[248:251], v[24:27]
    v_mfma_f32_16x16x32_bf16 v[28:31], v[108:111], v[252:255], v[28:31]
    s_waitcnt vmcnt(10)
    s_barrier
    ds_read_b64_tr_b16 v[96:97], v132 offset:49152
    ds_read_b64_tr_b16 v[98:99], v132 offset:49664
    v_mfma_f32_16x16x32_bf16 v[40:43], v[112:115], v[248:251], v[40:43]
    v_mfma_f32_16x16x32_bf16 v[44:47], v[112:115], v[252:255], v[44:47]
    ds_read_b64_tr_b16 v[100:101], v133 offset:49152
    ds_read_b64_tr_b16 v[102:103], v133 offset:49664
    v_mfma_f32_16x16x32_bf16 v[56:59], v[116:119], v[248:251], v[56:59]
    v_mfma_f32_16x16x32_bf16 v[60:63], v[116:119], v[252:255], v[60:63]
    s_waitcnt lgkmcnt(2)
    v_mfma_f32_16x16x32_bf16 v[64:67], v[96:99], v[144:147], 0
    v_mfma_f32_16x16x32_bf16 v[68:71], v[96:99], v[148:151], 0
    ds_read_b64_tr_b16 v[108:109], v132 offset:57344
    ds_read_b64_tr_b16 v[110:111], v132 offset:57856
    v_cvt_pk_bf16_f32 v136, v16, v17
    v_cvt_pk_bf16_f32 v137, v18, v19
    v_cvt_pk_bf16_f32 v138, v20, v21
    v_cvt_pk_bf16_f32 v139, v22, v23
    v_cvt_pk_bf16_f32 v140, v24, v25
    v_cvt_pk_bf16_f32 v141, v26, v27
    v_cvt_pk_bf16_f32 v142, v28, v29
    v_cvt_pk_bf16_f32 v143, v30, v31
    s_waitcnt lgkmcnt(2)
    v_mfma_f32_16x16x32_bf16 v[80:83], v[100:103], v[144:147], 0
    v_mfma_f32_16x16x32_bf16 v[84:87], v[100:103], v[148:151], 0
    ds_read_b64_tr_b16 v[112:113], v133 offset:57344
    ds_read_b64_tr_b16 v[114:115], v133 offset:57856
    s_add_u32 s59, s62, 0
    v_permlane16_swap_b32 v136, v138
    v_permlane16_swap_b32 v137, v139
    v_permlane16_swap_b32 v140, v142
    v_permlane16_swap_b32 v141, v143
    buffer_store_dwordx4 v[136:139], v134, s[28:31], s59 offen offset:0 sc1
    buffer_store_dwordx4 v[140:143], v134, s[28:31], s59 offen offset:1024 sc1
    s_waitcnt lgkmcnt(2)
    v_mfma_f32_16x16x32_bf16 v[72:75], v[108:111], v[144:147], 0
    v_mfma_f32_16x16x32_bf16 v[76:79], v[108:111], v[148:151], 0
    ds_read_b64_tr_b16 v[96:97], v132 offset:53248
    ds_read_b64_tr_b16 v[98:99], v132 offset:53760
    s_waitcnt lgkmcnt(2)
    v_mfma_f32_16x16x32_bf16 v[88:91], v[112:115], v[144:147], 0
    v_mfma_f32_16x16x32_bf16 v[92:95], v[112:115], v[148:151], 0
    ds_read_b64_tr_b16 v[100:101], v133 offset:53248
    ds_read_b64_tr_b16 v[102:103], v133 offset:53760
    s_waitcnt lgkmcnt(2)
    v_mfma_f32_16x16x32_bf16 v[64:67], v[96:99], v[152:155], v[64:67]
    v_mfma_f32_16x16x32_bf16 v[68:71], v[96:99], v[156:159], v[68:71]
    ds_read_b64_tr_b16 v[108:109], v132 offset:61440
    ds_read_b64_tr_b16 v[110:111], v132 offset:61952
    s_waitcnt lgkmcnt(2)
    v_mfma_f32_16x16x32_bf16 v[80:83], v[100:103], v[152:155], v[80:83]
    v_mfma_f32_16x16x32_bf16 v[84:87], v[100:103], v[156:159], v[84:87]
    ds_read_b64_tr_b16 v[112:113], v133 offset:61440
    ds_read_b64_tr_b16 v[114:115], v133 offset:61952
    s_waitcnt lgkmcnt(2)
    v_mfma_f32_16x16x32_bf16 v[72:75], v[108:111], v[152:155], v[72:75]
    v_mfma_f32_16x16x32_bf16 v[76:79], v[108:111], v[156:159], v[76:79]
    ds_read_b64_tr_b16 v[96:97], v130 offset:49152
    ds_read_b64_tr_b16 v[98:99], v130 offset:49664
    s_waitcnt lgkmcnt(2)
    v_mfma_f32_16x16x32_bf16 v[88:91], v[112:115], v[152:155], v[88:91]
    v_mfma_f32_16x16x32_bf16 v[92:95], v[112:115], v[156:159], v[92:95]
    ds_read_b64_tr_b16 v[100:101], v131 offset:49152
    ds_read_b64_tr_b16 v[102:103], v131 offset:49664
    v_mul_f32 v1, v32, v32
    v_mul_f32 v2, v33, v33
    v_mul_f32 v3, v34, v34
    v_mul_f32 v4, v35, v35
    v_add_u32 v144, 28672, v134
    v_add_u32 v145, 57344, v134
    v_add_u32 v146, 86016, v134
    v_add_u32 v147, 14336, v10
    v_add_u32 v148, 28672, v10
    v_add_u32 v149, 43008, v10
    s_waitcnt lgkmcnt(2)
    v_mfma_f32_16x16x32_bf16 v[64:67], v[96:99], v[160:163], v[64:67]
    v_mfma_f32_16x16x32_bf16 v[68:71], v[96:99], v[164:167], v[68:71]
    ds_read_b64_tr_b16 v[108:109], v130 offset:57344
    ds_read_b64_tr_b16 v[110:111], v130 offset:57856
    s_add_u32 m0, s57, 16384
    s_add_u32 s64, s56, 917632
    buffer_load_dwordx4 v123, s[40:43], s64 offen lds
    v_fmamk_f32 v1, v1, 0xbdd2d3e8, v15
    v_fmamk_f32 v2, v2, 0xbdd2d3e8, v15
    v_fmamk_f32 v3, v3, 0xbdd2d3e8, v15
    s_waitcnt lgkmcnt(2)
    v_mfma_f32_16x16x32_bf16 v[80:83], v[100:103], v[160:163], v[80:83]
    v_mfma_f32_16x16x32_bf16 v[84:87], v[100:103], v[164:167], v[84:87]
    ds_read_b64_tr_b16 v[112:113], v131 offset:57344
    ds_read_b64_tr_b16 v[114:115], v131 offset:57856
    s_add_u32 m0, s57, 20480
    s_add_u32 s64, s56, 1032320
    buffer_load_dwordx4 v123, s[40:43], s64 offen lds
    v_fmamk_f32 v4, v4, 0xbdd2d3e8, v15
    v_mul_f32 v1, v1, v32
    v_mul_f32 v2, v2, v33
    v_add_u32 v150, 57344, v10
    v_add_u32 v151, 71680, v10
    v_add_u32 v152, 86016, v10
    v_add_u32 v153, 100352, v10
    s_add_u32 s0, s70, 1
    s_and_b32 s0, s0, 3
    s_waitcnt lgkmcnt(2)
    v_mfma_f32_16x16x32_bf16 v[72:75], v[108:111], v[160:163], v[72:75]
    v_mfma_f32_16x16x32_bf16 v[76:79], v[108:111], v[164:167], v[76:79]
    ds_read_b64_tr_b16 v[96:97], v130 offset:53248
    ds_read_b64_tr_b16 v[98:99], v130 offset:53760
    s_add_u32 m0, s57, 24576
    s_add_u32 s64, s56, 917632
    buffer_load_dwordx4 v123, s[44:47], s64 offen lds
    v_mul_f32 v3, v3, v34
    v_mul_f32 v4, v4, v35
    v_exp_f32 v1, v1
    s_waitcnt lgkmcnt(2)
    v_mfma_f32_16x16x32_bf16 v[88:91], v[112:115], v[160:163], v[88:91]
    v_mfma_f32_16x16x32_bf16 v[92:95], v[112:115], v[164:167], v[92:95]
    ds_read_b64_tr_b16 v[100:101], v131 offset:53248
    ds_read_b64_tr_b16 v[102:103], v131 offset:53760
    s_add_u32 m0, s57, 28672
    s_add_u32 s64, s56, 1032320
    buffer_load_dwordx4 v123, s[44:47], s64 offen lds
    v_exp_f32 v2, v2
    v_exp_f32 v3, v3
    v_exp_f32 v4, v4
    s_mul_i32 s0, s0, 12288
    s_add_u32 s0, s0, 106496
    v_add_u32 v154, s0, v134
    s_add_u32 s0, s70, 2
    s_and_b32 s0, s0, 3
    s_mul_i32 s0, s0, 12288
    s_waitcnt lgkmcnt(2)
    v_mfma_f32_16x16x32_bf16 v[64:67], v[96:99], v[168:171], v[64:67]
    v_mfma_f32_16x16x32_bf16 v[68:71], v[96:99], v[172:175], v[68:71]
    ds_read_b64_tr_b16 v[108:109], v130 offset:61440
    ds_read_b64_tr_b16 v[110:111], v130 offset:61952
    s_add_u32 m0, s57, 114688
    s_add_u32 s64, s56, 1147008
    buffer_load_dwordx4 v123, s[40:43], s64 offen lds
    v_mul_f32 v40, v32, v40
    v_mul_f32 v41, v33, v41
    v_mul_f32 v42, v34, v42
    s_waitcnt lgkmcnt(2)
    v_mfma_f32_16x16x32_bf16 v[80:83], v[100:103], v[168:171], v[80:83]
    v_mfma_f32_16x16x32_bf16 v[84:87], v[100:103], v[172:175], v[84:87]
    ds_read_b64_tr_b16 v[112:113], v131 offset:61440
    ds_read_b64_tr_b16 v[114:115], v131 offset:61952
    s_add_u32 m0, s57, 118784
    s_add_u32 s64, s56, 1261696
    buffer_load_dwordx4 v123, s[40:43], s64 offen lds
    v_mul_f32 v43, v35, v43
    v_add_f32 v1, 1.0, v1
    v_add_f32 v2, 1.0, v2
    v_add_f32 v3, 1.0, v3
    s_waitcnt lgkmcnt(0)
    s_add_u32 s0, s0, 110592
    v_add_u32 v155, s0, v134
    s_add_u32 s0, s70, 3
    s_and_b32 s0, s0, 3
    s_mul_i32 s0, s0, 12288
    s_add_u32 s0, s0, 114688
    v_add_u32 v156, s0, v134
    v_mfma_f32_16x16x32_bf16 v[72:75], v[108:111], v[168:171], v[72:75]
    v_mfma_f32_16x16x32_bf16 v[76:79], v[108:111], v[172:175], v[76:79]
    s_waitcnt vmcnt(8)
    s_barrier
    ds_read_b64_tr_b16 v[96:97], v132 offset:0
    ds_read_b64_tr_b16 v[98:99], v132 offset:512
    s_add_u32 m0, s57, 122880
    s_add_u32 s64, s56, 1147008
    buffer_load_dwordx4 v123, s[44:47], s64 offen lds
    v_add_f32 v4, 1.0, v4
    v_rcp_f32 v1, v1
    v_rcp_f32 v2, v2
    v_mfma_f32_16x16x32_bf16 v[88:91], v[112:115], v[168:171], v[88:91]
    v_mfma_f32_16x16x32_bf16 v[92:95], v[112:115], v[172:175], v[92:95]
    ds_read_b64_tr_b16 v[100:101], v133 offset:0
    ds_read_b64_tr_b16 v[102:103], v133 offset:512
    s_add_u32 m0, s57, 126976
    s_add_u32 s64, s56, 1261696
    buffer_load_dwordx4 v123, s[44:47], s64 offen lds
    v_rcp_f32 v3, v3
    v_rcp_f32 v4, v4
    v_mul_f32 v40, v40, v1
    s_lshl_b32 s3, s26, 9
    s_add_u32 s3, s3, 155648
    v_lshl_add_u32 v8, v0, 3, s3
    v_mov_b64 v[6:7], 0
    ds_write_b64 v8, v[6:7]
    ds_write_b64 v8, v[6:7] offset:4096
    s_add_u32 s0, s70, 4
    s_and_b32 s0, s0, 3
    s_mul_i32 s0, s0, 12288
    s_add_u32 s0, s0, 106496
    v_add_u32 v157, s0, v134
    s_lshl_b32 s0, s70, 8
    s_waitcnt lgkmcnt(4)
    v_mfma_f32_16x16x32_bf16 v[64:67], v[96:99], v[176:179], v[64:67]
    v_mfma_f32_16x16x32_bf16 v[68:71], v[96:99], v[180:183], v[68:71]
    ds_read_b64_tr_b16 v[108:109], v132 offset:8192
    ds_read_b64_tr_b16 v[110:111], v132 offset:8704
    s_add_u32 m0, s57, 32768
    s_add_u32 s64, s56, 1376384
    buffer_load_dwordx4 v123, s[40:43], s64 offen lds
    v_mul_f32 v41, v41, v2
    v_mul_f32 v42, v42, v3
    v_mul_f32 v43, v43, v4
    s_waitcnt lgkmcnt(4)
    v_mfma_f32_16x16x32_bf16 v[80:83], v[100:103], v[176:179], v[80:83]
    v_mfma_f32_16x16x32_bf16 v[84:87], v[100:103], v[180:183], v[84:87]
    ds_read_b64_tr_b16 v[112:113], v133 offset:8192
    ds_read_b64_tr_b16 v[114:115], v133 offset:8704
    s_add_u32 m0, s57, 36864
    s_add_u32 s64, s56, 1491072
    buffer_load_dwordx4 v123, s[40:43], s64 offen lds
    v_cvt_pk_bf16_f32 v136, v40, v41
    v_cvt_pk_bf16_f32 v137, v42, v43
    v_mul_f32 v1, v36, v36
    s_add_u32 s0, s0, 157696
    v_lshl_add_u32 v158, v0, 2, s0
    v_and_b32 v159, 3, v0
    v_lshlrev_b32 v159, 8, v159
    v_add_u32 v159, 157696, v159
    s_and_b32 s0, s66, 1
    s_waitcnt lgkmcnt(2)
    v_mfma_f32_16x16x32_bf16 v[72:75], v[108:111], v[176:179], v[72:75]
    v_mfma_f32_16x16x32_bf16 v[76:79], v[108:111], v[180:183], v[76:79]
    s_waitcnt vmcnt(10)
    s_barrier
    s_cmp_lg_u32 s26, 0
    s_cbranch_scc1 gated_mix__mha_block__glu_gated_geglu__prompt_kernel_skip11
    v_mov_b32 v5, 1
    s_mov_b64 exec, 1
    buffer_store_dword v5, off, s[28:31], s27 sc1
    s_mov_b64 exec, -1
gated_mix__mha_block__glu_gated_geglu__prompt_kernel_skip11:
    ds_read_b64_tr_b16 v[96:97], v132 offset:4096
    ds_read_b64_tr_b16 v[98:99], v132 offset:4608
    s_add_u32 m0, s57, 40960
    s_add_u32 s64, s56, 1376384
    buffer_load_dwordx4 v123, s[44:47], s64 offen lds
    v_mul_f32 v2, v37, v37
    v_mul_f32 v3, v38, v38
    v_mul_f32 v4, v39, v39
    v_fmamk_f32 v1, v1, 0xbdd2d3e8, v15
    s_waitcnt lgkmcnt(2)
    v_mfma_f32_16x16x32_bf16 v[88:91], v[112:115], v[176:179], v[88:91]
    v_mfma_f32_16x16x32_bf16 v[92:95], v[112:115], v[180:183], v[92:95]
    ds_read_b64_tr_b16 v[100:101], v133 offset:4096
    ds_read_b64_tr_b16 v[102:103], v133 offset:4608
    s_add_u32 m0, s57, 45056
    s_add_u32 s64, s56, 1491072
    buffer_load_dwordx4 v123, s[44:47], s64 offen lds
    v_fmamk_f32 v2, v2, 0xbdd2d3e8, v15
    v_fmamk_f32 v3, v3, 0xbdd2d3e8, v15
    v_fmamk_f32 v4, v4, 0xbdd2d3e8, v15
    v_lshrrev_b32 v120, 5, v0
    v_or_b32 v121, s0, v120
    v_xor_b32 v121, s0, v121
    v_add_u32 v121, -1, v121
    v_xor_b32 v120, 1, v120
    v_and_b32 v120, s0, v120
    s_waitcnt lgkmcnt(2)
    v_mfma_f32_16x16x32_bf16 v[64:67], v[96:99], v[184:187], v[64:67]
    v_mfma_f32_16x16x32_bf16 v[68:71], v[96:99], v[188:191], v[68:71]
    ds_read_b64_tr_b16 v[108:109], v132 offset:12288
    ds_read_b64_tr_b16 v[110:111], v132 offset:12800
    v_mul_f32 v1, v1, v36
    v_mul_f32 v2, v2, v37
    v_mul_f32 v3, v3, v38
    s_waitcnt lgkmcnt(2)
    v_mfma_f32_16x16x32_bf16 v[80:83], v[100:103], v[184:187], v[80:83]
    v_mfma_f32_16x16x32_bf16 v[84:87], v[100:103], v[188:191], v[84:87]
    ds_read_b64_tr_b16 v[112:113], v133 offset:12288
    ds_read_b64_tr_b16 v[114:115], v133 offset:12800
    v_mul_f32 v4, v4, v39
    v_exp_f32 v1, v1
    v_exp_f32 v2, v2
    v_add_u32 v120, -1, v120
    v_and_b32 v122, 31, v0
    v_lshlrev_b32 v122, 2, v122
    v_and_b32 v13, 31, v0
    v_cmp_eq_u32 s[0:1], 28, v13
    v_mov_b32 v13, 0x3f803f80
    s_nop 0
    v_cndmask_b32 v13, 0, v13, s[0:1]
    s_waitcnt lgkmcnt(2)
    v_mfma_f32_16x16x32_bf16 v[72:75], v[108:111], v[184:187], v[72:75]
    v_mfma_f32_16x16x32_bf16 v[76:79], v[108:111], v[188:191], v[76:79]
    ds_read_b64_tr_b16 v[96:97], v130 offset:0
    ds_read_b64_tr_b16 v[98:99], v130 offset:512
    v_exp_f32 v3, v3
    v_exp_f32 v4, v4
    v_mul_f32 v44, v36, v44
    s_waitcnt lgkmcnt(2)
    v_mfma_f32_16x16x32_bf16 v[88:91], v[112:115], v[184:187], v[88:91]
    v_mfma_f32_16x16x32_bf16 v[92:95], v[112:115], v[188:191], v[92:95]
    ds_read_b64_tr_b16 v[100:101], v131 offset:0
    ds_read_b64_tr_b16 v[102:103], v131 offset:512
    v_mul_f32 v45, v37, v45
    v_mul_f32 v46, v38, v46
    v_mul_f32 v47, v39, v47
    v_mov_b32 v160, v13
    v_mov_b32 v161, v13
    s_waitcnt lgkmcnt(2)
    v_mfma_f32_16x16x32_bf16 v[64:67], v[96:99], v[192:195], v[64:67]
    v_mfma_f32_16x16x32_bf16 v[68:71], v[96:99], v[196:199], v[68:71]
    ds_read_b64_tr_b16 v[108:109], v130 offset:8192
    ds_read_b64_tr_b16 v[110:111], v130 offset:8704
    v_add_f32 v1, 1.0, v1
    v_add_f32 v2, 1.0, v2
    v_add_f32 v3, 1.0, v3
    v_add_f32 v4, 1.0, v4
    s_waitcnt lgkmcnt(2)
    v_mfma_f32_16x16x32_bf16 v[80:83], v[100:103], v[192:195], v[80:83]
    v_mfma_f32_16x16x32_bf16 v[84:87], v[100:103], v[196:199], v[84:87]
    ds_read_b64_tr_b16 v[112:113], v131 offset:8192
    ds_read_b64_tr_b16 v[114:115], v131 offset:8704
    v_rcp_f32 v1, v1
    v_rcp_f32 v2, v2
    v_rcp_f32 v3, v3
    v_mov_b32 v162, v13
    v_mov_b32 v163, v13
    s_waitcnt lgkmcnt(2)
    v_mfma_f32_16x16x32_bf16 v[72:75], v[108:111], v[192:195], v[72:75]
    v_mfma_f32_16x16x32_bf16 v[76:79], v[108:111], v[196:199], v[76:79]
    ds_read_b64_tr_b16 v[96:97], v130 offset:4096
    ds_read_b64_tr_b16 v[98:99], v130 offset:4608
    v_rcp_f32 v4, v4
    v_mul_f32 v44, v44, v1
    v_mul_f32 v45, v45, v2
    s_waitcnt lgkmcnt(2)
    v_mfma_f32_16x16x32_bf16 v[88:91], v[112:115], v[192:195], v[88:91]
    v_mfma_f32_16x16x32_bf16 v[92:95], v[112:115], v[196:199], v[92:95]
    ds_read_b64_tr_b16 v[100:101], v131 offset:4096
    ds_read_b64_tr_b16 v[102:103], v131 offset:4608
    v_mul_f32 v46, v46, v3
    v_mul_f32 v47, v47, v4
    v_cvt_pk_bf16_f32 v138, v44, v45
    v_and_b32 v8, 3, v0
    v_lshlrev_b32 v8, 6, v8
    buffer_load_dword v7, v8, s[48:51], 0 offen sc1
    v_mov_b32 v164, v13
    v_mov_b32 v165, v13
    s_waitcnt lgkmcnt(2)
    v_mfma_f32_16x16x32_bf16 v[64:67], v[96:99], v[200:203], v[64:67]
    v_mfma_f32_16x16x32_bf16 v[68:71], v[96:99], v[204:207], v[68:71]
    ds_read_b64_tr_b16 v[108:109], v130 offset:12288
    ds_read_b64_tr_b16 v[110:111], v130 offset:12800
    v_cvt_pk_bf16_f32 v139, v46, v47
    s_add_u32 s59, s63, 0
    v_permlane16_swap_b32 v136, v138
    s_waitcnt lgkmcnt(2)
    v_mfma_f32_16x16x32_bf16 v[80:83], v[100:103], v[200:203], v[80:83]
    v_mfma_f32_16x16x32_bf16 v[84:87], v[100:103], v[204:207], v[84:87]
    ds_read_b64_tr_b16 v[112:113], v131 offset:12288
    ds_read_b64_tr_b16 v[114:115], v131 offset:12800
    v_permlane16_swap_b32 v137, v139
    buffer_store_dwordx4 v[136:139], v134, s[28:31], s59 offen sc1
    v_mul_f32 v1, v48, v48
    v_mul_f32 v2, v49, v49
    s_waitcnt lgkmcnt(0)
    v_mov_b32 v166, v13
    v_mov_b32 v167, v13
    v_mfma_f32_16x16x32_bf16 v[72:75], v[108:111], v[200:203], v[72:75]
    v_mfma_f32_16x16x32_bf16 v[76:79], v[108:111], v[204:207], v[76:79]
    s_waitcnt vmcnt(2)
    s_barrier
    ds_read_b64_tr_b16 v[96:97], v132 offset:16384
    ds_read_b64_tr_b16 v[98:99], v132 offset:16896
    v_mul_f32 v3, v50, v50
    v_mul_f32 v4, v51, v51
    v_fmamk_f32 v1, v1, 0xbdd2d3e8, v15
    v_mfma_f32_16x16x32_bf16 v[88:91], v[112:115], v[200:203], v[88:91]
    v_mfma_f32_16x16x32_bf16 v[92:95], v[112:115], v[204:207], v[92:95]
    ds_read_b64_tr_b16 v[100:101], v133 offset:16384
    ds_read_b64_tr_b16 v[102:103], v133 offset:16896
    v_fmamk_f32 v2, v2, 0xbdd2d3e8, v15
    v_fmamk_f32 v3, v3, 0xbdd2d3e8, v15
    v_fmamk_f32 v4, v4, 0xbdd2d3e8, v15
    v_mov_b32 v168, v13
    v_mov_b32 v169, v13
    s_waitcnt lgkmcnt(2)
    v_mfma_f32_16x16x32_bf16 v[64:67], v[96:99], v[208:211], v[64:67]
    v_mfma_f32_16x16x32_bf16 v[68:71], v[96:99], v[212:215], v[68:71]
    ds_read_b64_tr_b16 v[108:109], v132 offset:24576
    ds_read_b64_tr_b16 v[110:111], v132 offset:25088
    v_mul_f32 v1, v1, v48
    v_mul_f32 v2, v2, v49
    v_mul_f32 v3, v3, v50
    s_waitcnt lgkmcnt(2)
    v_mfma_f32_16x16x32_bf16 v[80:83], v[100:103], v[208:211], v[80:83]
    v_mfma_f32_16x16x32_bf16 v[84:87], v[100:103], v[212:215], v[84:87]
    ds_read_b64_tr_b16 v[112:113], v133 offset:24576
    ds_read_b64_tr_b16 v[114:115], v133 offset:25088
    v_mul_f32 v4, v4, v51
    v_exp_f32 v1, v1
    v_exp_f32 v2, v2
    v_mov_b32 v170, v13
    v_mov_b32 v171, v13
    s_waitcnt lgkmcnt(2)
    v_mfma_f32_16x16x32_bf16 v[72:75], v[108:111], v[208:211], v[72:75]
    v_mfma_f32_16x16x32_bf16 v[76:79], v[108:111], v[212:215], v[76:79]
    ds_read_b64_tr_b16 v[96:97], v132 offset:20480
    ds_read_b64_tr_b16 v[98:99], v132 offset:20992
    v_exp_f32 v3, v3
    v_exp_f32 v4, v4
    v_mul_f32 v56, v48, v56
    s_waitcnt lgkmcnt(2)
    v_mfma_f32_16x16x32_bf16 v[88:91], v[112:115], v[208:211], v[88:91]
    v_mfma_f32_16x16x32_bf16 v[92:95], v[112:115], v[212:215], v[92:95]
    ds_read_b64_tr_b16 v[100:101], v133 offset:20480
    ds_read_b64_tr_b16 v[102:103], v133 offset:20992
    v_mul_f32 v57, v49, v57
    v_mul_f32 v58, v50, v58
    v_mul_f32 v59, v51, v59
    v_add_f32 v1, 1.0, v1
    v_mov_b32 v172, v13
    v_mov_b32 v173, v13
    s_waitcnt lgkmcnt(2)
    v_mfma_f32_16x16x32_bf16 v[64:67], v[96:99], v[216:219], v[64:67]
    v_mfma_f32_16x16x32_bf16 v[68:71], v[96:99], v[220:223], v[68:71]
    ds_read_b64_tr_b16 v[108:109], v132 offset:28672
    ds_read_b64_tr_b16 v[110:111], v132 offset:29184
    v_add_f32 v2, 1.0, v2
    v_add_f32 v3, 1.0, v3
    v_add_f32 v4, 1.0, v4
    s_waitcnt lgkmcnt(2)
    v_mfma_f32_16x16x32_bf16 v[80:83], v[100:103], v[216:219], v[80:83]
    v_mfma_f32_16x16x32_bf16 v[84:87], v[100:103], v[220:223], v[84:87]
    ds_read_b64_tr_b16 v[112:113], v133 offset:28672
    ds_read_b64_tr_b16 v[114:115], v133 offset:29184
    v_rcp_f32 v1, v1
    v_rcp_f32 v2, v2
    v_rcp_f32 v3, v3
    v_mov_b32 v174, v13
    v_mov_b32 v175, v13
    s_waitcnt lgkmcnt(2)
    v_mfma_f32_16x16x32_bf16 v[72:75], v[108:111], v[216:219], v[72:75]
    v_mfma_f32_16x16x32_bf16 v[76:79], v[108:111], v[220:223], v[76:79]
    ds_read_b64_tr_b16 v[96:97], v130 offset:16384
    ds_read_b64_tr_b16 v[98:99], v130 offset:16896
    v_rcp_f32 v4, v4
    v_mul_f32 v56, v56, v1
    v_mul_f32 v57, v57, v2
    s_waitcnt lgkmcnt(2)
    v_mfma_f32_16x16x32_bf16 v[88:91], v[112:115], v[216:219], v[88:91]
    v_mfma_f32_16x16x32_bf16 v[92:95], v[112:115], v[220:223], v[92:95]
    ds_read_b64_tr_b16 v[100:101], v131 offset:16384
    ds_read_b64_tr_b16 v[102:103], v131 offset:16896
    v_mul_f32 v58, v58, v3
    v_mul_f32 v59, v59, v4
    v_cvt_pk_bf16_f32 v140, v56, v57
    v_mov_b32 v176, v13
    v_mov_b32 v177, v13
    s_waitcnt lgkmcnt(2)
    v_mfma_f32_16x16x32_bf16 v[64:67], v[96:99], v[224:227], v[64:67]
    v_mfma_f32_16x16x32_bf16 v[68:71], v[96:99], v[228:231], v[68:71]
    ds_read_b64_tr_b16 v[108:109], v130 offset:24576
    ds_read_b64_tr_b16 v[110:111], v130 offset:25088
    v_cvt_pk_bf16_f32 v141, v58, v59
    v_mul_f32 v1, v52, v52
    v_mul_f32 v2, v53, v53
    v_mul_f32 v3, v54, v54
    s_waitcnt lgkmcnt(2)
    v_mfma_f32_16x16x32_bf16 v[80:83], v[100:103], v[224:227], v[80:83]
    v_mfma_f32_16x16x32_bf16 v[84:87], v[100:103], v[228:231], v[84:87]
    ds_read_b64_tr_b16 v[112:113], v131 offset:24576
    ds_read_b64_tr_b16 v[114:115], v131 offset:25088
    v_mul_f32 v4, v55, v55
    v_fmamk_f32 v1, v1, 0xbdd2d3e8, v15
    v_fmamk_f32 v2, v2, 0xbdd2d3e8, v15
    v_mov_b32 v178, v13
    v_mov_b32 v179, v13
    s_waitcnt lgkmcnt(2)
    v_mfma_f32_16x16x32_bf16 v[72:75], v[108:111], v[224:227], v[72:75]
    v_mfma_f32_16x16x32_bf16 v[76:79], v[108:111], v[228:231], v[76:79]
    ds_read_b64_tr_b16 v[96:97], v130 offset:20480
    ds_read_b64_tr_b16 v[98:99], v130 offset:20992
    v_fmamk_f32 v3, v3, 0xbdd2d3e8, v15
    v_fmamk_f32 v4, v4, 0xbdd2d3e8, v15
    v_mul_f32 v1, v1, v52
    s_waitcnt lgkmcnt(2)
    v_mfma_f32_16x16x32_bf16 v[88:91], v[112:115], v[224:227], v[88:91]
    v_mfma_f32_16x16x32_bf16 v[92:95], v[112:115], v[228:231], v[92:95]
    ds_read_b64_tr_b16 v[100:101], v131 offset:20480
    ds_read_b64_tr_b16 v[102:103], v131 offset:20992
    v_mul_f32 v2, v2, v53
    v_mul_f32 v3, v3, v54
    v_mul_f32 v4, v4, v55
    v_mov_b32 v180, v13
    v_mov_b32 v181, v13
    s_waitcnt lgkmcnt(2)
    v_mfma_f32_16x16x32_bf16 v[64:67], v[96:99], v[232:235], v[64:67]
    v_mfma_f32_16x16x32_bf16 v[68:71], v[96:99], v[236:239], v[68:71]
    ds_read_b64_tr_b16 v[108:109], v130 offset:28672
    ds_read_b64_tr_b16 v[110:111], v130 offset:29184
    v_exp_f32 v1, v1
    v_exp_f32 v2, v2
    v_exp_f32 v3, v3
    s_waitcnt lgkmcnt(2)
    v_mfma_f32_16x16x32_bf16 v[80:83], v[100:103], v[232:235], v[80:83]
    v_mfma_f32_16x16x32_bf16 v[84:87], v[100:103], v[236:239], v[84:87]
    ds_read_b64_tr_b16 v[112:113], v131 offset:28672
    ds_read_b64_tr_b16 v[114:115], v131 offset:29184
    v_exp_f32 v4, v4
    v_mul_f32 v60, v52, v60
    v_mul_f32 v61, v53, v61
    v_mov_b32 v182, v13
    v_mov_b32 v183, v13
    s_waitcnt lgkmcnt(2)
    v_mfma_f32_16x16x32_bf16 v[72:75], v[108:111], v[232:235], v[72:75]
    v_mfma_f32_16x16x32_bf16 v[76:79], v[108:111], v[236:239], v[76:79]
    ds_read_b64_tr_b16 v[96:97], v132 offset:32768
    ds_read_b64_tr_b16 v[98:99], v132 offset:33280
    v_mul_f32 v62, v54, v62
    v_mul_f32 v63, v55, v63
    v_add_f32 v1, 1.0, v1
    v_add_f32 v2, 1.0, v2
    s_waitcnt lgkmcnt(2)
    v_mfma_f32_16x16x32_bf16 v[88:91], v[112:115], v[232:235], v[88:91]
    v_mfma_f32_16x16x32_bf16 v[92:95], v[112:115], v[236:239], v[92:95]
    ds_read_b64_tr_b16 v[100:101], v133 offset:32768
    ds_read_b64_tr_b16 v[102:103], v133 offset:33280
    v_add_f32 v3, 1.0, v3
    v_add_f32 v4, 1.0, v4
    v_rcp_f32 v1, v1
    s_waitcnt vmcnt(1)
    v_cmp_gt_u32 vcc, 64, v7
    s_nop 0
    s_cbranch_vccz gated_mix__mha_block__glu_gated_geglu__prompt_kernel_ok12
    s_mov_b32 s3, 131072
gated_mix__mha_block__glu_gated_geglu__prompt_kernel_again13:
    buffer_load_dword v7, v8, s[48:51], 0 offen sc1
    s_waitcnt vmcnt(0)
    v_cmp_gt_u32 vcc, 64, v7
    s_nop 0
    s_cbranch_vccz gated_mix__mha_block__glu_gated_geglu__prompt_kernel_ok12
    s_sub_u32 s3, s3, 1
    s_cbranch_scc0 gated_mix__mha_block__glu_gated_geglu__prompt_kernel_again13
gated_mix__mha_block__glu_gated_geglu__prompt_kernel_ok12:
    v_mov_b32 v184, v13
    v_mov_b32 v185, v13
    s_waitcnt lgkmcnt(2)
    v_mfma_f32_16x16x32_bf16 v[64:67], v[96:99], v[240:243], v[64:67]
    v_mfma_f32_16x16x32_bf16 v[68:71], v[96:99], v[244:247], v[68:71]
    ds_read_b64_tr_b16 v[108:109], v132 offset:40960
    ds_read_b64_tr_b16 v[110:111], v132 offset:41472
    v_rcp_f32 v2, v2
    v_rcp_f32 v3, v3
    v_rcp_f32 v4, v4
    s_waitcnt lgkmcnt(2)
    v_mfma_f32_16x16x32_bf16 v[80:83], v[100:103], v[240:243], v[80:83]
    v_mfma_f32_16x16x32_bf16 v[84:87], v[100:103], v[244:247], v[84:87]
    ds_read_b64_tr_b16 v[112:113], v133 offset:40960
    ds_read_b64_tr_b16 v[114:115], v133 offset:41472
    v_mul_f32 v60, v60, v1
    v_mul_f32 v61, v61, v2
    v_mul_f32 v62, v62, v3
    v_mov_b32 v186, v13
    v_mov_b32 v187, v13
    s_mov_b64 exec, 0x1ffff
    buffer_load_dword v6, v12, s[28:31], 0 offen sc1
    s_mov_b64 exec, -1
    s_waitcnt lgkmcnt(2)
    v_mfma_f32_16x16x32_bf16 v[72:75], v[108:111], v[240:243], v[72:75]
    v_mfma_f32_16x16x32_bf16 v[76:79], v[108:111], v[244:247], v[76:79]
    ds_read_b64_tr_b16 v[96:97], v132 offset:36864
    ds_read_b64_tr_b16 v[98:99], v132 offset:37376
    v_mul_f32 v63, v63, v4
    v_cvt_pk_bf16_f32 v142, v60, v61
    v_cvt_pk_bf16_f32 v143, v62, v63
    s_waitcnt lgkmcnt(2)
    v_mfma_f32_16x16x32_bf16 v[88:91], v[112:115], v[240:243], v[88:91]
    v_mfma_f32_16x16x32_bf16 v[92:95], v[112:115], v[244:247], v[92:95]
    ds_read_b64_tr_b16 v[100:101], v133 offset:36864
    ds_read_b64_tr_b16 v[102:103], v133 offset:37376
    s_add_u32 s59, s63, 1024
    v_permlane16_swap_b32 v140, v142
    v_permlane16_swap_b32 v141, v143
    buffer_store_dwordx4 v[140:143], v134, s[28:31], s59 offen sc1
    v_mov_b32 v188, v13
    v_mov_b32 v189, v13
    s_waitcnt lgkmcnt(2)
    v_mfma_f32_16x16x32_bf16 v[64:67], v[96:99], v[248:251], v[64:67]
    v_mfma_f32_16x16x32_bf16 v[68:71], v[96:99], v[252:255], v[68:71]
    ds_read_b64_tr_b16 v[108:109], v132 offset:45056
    ds_read_b64_tr_b16 v[110:111], v132 offset:45568
    s_waitcnt lgkmcnt(2)
    v_mfma_f32_16x16x32_bf16 v[80:83], v[100:103], v[248:251], v[80:83]
    v_mfma_f32_16x16x32_bf16 v[84:87], v[100:103], v[252:255], v[84:87]
    ds_read_b64_tr_b16 v[112:113], v133 offset:45056
    ds_read_b64_tr_b16 v[114:115], v133 offset:45568
    s_waitcnt lgkmcnt(0)
    v_mov_b32 v190, v13
    v_mov_b32 v191, v13
    v_mfma_f32_16x16x32_bf16 v[72:75], v[108:111], v[248:251], v[72:75]
    v_mfma_f32_16x16x32_bf16 v[76:79], v[108:111], v[252:255], v[76:79]
    s_barrier
    v_mfma_f32_16x16x32_bf16 v[88:91], v[112:115], v[248:251], v[88:91]
    v_mfma_f32_16x16x32_bf16 v[92:95], v[112:115], v[252:255], v[92:95]
    s_waitcnt vmcnt(1)
    s_branch gated_mix__mha_block__glu_gated_geglu__prompt_kernel_a_e2
gated_mix__mha_block__glu_gated_geglu__prompt_kernel_K1_6:
    s_waitcnt lgkmcnt(10)
    v_mfma_f32_16x16x32_bf16 v[16:19], v[108:111], v[144:147], 0
    v_mfma_f32_16x16x32_bf16 v[20:23], v[108:111], v[148:151], 0
    ds_read_b128 v[152:155], v126 offset:0
    ds_read_b128 v[156:159], v126 offset:2048
    ds_read_b64_tr_b16 v[96:97], v129 offset:4096
    ds_read_b64_tr_b16 v[98:99], v129 offset:4608
    s_waitcnt lgkmcnt(12)
    v_mfma_f32_16x16x32_bf16 v[32:35], v[112:115], v[144:147], 0
    v_mfma_f32_16x16x32_bf16 v[36:39], v[112:115], v[148:151], 0
    ds_read_b64_tr_b16 v[100:101], v130 offset:4096
    ds_read_b64_tr_b16 v[102:103], v130 offset:4608
    s_waitcnt lgkmcnt(12)
    v_mfma_f32_16x16x32_bf16 v[48:51], v[116:119], v[144:147], 0
    v_mfma_f32_16x16x32_bf16 v[52:55], v[116:119], v[148:151], 0
    ds_read_b64_tr_b16 v[104:105], v131 offset:4096
    ds_read_b64_tr_b16 v[106:107], v131 offset:4608
    s_waitcnt lgkmcnt(12)
    v_mfma_f32_16x16x32_bf16 v[24:27], v[64:67], v[144:147], 0
    v_mfma_f32_16x16x32_bf16 v[28:31], v[64:67], v[148:151], 0
    ds_read_b64_tr_b16 v[108:109], v127 offset:4096
    ds_read_b64_tr_b16 v[110:111], v127 offset:4608
    s_waitcnt lgkmcnt(12)
    v_mfma_f32_16x16x32_bf16 v[40:43], v[68:71], v[144:147], 0
    v_mfma_f32_16x16x32_bf16 v[44:47], v[68:71], v[148:151], 0
    ds_read_b64_tr_b16 v[112:113], v130 offset:12288
    ds_read_b64_tr_b16 v[114:115], v130 offset:12800
    s_waitcnt lgkmcnt(12)
    v_mfma_f32_16x16x32_bf16 v[56:59], v[72:75], v[144:147], 0
    v_mfma_f32_16x16x32_bf16 v[60:63], v[72:75], v[148:151], 0
    ds_read_b64_tr_b16 v[116:117], v131 offset:12288
    ds_read_b64_tr_b16 v[118:119], v131 offset:12800
    s_waitcnt lgkmcnt(0)
    v_mfma_f32_16x16x32_bf16 v[16:19], v[96:99], v[152:155], v[16:19]
    v_mfma_f32_16x16x32_bf16 v[20:23], v[96:99], v[156:159], v[20:23]
    s_waitcnt vmcnt(6)
    s_barrier
    ds_read_b128 v[160:163], v125 offset:16384
    ds_read_b128 v[164:167], v125 offset:18432
    ds_read_b64_tr_b16 v[64:65], v129 offset:8192
    ds_read_b64_tr_b16 v[66:67], v129 offset:8704
    v_mfma_f32_16x16x32_bf16 v[32:35], v[100:103], v[152:155], v[32:35]
    v_mfma_f32_16x16x32_bf16 v[36:39], v[100:103], v[156:159], v[36:39]
    ds_read_b64_tr_b16 v[68:69], v130 offset:16384
    ds_read_b64_tr_b16 v[70:71], v130 offset:16896
    v_mfma_f32_16x16x32_bf16 v[48:51], v[104:107], v[152:155], v[48:51]
    v_mfma_f32_16x16x32_bf16 v[52:55], v[104:107], v[156:159], v[52:55]
    ds_read_b64_tr_b16 v[72:73], v131 offset:16384
    ds_read_b64_tr_b16 v[74:75], v131 offset:16896
    v_mfma_f32_16x16x32_bf16 v[24:27], v[108:111], v[152:155], v[24:27]
    v_mfma_f32_16x16x32_bf16 v[28:31], v[108:111], v[156:159], v[28:31]
    ds_read_b64_tr_b16 v[96:97], v127 offset:8192
    ds_read_b64_tr_b16 v[98:99], v127 offset:8704
    v_mfma_f32_16x16x32_bf16 v[40:43], v[112:115], v[152:155], v[40:43]
    v_mfma_f32_16x16x32_bf16 v[44:47], v[112:115], v[156:159], v[44:47]
    ds_read_b64_tr_b16 v[100:101], v130 offset:24576
    ds_read_b64_tr_b16 v[102:103], v130 offset:25088
    v_mfma_f32_16x16x32_bf16 v[56:59], v[116:119], v[152:155], v[56:59]
    v_mfma_f32_16x16x32_bf16 v[60:63], v[116:119], v[156:159], v[60:63]
    ds_read_b64_tr_b16 v[104:105], v131 offset:24576
    ds_read_b64_tr_b16 v[106:107], v131 offset:25088
    s_waitcnt lgkmcnt(6)
    v_mfma_f32_16x16x32_bf16 v[16:19], v[64:67], v[160:163], v[16:19]
    v_mfma_f32_16x16x32_bf16 v[20:23], v[64:67], v[164:167], v[20:23]
    ds_read_b128 v[168:171], v126 offset:16384
    ds_read_b128 v[172:175], v126 offset:18432
    ds_read_b64_tr_b16 v[108:109], v129 offset:12288
    ds_read_b64_tr_b16 v[110:111], v129 offset:12800
    v_mfma_f32_16x16x32_bf16 v[32:35], v[68:71], v[160:163], v[32:35]
    v_mfma_f32_16x16x32_bf16 v[36:39], v[68:71], v[164:167], v[36:39]
    ds_read_b64_tr_b16 v[112:113], v130 offset:20480
    ds_read_b64_tr_b16 v[114:115], v130 offset:20992
    v_mfma_f32_16x16x32_bf16 v[48:51], v[72:75], v[160:163], v[48:51]
    v_mfma_f32_16x16x32_bf16 v[52:55], v[72:75], v[164:167], v[52:55]
    ds_read_b64_tr_b16 v[116:117], v131 offset:20480
    ds_read_b64_tr_b16 v[118:119], v131 offset:20992
    s_waitcnt lgkmcnt(8)
    v_mfma_f32_16x16x32_bf16 v[24:27], v[96:99], v[160:163], v[24:27]
    v_mfma_f32_16x16x32_bf16 v[28:31], v[96:99], v[164:167], v[28:31]
    ds_read_b64_tr_b16 v[64:65], v127 offset:12288
    ds_read_b64_tr_b16 v[66:67], v127 offset:12800
    v_mfma_f32_16x16x32_bf16 v[40:43], v[100:103], v[160:163], v[40:43]
    v_mfma_f32_16x16x32_bf16 v[44:47], v[100:103], v[164:167], v[44:47]
    ds_read_b64_tr_b16 v[68:69], v130 offset:28672
    ds_read_b64_tr_b16 v[70:71], v130 offset:29184
    v_mfma_f32_16x16x32_bf16 v[56:59], v[104:107], v[160:163], v[56:59]
    v_mfma_f32_16x16x32_bf16 v[60:63], v[104:107], v[164:167], v[60:63]
    ds_read_b64_tr_b16 v[72:73], v131 offset:28672
    ds_read_b64_tr_b16 v[74:75], v131 offset:29184
    s_waitcnt lgkmcnt(0)
    v_mfma_f32_16x16x32_bf16 v[16:19], v[108:111], v[168:171], v[16:19]
    v_mfma_f32_16x16x32_bf16 v[20:23], v[108:111], v[172:175], v[20:23]
    s_barrier
    ds_read_b128 v[176:179], v125 offset:32768
    ds_read_b128 v[180:183], v125 offset:34816
    ds_read_b64_tr_b16 v[96:97], v129 offset:16384
    ds_read_b64_tr_b16 v[98:99], v129 offset:16896
    v_mfma_f32_16x16x32_bf16 v[32:35], v[112:115], v[168:171], v[32:35]
    v_mfma_f32_16x16x32_bf16 v[36:39], v[112:115], v[172:175], v[36:39]
    ds_read_b64_tr_b16 v[100:101], v130 offset:32768
    ds_read_b64_tr_b16 v[102:103], v130 offset:33280
    v_mfma_f32_16x16x32_bf16 v[48:51], v[116:119], v[168:171], v[48:51]
    v_mfma_f32_16x16x32_bf16 v[52:55], v[116:119], v[172:175], v[52:55]
    ds_read_b64_tr_b16 v[104:105], v131 offset:32768
    ds_read_b64_tr_b16 v[106:107], v131 offset:33280
    v_mfma_f32_16x16x32_bf16 v[24:27], v[64:67], v[168:171], v[24:27]
    v_mfma_f32_16x16x32_bf16 v[28:31], v[64:67], v[172:175], v[28:31]
    ds_read_b64_tr_b16 v[108:109], v127 offset:16384
    ds_read_b64_tr_b16 v[110:111], v127 offset:16896
    v_mfma_f32_16x16x32_bf16 v[40:43], v[68:71], v[168:171], v[40:43]
    v_mfma_f32_16x16x32_bf16 v[44:47], v[68:71], v[172:175], v[44:47]
    ds_read_b64_tr_b16 v[112:113], v130 offset:40960
    ds_read_b64_tr_b16 v[114:115], v130 offset:41472
    v_mfma_f32_16x16x32_bf16 v[56:59], v[72:75], v[168:171], v[56:59]
    v_mfma_f32_16x16x32_bf16 v[60:63], v[72:75], v[172:175], v[60:63]
    ds_read_b64_tr_b16 v[116:117], v131 offset:40960
    ds_read_b64_tr_b16 v[118:119], v131 offset:41472
    s_waitcnt lgkmcnt(6)
    v_mfma_f32_16x16x32_bf16 v[16:19], v[96:99], v[176:179], v[16:19]
    v_mfma_f32_16x16x32_bf16 v[20:23], v[96:99], v[180:183], v[20:23]
    ds_read_b128 v[184:187], v126 offset:32768
    ds_read_b128 v[188:191], v126 offset:34816
    ds_read_b64_tr_b16 v[64:65], v129 offset:20480
    ds_read_b64_tr_b16 v[66:67], v129 offset:20992
    v_mfma_f32_16x16x32_bf16 v[32:35], v[100:103], v[176:179], v[32:35]
    v_mfma_f32_16x16x32_bf16 v[36:39], v[100:103], v[180:183], v[36:39]
    ds_read_b64_tr_b16 v[68:69], v130 offset:36864
    ds_read_b64_tr_b16 v[70:71], v130 offset:37376
    v_mfma_f32_16x16x32_bf16 v[48:51], v[104:107], v[176:179], v[48:51]
    v_mfma_f32_16x16x32_bf16 v[52:55], v[104:107], v[180:183], v[52:55]
    ds_read_b64_tr_b16 v[72:73], v131 offset:36864
    ds_read_b64_tr_b16 v[74:75], v131 offset:37376
    s_waitcnt lgkmcnt(8)
    v_mfma_f32_16x16x32_bf16 v[24:27], v[108:111], v[176:179], v[24:27]
    v_mfma_f32_16x16x32_bf16 v[28:31], v[108:111], v[180:183], v[28:31]
    ds_read_b64_tr_b16 v[96:97], v127 offset:20480
    ds_read_b64_tr_b16 v[98:99], v127 offset:20992
    v_mov_b32 v1, 0
    v_mfma_f32_16x16x32_bf16 v[40:43], v[112:115], v[176:179], v[40:43]
    v_mfma_f32_16x16x32_bf16 v[44:47], v[112:115], v[180:183], v[44:47]
    ds_read_b64_tr_b16 v[100:101], v130 offset:45056
    ds_read_b64_tr_b16 v[102:103], v130 offset:45568
    s_waitcnt vmcnt(0)
    v_dot2_f32_bf16 v1, v136, v140, v1
    v_mfma_f32_16x16x32_bf16 v[56:59], v[116:119], v[176:179], v[56:59]
    v_mfma_f32_16x16x32_bf16 v[60:63], v[116:119], v[180:183], v[60:63]
    ds_read_b64_tr_b16 v[104:105], v131 offset:45056
    ds_read_b64_tr_b16 v[106:107], v131 offset:45568
    v_dot2_f32_bf16 v1, v137, v141, v1
    s_waitcnt lgkmcnt(0)
    v_mfma_f32_16x16x32_bf16 v[16:19], v[64:67], v[184:187], v[16:19]
    v_mfma_f32_16x16x32_bf16 v[20:23], v[64:67], v[188:191], v[20:23]
    s_barrier
    ds_read_b128 v[192:195], v125 offset:49152
    ds_read_b128 v[196:199], v125 offset:51200
    ds_read_b64_tr_b16 v[108:109], v129 offset:24576
    ds_read_b64_tr_b16 v[110:111], v129 offset:25088
    v_dot2_f32_bf16 v1, v138, v142, v1
    v_mfma_f32_16x16x32_bf16 v[32:35], v[68:71], v[184:187], v[32:35]
    v_mfma_f32_16x16x32_bf16 v[36:39], v[68:71], v[188:191], v[36:39]
    ds_read_b64_tr_b16 v[112:113], v130 offset:49152
    ds_read_b64_tr_b16 v[114:115], v130 offset:49664
    v_dot2_f32_bf16 v1, v139, v143, v1
    s_nop 2
    v_add_f32_dpp v1, v1, v1 row_shr:1 row_mask:0xf bank_mask:0xf
    v_mfma_f32_16x16x32_bf16 v[48:51], v[72:75], v[184:187], v[48:51]
    v_mfma_f32_16x16x32_bf16 v[52:55], v[72:75], v[188:191], v[52:55]
    ds_read_b64_tr_b16 v[116:117], v131 offset:49152
    ds_read_b64_tr_b16 v[118:119], v131 offset:49664
    v_add_f32_dpp v1, v1, v1 row_shr:2 row_mask:0xf bank_mask:0xf
    v_mfma_f32_16x16x32_bf16 v[24:27], v[96:99], v[184:187], v[24:27]
    v_mfma_f32_16x16x32_bf16 v[28:31], v[96:99], v[188:191], v[28:31]
    ds_read_b64_tr_b16 v[64:65], v127 offset:24576
    ds_read_b64_tr_b16 v[66:67], v127 offset:25088
    v_add_f32_dpp v1, v1, v1 row_shr:4 row_mask:0xf bank_mask:0xf
    v_mfma_f32_16x16x32_bf16 v[40:43], v[100:103], v[184:187], v[40:43]
    v_mfma_f32_16x16x32_bf16 v[44:47], v[100:103], v[188:191], v[44:47]
    ds_read_b64_tr_b16 v[68:69], v130 offset:57344
    ds_read_b64_tr_b16 v[70:71], v130 offset:57856
    v_add_f32_dpp v1, v1, v1 row_shr:8 row_mask:0xf bank_mask:0xf
    v_mfma_f32_16x16x32_bf16 v[56:59], v[104:107], v[184:187], v[56:59]
    v_mfma_f32_16x16x32_bf16 v[60:63], v[104:107], v[188:191], v[60:63]
    ds_read_b64_tr_b16 v[72:73], v131 offset:57344
    ds_read_b64_tr_b16 v[74:75], v131 offset:57856
    v_add_f32_dpp v1, v1, v1 row_bcast:15 row_mask:0xa bank_mask:0xf
    s_waitcnt lgkmcnt(6)
    v_mfma_f32_16x16x32_bf16 v[16:19], v[108:111], v[192:195], v[16:19]
    v_mfma_f32_16x16x32_bf16 v[20:23], v[108:111], v[196:199], v[20:23]
    ds_read_b128 v[200:203], v126 offset:49152
    ds_read_b128 v[204:207], v126 offset:51200
    ds_read_b64_tr_b16 v[96:97], v129 offset:28672
    ds_read_b64_tr_b16 v[98:99], v129 offset:29184
    v_add_f32_dpp v1, v1, v1 row_bcast:31 row_mask:0xc bank_mask:0xf
    v_mul_f32 v1, 0xbfb8aa3b, v1
    v_mfma_f32_16x16x32_bf16 v[32:35], v[112:115], v[192:195], v[32:35]
    v_mfma_f32_16x16x32_bf16 v[36:39], v[112:115], v[196:199], v[36:39]
    ds_read_b64_tr_b16 v[100:101], v130 offset:53248
    ds_read_b64_tr_b16 v[102:103], v130 offset:53760
    v_exp_f32 v1, v1
    v_mfma_f32_16x16x32_bf16 v[48:51], v[116:119], v[192:195], v[48:51]
    v_mfma_f32_16x16x32_bf16 v[52:55], v[116:119], v[196:199], v[52:55]
    ds_read_b64_tr_b16 v[104:105], v131 offset:53248
    ds_read_b64_tr_b16 v[106:107], v131 offset:53760
    s_lshl_b32 s3, s3, 2
    s_waitcnt lgkmcnt(8)
    v_mfma_f32_16x16x32_bf16 v[24:27], v[64:67], v[192:195], v[24:27]
    v_mfma_f32_16x16x32_bf16 v[28:31], v[64:67], v[196:199], v[28:31]
    ds_read_b64_tr_b16 v[108:109], v127 offset:28672
    ds_read_b64_tr_b16 v[110:111], v127 offset:29184
    v_add_f32 v1, 1.0, v1
    v_mfma_f32_16x16x32_bf16 v[40:43], v[68:71], v[192:195], v[40:43]
    v_mfma_f32_16x16x32_bf16 v[44:47], v[68:71], v[196:199], v[44:47]
    ds_read_b64_tr_b16 v[112:113], v130 offset:61440
    ds_read_b64_tr_b16 v[114:115], v130 offset:61952
    v_rcp_f32 v1, v1
    v_mfma_f32_16x16x32_bf16 v[56:59], v[72:75], v[192:195], v[56:59]
    v_mfma_f32_16x16x32_bf16 v[60:63], v[72:75], v[196:199], v[60:63]
    ds_read_b64_tr_b16 v[116:117], v131 offset:61440
    ds_read_b64_tr_b16 v[118:119], v131 offset:61952
    s_add_u32 s3, s3, 14942208
    s_mov_b32 exec_lo, 0
    s_mov_b32 exec_hi, 0x80000000
    buffer_store_dword v1, off, s[28:31], s3 sc1
    s_mov_b64 exec, -1
    s_waitcnt lgkmcnt(0)
    v_mfma_f32_16x16x32_bf16 v[16:19], v[96:99], v[200:203], v[16:19]
    v_mfma_f32_16x16x32_bf16 v[20:23], v[96:99], v[204:207], v[20:23]
    s_barrier
    ds_read_b128 v[208:211], v125 offset:0
    ds_read_b128 v[212:215], v125 offset:2048
    ds_read_b64_tr_b16 v[64:65], v129 offset:0
    ds_read_b64_tr_b16 v[66:67], v129 offset:512
    s_lshl_b32 s0, s52, 2
    v_mfma_f32_16x16x32_bf16 v[32:35], v[100:103], v[200:203], v[32:35]
    v_mfma_f32_16x16x32_bf16 v[36:39], v[100:103], v[204:207], v[36:39]
    ds_read_b64_tr_b16 v[68:69], v130 offset:0
    ds_read_b64_tr_b16 v[70:71], v130 offset:512
    s_add_u32 s0, s0, s60
    v_mfma_f32_16x16x32_bf16 v[48:51], v[104:107], v[200:203], v[48:51]
    v_mfma_f32_16x16x32_bf16 v[52:55], v[104:107], v[204:207], v[52:55]
    ds_read_b64_tr_b16 v[72:73], v131 offset:0
    ds_read_b64_tr_b16 v[74:75], v131 offset:512
    s_mul_i32 s62, s0, 28672
    v_mfma_f32_16x16x32_bf16 v[24:27], v[108:111], v[200:203], v[24:27]
    v_mfma_f32_16x16x32_bf16 v[28:31], v[108:111], v[204:207], v[28:31]
    ds_read_b64_tr_b16 v[96:97], v127 offset:0
    ds_read_b64_tr_b16 v[98:99], v127 offset:512
    s_mul_i32 s63, s0, 114688
    v_mfma_f32_16x16x32_bf16 v[40:43], v[112:115], v[200:203], v[40:43]
    v_mfma_f32_16x16x32_bf16 v[44:47], v[112:115], v[204:207], v[44:47]
    ds_read_b64_tr_b16 v[100:101], v130 offset:8192
    ds_read_b64_tr_b16 v[102:103], v130 offset:8704
    s_lshl_b32 s0, s53, 13
    v_mfma_f32_16x16x32_bf16 v[56:59], v[116:119], v[200:203], v[56:59]
    v_mfma_f32_16x16x32_bf16 v[60:63], v[116:119], v[204:207], v[60:63]
    ds_read_b64_tr_b16 v[104:105], v131 offset:8192
    ds_read_b64_tr_b16 v[106:107], v131 offset:8704
    s_add_u32 s63, s63, s0
    s_add_u32 s63, s63, 5507072
    s_waitcnt lgkmcnt(6)
    v_mfma_f32_16x16x32_bf16 v[16:19], v[64:67], v[208:211], v[16:19]
    v_mfma_f32_16x16x32_bf16 v[20:23], v[64:67], v[212:215], v[20:23]
    ds_read_b128 v[216:219], v126 offset:0
    ds_read_b128 v[220:223], v126 offset:2048
    ds_read_b64_tr_b16 v[108:109], v129 offset:4096
    ds_read_b64_tr_b16 v[110:111], v129 offset:4608
    s_lshl_b32 s0, s53, 12
    v_mfma_f32_16x16x32_bf16 v[32:35], v[68:71], v[208:211], v[32:35]
    v_mfma_f32_16x16x32_bf16 v[36:39], v[68:71], v[212:215], v[36:39]
    ds_read_b64_tr_b16 v[112:113], v130 offset:4096
    ds_read_b64_tr_b16 v[114:115], v130 offset:4608
    s_add_u32 s62, s62, s0
    v_mfma_f32_16x16x32_bf16 v[48:51], v[72:75], v[208:211], v[48:51]
    v_mfma_f32_16x16x32_bf16 v[52:55], v[72:75], v[212:215], v[52:55]
    ds_read_b64_tr_b16 v[116:117], v131 offset:4096
    ds_read_b64_tr_b16 v[118:119], v131 offset:4608
    s_add_u32 s62, s62, 1837056
    s_waitcnt lgkmcnt(8)
    v_mfma_f32_16x16x32_bf16 v[24:27], v[96:99], v[208:211], v[24:27]
    v_mfma_f32_16x16x32_bf16 v[28:31], v[96:99], v[212:215], v[28:31]
    ds_read_b64_tr_b16 v[64:65], v127 offset:4096
    ds_read_b64_tr_b16 v[66:67], v127 offset:4608
    s_mov_b32 s72, s16
    v_mfma_f32_16x16x32_bf16 v[40:43], v[100:103], v[208:211], v[40:43]
    v_mfma_f32_16x16x32_bf16 v[44:47], v[100:103], v[212:215], v[44:47]
    ds_read_b64_tr_b16 v[68:69], v130 offset:12288
    ds_read_b64_tr_b16 v[70:71], v130 offset:12800
    s_mov_b32 s73, s17
    v_mfma_f32_16x16x32_bf16 v[56:59], v[104:107], v[208:211], v[56:59]
    v_mfma_f32_16x16x32_bf16 v[60:63], v[104:107], v[212:215], v[60:63]
    ds_read_b64_tr_b16 v[72:73], v131 offset:12288
    ds_read_b64_tr_b16 v[74:75], v131 offset:12800
    s_mov_b32 s74, 1605632
    s_mov_b32 s75, 0x00020000
    s_waitcnt lgkmcnt(0)
    v_mfma_f32_16x16x32_bf16 v[16:19], v[108:111], v[216:219], v[16:19]
    v_mfma_f32_16x16x32_bf16 v[20:23], v[108:111], v[220:223], v[20:23]
    s_barrier
    ds_read_b128 v[224:227], v125 offset:16384
    ds_read_b128 v[228:231], v125 offset:18432
    ds_read_b64_tr_b16 v[96:97], v129 offset:8192
    ds_read_b64_tr_b16 v[98:99], v129 offset:8704
    v_lshrrev_b32 v5, 3, v0
    v_mfma_f32_16x16x32_bf16 v[32:35], v[112:115], v[216:219], v[32:35]
    v_mfma_f32_16x16x32_bf16 v[36:39], v[112:115], v[220:223], v[36:39]
    ds_read_b64_tr_b16 v[100:101], v130 offset:16384
    ds_read_b64_tr_b16 v[102:103], v130 offset:16896
    v_mul_u32_u24 v6, 896, v5
    v_mfma_f32_16x16x32_bf16 v[48:51], v[116:119], v[216:219], v[48:51]
    v_mfma_f32_16x16x32_bf16 v[52:55], v[116:119], v[220:223], v[52:55]
    ds_read_b64_tr_b16 v[104:105], v131 offset:16384
    ds_read_b64_tr_b16 v[106:107], v131 offset:16896
    v_lshrrev_b32 v5, 2, v0
    v_mfma_f32_16x16x32_bf16 v[24:27], v[64:67], v[216:219], v[24:27]
    v_mfma_f32_16x16x32_bf16 v[28:31], v[64:67], v[220:223], v[28:31]
    ds_read_b64_tr_b16 v[108:109], v127 offset:8192
    ds_read_b64_tr_b16 v[110:111], v127 offset:8704
    v_and_b32 v5, 4, v5
    v_mfma_f32_16x16x32_bf16 v[40:43], v[68:71], v[216:219], v[40:43]
    v_mfma_f32_16x16x32_bf16 v[44:47], v[68:71], v[220:223], v[44:47]
    ds_read_b64_tr_b16 v[112:113], v130 offset:24576
    ds_read_b64_tr_b16 v[114:115], v130 offset:25088
    v_and_b32 v7, 7, v0
    v_mfma_f32_16x16x32_bf16 v[56:59], v[72:75], v[216:219], v[56:59]
    v_mfma_f32_16x16x32_bf16 v[60:63], v[72:75], v[220:223], v[60:63]
    ds_read_b64_tr_b16 v[116:117], v131 offset:24576
    ds_read_b64_tr_b16 v[118:119], v131 offset:25088
    v_xor_b32 v5, v5, v7
    v_lshl_add_u32 v9, v5, 4, v6
    s_waitcnt lgkmcnt(6)
    v_mfma_f32_16x16x32_bf16 v[16:19], v[96:99], v[224:227], v[16:19]
    v_mfma_f32_16x16x32_bf16 v[20:23], v[96:99], v[228:231], v[20:23]
    ds_read_b128 v[232:235], v126 offset:16384
    ds_read_b128 v[236:239], v126 offset:18432
    ds_read_b64_tr_b16 v[64:65], v129 offset:12288
    ds_read_b64_tr_b16 v[66:67], v129 offset:12800
    v_add_u32 v10, 6144, v9
    v_mfma_f32_16x16x32_bf16 v[32:35], v[100:103], v[224:227], v[32:35]
    v_mfma_f32_16x16x32_bf16 v[36:39], v[100:103], v[228:231], v[36:39]
    ds_read_b64_tr_b16 v[68:69], v130 offset:20480
    ds_read_b64_tr_b16 v[70:71], v130 offset:20992
    s_and_b32 s70, s26, 3
    v_mfma_f32_16x16x32_bf16 v[48:51], v[104:107], v[224:227], v[48:51]
    v_mfma_f32_16x16x32_bf16 v[52:55], v[104:107], v[228:231], v[52:55]
    ds_read_b64_tr_b16 v[72:73], v131 offset:20480
    ds_read_b64_tr_b16 v[74:75], v131 offset:20992
    s_mul_i32 s81, s70, 14336
    s_waitcnt lgkmcnt(8)
    v_mfma_f32_16x16x32_bf16 v[24:27], v[108:111], v[224:227], v[24:27]
    v_mfma_f32_16x16x32_bf16 v[28:31], v[108:111], v[228:231], v[28:31]
    ds_read_b64_tr_b16 v[96:97], v127 offset:12288
    ds_read_b64_tr_b16 v[98:99], v127 offset:12800
    s_mul_i32 s80, s70, 12288
    v_mfma_f32_16x16x32_bf16 v[40:43], v[112:115], v[224:227], v[40:43]
    v_mfma_f32_16x16x32_bf16 v[44:47], v[112:115], v[228:231], v[44:47]
    ds_read_b64_tr_b16 v[100:101], v130 offset:28672
    ds_read_b64_tr_b16 v[102:103], v130 offset:29184
    s_add_u32 s80, s80, 57344
    v_mfma_f32_16x16x32_bf16 v[56:59], v[116:119], v[224:227], v[56:59]
    v_mfma_f32_16x16x32_bf16 v[60:63], v[116:119], v[228:231], v[60:63]
    ds_read_b64_tr_b16 v[104:105], v131 offset:28672
    ds_read_b64_tr_b16 v[106:107], v131 offset:29184
    s_lshr_b32 s0, s2, 3
    s_bitcmp1_b32 s2, 0
    s_cselect_b32 s1, 32, 0
    s_cselect_b32 s69, 24, 32
    s_lshl_b32 s18, s2, 3
    s_add_u32 s18, s18, s26
    s_lshl_b32 s19, s18, 7
    v_lshl_add_u32 v13, v0, 18, s19
    s_mov_b32 s4, s16
    s_mov_b32 s5, s17
    s_mov_b32 s6, 1605632
    s_mov_b32 s7, 0x00020000
    s_mov_b32 s12, s8
    s_mov_b32 s13, s9
    s_mov_b32 s14, 401408
    s_mov_b32 s15, 0x00020000
    s_mov_b64 exec, 0x7f
    buffer_load_dword v11, v13, s[4:7], 0 offen
    buffer_load_dword v11, v13, s[12:15], 0 offen
    s_mov_b64 exec, -1
    s_waitcnt lgkmcnt(0)
    v_mfma_f32_16x16x32_bf16 v[16:19], v[64:67], v[232:235], v[16:19]
    v_mfma_f32_16x16x32_bf16 v[20:23], v[64:67], v[236:239], v[20:23]
    s_waitcnt vmcnt(2)
    s_barrier
    s_mov_b32 s48, s22
    s_mov_b32 s49, s23
    s_mov_b32 s50, 256
    s_mov_b32 s51, 0x00020000
    ds_read_b128 v[240:243], v125 offset:32768
    ds_read_b128 v[244:247], v125 offset:34816
    ds_read_b64_tr_b16 v[108:109], v129 offset:16384
    ds_read_b64_tr_b16 v[110:111], v129 offset:16896
    s_cmp_ge_u32 s0, s69
    s_cselect_b32 s69, 7, 0
    v_mfma_f32_16x16x32_bf16 v[32:35], v[68:71], v[232:235], v[32:35]
    v_mfma_f32_16x16x32_bf16 v[36:39], v[68:71], v[236:239], v[36:39]
    ds_read_b64_tr_b16 v[112:113], v130 offset:32768
    ds_read_b64_tr_b16 v[114:115], v130 offset:33280
    s_add_u32 s0, s0, s1
    v_mfma_f32_16x16x32_bf16 v[48:51], v[72:75], v[232:235], v[48:51]
    v_mfma_f32_16x16x32_bf16 v[52:55], v[72:75], v[236:239], v[52:55]
    ds_read_b64_tr_b16 v[116:117], v131 offset:32768
    ds_read_b64_tr_b16 v[118:119], v131 offset:33280
    s_mul_i32 s68, s0, 9363
    v_mfma_f32_16x16x32_bf16 v[24:27], v[96:99], v[232:235], v[24:27]
    v_mfma_f32_16x16x32_bf16 v[28:31], v[96:99], v[236:239], v[28:31]
    ds_read_b64_tr_b16 v[64:65], v127 offset:16384
    ds_read_b64_tr_b16 v[66:67], v127 offset:16896
    s_lshr_b32 s68, s68, 16
    v_mfma_f32_16x16x32_bf16 v[40:43], v[100:103], v[232:235], v[40:43]
    v_mfma_f32_16x16x32_bf16 v[44:47], v[100:103], v[236:239], v[44:47]
    ds_read_b64_tr_b16 v[68:69], v130 offset:40960
    ds_read_b64_tr_b16 v[70:71], v130 offset:41472
    s_mul_i32 s1, s68, 7
    v_mfma_f32_16x16x32_bf16 v[56:59], v[104:107], v[232:235], v[56:59]
    v_mfma_f32_16x16x32_bf16 v[60:63], v[104:107], v[236:239], v[60:63]
    ds_read_b64_tr_b16 v[72:73], v131 offset:40960
    ds_read_b64_tr_b16 v[74:75], v131 offset:41472
    s_sub_u32 s0, s0, s1
    s_or_b32 s69, s69, s0
    s_waitcnt lgkmcnt(6)
    v_mfma_f32_16x16x32_bf16 v[16:19], v[108:111], v[240:243], v[16:19]
    v_mfma_f32_16x16x32_bf16 v[20:23], v[108:111], v[244:247], v[20:23]
    ds_read_b128 v[248:251], v126 offset:32768
    ds_read_b128 v[252:255], v126 offset:34816
    ds_read_b64_tr_b16 v[96:97], v129 offset:20480
    ds_read_b64_tr_b16 v[98:99], v129 offset:20992
    s_min_u32 s68, s68, 7
    v_mfma_f32_16x16x32_bf16 v[32:35], v[112:115], v[240:243], v[32:35]
    v_mfma_f32_16x16x32_bf16 v[36:39], v[112:115], v[244:247], v[36:39]
    ds_read_b64_tr_b16 v[100:101], v130 offset:36864
    ds_read_b64_tr_b16 v[102:103], v130 offset:37376
    s_bfe_u32 s0, s2, 0x20001
    v_mfma_f32_16x16x32_bf16 v[48:51], v[116:119], v[240:243], v[48:51]
    v_mfma_f32_16x16x32_bf16 v[52:55], v[116:119], v[244:247], v[52:55]
    ds_read_b64_tr_b16 v[104:105], v131 offset:36864
    ds_read_b64_tr_b16 v[106:107], v131 offset:37376
    s_lshl_b32 s0, s0, 3
    s_waitcnt lgkmcnt(8)
    v_mfma_f32_16x16x32_bf16 v[24:27], v[64:67], v[240:243], v[24:27]
    v_mfma_f32_16x16x32_bf16 v[28:31], v[64:67], v[244:247], v[28:31]
    ds_read_b64_tr_b16 v[108:109], v127 offset:20480
    ds_read_b64_tr_b16 v[110:111], v127 offset:20992
    s_add_u32 s68, s68, s0
    v_mfma_f32_16x16x32_bf16 v[40:43], v[68:71], v[240:243], v[40:43]
    v_mfma_f32_16x16x32_bf16 v[44:47], v[68:71], v[244:247], v[44:47]
    ds_read_b64_tr_b16 v[112:113], v130 offset:45056
    ds_read_b64_tr_b16 v[114:115], v130 offset:45568
    s_lshl_b32 s0, s69, 7
    v_mfma_f32_16x16x32_bf16 v[56:59], v[72:75], v[240:243], v[56:59]
    v_mfma_f32_16x16x32_bf16 v[60:63], v[72:75], v[244:247], v[60:63]
    ds_read_b64_tr_b16 v[116:117], v131 offset:45056
    ds_read_b64_tr_b16 v[118:119], v131 offset:45568
    s_mul_i32 s82, s70, 401408
    s_add_u32 s82, s82, s0
    s_waitcnt lgkmcnt(6)
    v_mfma_f32_16x16x32_bf16 v[16:19], v[96:99], v[248:251], v[16:19]
    v_mfma_f32_16x16x32_bf16 v[20:23], v[96:99], v[252:255], v[20:23]
    v_mfma_f32_16x16x32_bf16 v[32:35], v[100:103], v[248:251], v[32:35]
    v_mfma_f32_16x16x32_bf16 v[36:39], v[100:103], v[252:255], v[36:39]
    v_mfma_f32_16x16x32_bf16 v[48:51], v[104:107], v[248:251], v[48:51]
    v_mfma_f32_16x16x32_bf16 v[52:55], v[104:107], v[252:255], v[52:55]
    s_waitcnt lgkmcnt(0)
    v_mfma_f32_16x16x32_bf16 v[24:27], v[108:111], v[248:251], v[24:27]
    v_mfma_f32_16x16x32_bf16 v[28:31], v[108:111], v[252:255], v[28:31]
    s_barrier
    ds_read_b64_tr_b16 v[96:97], v132 offset:49152
    ds_read_b64_tr_b16 v[98:99], v132 offset:49664
    v_mfma_f32_16x16x32_bf16 v[40:43], v[112:115], v[248:251], v[40:43]
    v_mfma_f32_16x16x32_bf16 v[44:47], v[112:115], v[252:255], v[44:47]
    ds_read_b64_tr_b16 v[100:101], v133 offset:49152
    ds_read_b64_tr_b16 v[102:103], v133 offset:49664
    v_mfma_f32_16x16x32_bf16 v[56:59], v[116:119], v[248:251], v[56:59]
    v_mfma_f32_16x16x32_bf16 v[60:63], v[116:119], v[252:255], v[60:63]
    s_waitcnt lgkmcnt(2)
    v_mfma_f32_16x16x32_bf16 v[64:67], v[96:99], v[144:147], 0
    v_mfma_f32_16x16x32_bf16 v[68:71], v[96:99], v[148:151], 0
    ds_read_b64_tr_b16 v[108:109], v132 offset:57344
    ds_read_b64_tr_b16 v[110:111], v132 offset:57856
    v_cvt_pk_bf16_f32 v136, v16, v17
    v_cvt_pk_bf16_f32 v137, v18, v19
    v_cvt_pk_bf16_f32 v138, v20, v21
    v_cvt_pk_bf16_f32 v139, v22, v23
    v_cvt_pk_bf16_f32 v140, v24, v25
    v_cvt_pk_bf16_f32 v141, v26, v27
    v_cvt_pk_bf16_f32 v142, v28, v29
    v_cvt_pk_bf16_f32 v143, v30, v31
    s_waitcnt lgkmcnt(2)
    v_mfma_f32_16x16x32_bf16 v[80:83], v[100:103], v[144:147], 0
    v_mfma_f32_16x16x32_bf16 v[84:87], v[100:103], v[148:151], 0
    ds_read_b64_tr_b16 v[112:113], v133 offset:57344
    ds_read_b64_tr_b16 v[114:115], v133 offset:57856
    s_add_u32 s59, s62, 0
    v_permlane16_swap_b32 v136, v138
    v_permlane16_swap_b32 v137, v139
    v_permlane16_swap_b32 v140, v142
    v_permlane16_swap_b32 v141, v143
    buffer_store_dwordx4 v[136:139], v134, s[28:31], s59 offen offset:0 sc1
    buffer_store_dwordx4 v[140:143], v134, s[28:31], s59 offen offset:1024 sc1
    s_waitcnt lgkmcnt(2)
    v_mfma_f32_16x16x32_bf16 v[72:75], v[108:111], v[144:147], 0
    v_mfma_f32_16x16x32_bf16 v[76:79], v[108:111], v[148:151], 0
    ds_read_b64_tr_b16 v[96:97], v132 offset:53248
    ds_read_b64_tr_b16 v[98:99], v132 offset:53760
    s_waitcnt lgkmcnt(2)
    v_mfma_f32_16x16x32_bf16 v[88:91], v[112:115], v[144:147], 0
    v_mfma_f32_16x16x32_bf16 v[92:95], v[112:115], v[148:151], 0
    ds_read_b64_tr_b16 v[100:101], v133 offset:53248
    ds_read_b64_tr_b16 v[102:103], v133 offset:53760
    s_waitcnt lgkmcnt(2)
    v_mfma_f32_16x16x32_bf16 v[64:67], v[96:99], v[152:155], v[64:67]
    v_mfma_f32_16x16x32_bf16 v[68:71], v[96:99], v[156:159], v[68:71]
    ds_read_b64_tr_b16 v[108:109], v132 offset:61440
    ds_read_b64_tr_b16 v[110:111], v132 offset:61952
    s_waitcnt lgkmcnt(2)
    v_mfma_f32_16x16x32_bf16 v[80:83], v[100:103], v[152:155], v[80:83]
    v_mfma_f32_16x16x32_bf16 v[84:87], v[100:103], v[156:159], v[84:87]
    ds_read_b64_tr_b16 v[112:113], v133 offset:61440
    ds_read_b64_tr_b16 v[114:115], v133 offset:61952
    s_waitcnt lgkmcnt(2)
    v_mfma_f32_16x16x32_bf16 v[72:75], v[108:111], v[152:155], v[72:75]
    v_mfma_f32_16x16x32_bf16 v[76:79], v[108:111], v[156:159], v[76:79]
    ds_read_b64_tr_b16 v[96:97], v130 offset:49152
    ds_read_b64_tr_b16 v[98:99], v130 offset:49664
    s_waitcnt lgkmcnt(2)
    v_mfma_f32_16x16x32_bf16 v[88:91], v[112:115], v[152:155], v[88:91]
    v_mfma_f32_16x16x32_bf16 v[92:95], v[112:115], v[156:159], v[92:95]
    ds_read_b64_tr_b16 v[100:101], v131 offset:49152
    ds_read_b64_tr_b16 v[102:103], v131 offset:49664
    v_mul_f32 v1, v32, v32
    v_mul_f32 v2, v33, v33
    v_mul_f32 v3, v34, v34
    v_mul_f32 v4, v35, v35
    s_waitcnt lgkmcnt(2)
    v_mfma_f32_16x16x32_bf16 v[64:67], v[96:99], v[160:163], v[64:67]
    v_mfma_f32_16x16x32_bf16 v[68:71], v[96:99], v[164:167], v[68:71]
    ds_read_b64_tr_b16 v[108:109], v130 offset:57344
    ds_read_b64_tr_b16 v[110:111], v130 offset:57856
    v_fmamk_f32 v1, v1, 0xbdd2d3e8, v15
    v_fmamk_f32 v2, v2, 0xbdd2d3e8, v15
    v_fmamk_f32 v3, v3, 0xbdd2d3e8, v15
    s_waitcnt lgkmcnt(2)
    v_mfma_f32_16x16x32_bf16 v[80:83], v[100:103], v[160:163], v[80:83]
    v_mfma_f32_16x16x32_bf16 v[84:87], v[100:103], v[164:167], v[84:87]
    ds_read_b64_tr_b16 v[112:113], v131 offset:57344
    ds_read_b64_tr_b16 v[114:115], v131 offset:57856
    v_fmamk_f32 v4, v4, 0xbdd2d3e8, v15
    v_mul_f32 v1, v1, v32
    v_mul_f32 v2, v2, v33
    s_waitcnt lgkmcnt(2)
    v_mfma_f32_16x16x32_bf16 v[72:75], v[108:111], v[160:163], v[72:75]
    v_mfma_f32_16x16x32_bf16 v[76:79], v[108:111], v[164:167], v[76:79]
    ds_read_b64_tr_b16 v[96:97], v130 offset:53248
    ds_read_b64_tr_b16 v[98:99], v130 offset:53760
    v_mul_f32 v3, v3, v34
    v_mul_f32 v4, v4, v35
    v_exp_f32 v1, v1
    s_waitcnt lgkmcnt(2)
    v_mfma_f32_16x16x32_bf16 v[88:91], v[112:115], v[160:163], v[88:91]
    v_mfma_f32_16x16x32_bf16 v[92:95], v[112:115], v[164:167], v[92:95]
    ds_read_b64_tr_b16 v[100:101], v131 offset:53248
    ds_read_b64_tr_b16 v[102:103], v131 offset:53760
    v_exp_f32 v2, v2
    v_exp_f32 v3, v3
    v_exp_f32 v4, v4
    s_waitcnt lgkmcnt(2)
    v_mfma_f32_16x16x32_bf16 v[64:67], v[96:99], v[168:171], v[64:67]
    v_mfma_f32_16x16x32_bf16 v[68:71], v[96:99], v[172:175], v[68:71]
    ds_read_b64_tr_b16 v[108:109], v130 offset:61440
    ds_read_b64_tr_b16 v[110:111], v130 offset:61952
    v_mul_f32 v40, v32, v40
    v_mul_f32 v41, v33, v41
    v_mul_f32 v42, v34, v42
    s_waitcnt lgkmcnt(2)
    v_mfma_f32_16x16x32_bf16 v[80:83], v[100:103], v[168:171], v[80:83]
    v_mfma_f32_16x16x32_bf16 v[84:87], v[100:103], v[172:175], v[84:87]
    ds_read_b64_tr_b16 v[112:113], v131 offset:61440
    ds_read_b64_tr_b16 v[114:115], v131 offset:61952
    v_mul_f32 v43, v35, v43
    v_add_f32 v1, 1.0, v1
    v_add_f32 v2, 1.0, v2
    v_add_f32 v3, 1.0, v3
    s_waitcnt lgkmcnt(0)
    v_mfma_f32_16x16x32_bf16 v[72:75], v[108:111], v[168:171], v[72:75]
    v_mfma_f32_16x16x32_bf16 v[76:79], v[108:111], v[172:175], v[76:79]
    s_barrier
    ds_read_b64_tr_b16 v[96:97], v132 offset:0
    ds_read_b64_tr_b16 v[98:99], v132 offset:512
    v_add_f32 v4, 1.0, v4
    v_rcp_f32 v1, v1
    v_rcp_f32 v2, v2
    v_mfma_f32_16x16x32_bf16 v[88:91], v[112:115], v[168:171], v[88:91]
    v_mfma_f32_16x16x32_bf16 v[92:95], v[112:115], v[172:175], v[92:95]
    ds_read_b64_tr_b16 v[100:101], v133 offset:0
    ds_read_b64_tr_b16 v[102:103], v133 offset:512
    v_rcp_f32 v3, v3
    v_rcp_f32 v4, v4
    v_mul_f32 v40, v40, v1
    s_lshl_b32 s3, s26, 9
    s_add_u32 s3, s3, 155648
    v_lshl_add_u32 v8, v0, 3, s3
    v_mov_b64 v[6:7], 0
    ds_write_b64 v8, v[6:7]
    ds_write_b64 v8, v[6:7] offset:4096
    s_waitcnt lgkmcnt(4)
    v_mfma_f32_16x16x32_bf16 v[64:67], v[96:99], v[176:179], v[64:67]
    v_mfma_f32_16x16x32_bf16 v[68:71], v[96:99], v[180:183], v[68:71]
    ds_read_b64_tr_b16 v[108:109], v132 offset:8192
    ds_read_b64_tr_b16 v[110:111], v132 offset:8704
    v_mul_f32 v41, v41, v2
    v_mul_f32 v42, v42, v3
    v_mul_f32 v43, v43, v4
    s_waitcnt lgkmcnt(4)
    v_mfma_f32_16x16x32_bf16 v[80:83], v[100:103], v[176:179], v[80:83]
    v_mfma_f32_16x16x32_bf16 v[84:87], v[100:103], v[180:183], v[84:87]
    ds_read_b64_tr_b16 v[112:113], v133 offset:8192
    ds_read_b64_tr_b16 v[114:115], v133 offset:8704
    v_cvt_pk_bf16_f32 v136, v40, v41
    v_cvt_pk_bf16_f32 v137, v42, v43
    v_mul_f32 v1, v36, v36
    s_waitcnt lgkmcnt(2)
    v_mfma_f32_16x16x32_bf16 v[72:75], v[108:111], v[176:179], v[72:75]
    v_mfma_f32_16x16x32_bf16 v[76:79], v[108:111], v[180:183], v[76:79]
    s_waitcnt vmcnt(0)
    s_barrier
    ds_read_b64_tr_b16 v[96:97], v132 offset:4096
    ds_read_b64_tr_b16 v[98:99], v132 offset:4608
    v_mul_f32 v2, v37, v37
    v_mul_f32 v3, v38, v38
    v_mul_f32 v4, v39, v39
    v_fmamk_f32 v1, v1, 0xbdd2d3e8, v15
    s_waitcnt lgkmcnt(2)
    v_mfma_f32_16x16x32_bf16 v[88:91], v[112:115], v[176:179], v[88:91]
    v_mfma_f32_16x16x32_bf16 v[92:95], v[112:115], v[180:183], v[92:95]
    ds_read_b64_tr_b16 v[100:101], v133 offset:4096
    ds_read_b64_tr_b16 v[102:103], v133 offset:4608
    v_fmamk_f32 v2, v2, 0xbdd2d3e8, v15
    v_fmamk_f32 v3, v3, 0xbdd2d3e8, v15
    v_fmamk_f32 v4, v4, 0xbdd2d3e8, v15
    s_waitcnt lgkmcnt(2)
    v_mfma_f32_16x16x32_bf16 v[64:67], v[96:99], v[184:187], v[64:67]
    v_mfma_f32_16x16x32_bf16 v[68:71], v[96:99], v[188:191], v[68:71]
    ds_read_b64_tr_b16 v[108:109], v132 offset:12288
    ds_read_b64_tr_b16 v[110:111], v132 offset:12800
    v_mul_f32 v1, v1, v36
    v_mul_f32 v2, v2, v37
    v_mul_f32 v3, v3, v38
    s_waitcnt lgkmcnt(2)
    v_mfma_f32_16x16x32_bf16 v[80:83], v[100:103], v[184:187], v[80:83]
    v_mfma_f32_16x16x32_bf16 v[84:87], v[100:103], v[188:191], v[84:87]
    ds_read_b64_tr_b16 v[112:113], v133 offset:12288
    ds_read_b64_tr_b16 v[114:115], v133 offset:12800
    v_mul_f32 v4, v4, v39
    v_exp_f32 v1, v1
    v_exp_f32 v2, v2
    s_waitcnt lgkmcnt(2)
    v_mfma_f32_16x16x32_bf16 v[72:75], v[108:111], v[184:187], v[72:75]
    v_mfma_f32_16x16x32_bf16 v[76:79], v[108:111], v[188:191], v[76:79]
    ds_read_b64_tr_b16 v[96:97], v130 offset:0
    ds_read_b64_tr_b16 v[98:99], v130 offset:512
    v_exp_f32 v3, v3
    v_exp_f32 v4, v4
    v_mul_f32 v44, v36, v44
    s_waitcnt lgkmcnt(2)
    v_mfma_f32_16x16x32_bf16 v[88:91], v[112:115], v[184:187], v[88:91]
    v_mfma_f32_16x16x32_bf16 v[92:95], v[112:115], v[188:191], v[92:95]
    ds_read_b64_tr_b16 v[100:101], v131 offset:0
    ds_read_b64_tr_b16 v[102:103], v131 offset:512
    v_mul_f32 v45, v37, v45
    v_mul_f32 v46, v38, v46
    v_mul_f32 v47, v39, v47
    s_waitcnt lgkmcnt(2)
    v_mfma_f32_16x16x32_bf16 v[64:67], v[96:99], v[192:195], v[64:67]
    v_mfma_f32_16x16x32_bf16 v[68:71], v[96:99], v[196:199], v[68:71]
    ds_read_b64_tr_b16 v[108:109], v130 offset:8192
    ds_read_b64_tr_b16 v[110:111], v130 offset:8704
    v_add_f32 v1, 1.0, v1
    v_add_f32 v2, 1.0, v2
    v_add_f32 v3, 1.0, v3
    v_add_f32 v4, 1.0, v4
    s_waitcnt lgkmcnt(2)
    v_mfma_f32_16x16x32_bf16 v[80:83], v[100:103], v[192:195], v[80:83]
    v_mfma_f32_16x16x32_bf16 v[84:87], v[100:103], v[196:199], v[84:87]
    ds_read_b64_tr_b16 v[112:113], v131 offset:8192
    ds_read_b64_tr_b16 v[114:115], v131 offset:8704
    v_rcp_f32 v1, v1
    v_rcp_f32 v2, v2
    v_rcp_f32 v3, v3
    s_waitcnt lgkmcnt(2)
    v_mfma_f32_16x16x32_bf16 v[72:75], v[108:111], v[192:195], v[72:75]
    v_mfma_f32_16x16x32_bf16 v[76:79], v[108:111], v[196:199], v[76:79]
    ds_read_b64_tr_b16 v[96:97], v130 offset:4096
    ds_read_b64_tr_b16 v[98:99], v130 offset:4608
    v_rcp_f32 v4, v4
    v_mul_f32 v44, v44, v1
    v_mul_f32 v45, v45, v2
    s_waitcnt lgkmcnt(2)
    v_mfma_f32_16x16x32_bf16 v[88:91], v[112:115], v[192:195], v[88:91]
    v_mfma_f32_16x16x32_bf16 v[92:95], v[112:115], v[196:199], v[92:95]
    ds_read_b64_tr_b16 v[100:101], v131 offset:4096
    ds_read_b64_tr_b16 v[102:103], v131 offset:4608
    v_mul_f32 v46, v46, v3
    v_mul_f32 v47, v47, v4
    v_cvt_pk_bf16_f32 v138, v44, v45
    s_waitcnt lgkmcnt(2)
    v_mfma_f32_16x16x32_bf16 v[64:67], v[96:99], v[200:203], v[64:67]
    v_mfma_f32_16x16x32_bf16 v[68:71], v[96:99], v[204:207], v[68:71]
    ds_read_b64_tr_b16 v[108:109], v130 offset:12288
    ds_read_b64_tr_b16 v[110:111], v130 offset:12800
    v_cvt_pk_bf16_f32 v139, v46, v47
    s_add_u32 s59, s63, 0
    v_permlane16_swap_b32 v136, v138
    s_waitcnt lgkmcnt(2)
    v_mfma_f32_16x16x32_bf16 v[80:83], v[100:103], v[200:203], v[80:83]
    v_mfma_f32_16x16x32_bf16 v[84:87], v[100:103], v[204:207], v[84:87]
    ds_read_b64_tr_b16 v[112:113], v131 offset:12288
    ds_read_b64_tr_b16 v[114:115], v131 offset:12800
    v_permlane16_swap_b32 v137, v139
    buffer_store_dwordx4 v[136:139], v134, s[28:31], s59 offen sc1
    v_mul_f32 v1, v48, v48
    v_mul_f32 v2, v49, v49
    s_waitcnt lgkmcnt(0)
    v_mfma_f32_16x16x32_bf16 v[72:75], v[108:111], v[200:203], v[72:75]
    v_mfma_f32_16x16x32_bf16 v[76:79], v[108:111], v[204:207], v[76:79]
    s_barrier
    ds_read_b64_tr_b16 v[96:97], v132 offset:16384
    ds_read_b64_tr_b16 v[98:99], v132 offset:16896
    v_mul_f32 v3, v50, v50
    v_mul_f32 v4, v51, v51
    v_fmamk_f32 v1, v1, 0xbdd2d3e8, v15
    v_mfma_f32_16x16x32_bf16 v[88:91], v[112:115], v[200:203], v[88:91]
    v_mfma_f32_16x16x32_bf16 v[92:95], v[112:115], v[204:207], v[92:95]
    ds_read_b64_tr_b16 v[100:101], v133 offset:16384
    ds_read_b64_tr_b16 v[102:103], v133 offset:16896
    v_fmamk_f32 v2, v2, 0xbdd2d3e8, v15
    v_fmamk_f32 v3, v3, 0xbdd2d3e8, v15
    v_fmamk_f32 v4, v4, 0xbdd2d3e8, v15
    s_add_u32 m0, s80, 0
    s_add_u32 s0, s82, 0
    buffer_load_dwordx4 v9, s[72:75], s0 offen lds
    buffer_load_dwordx4 v10, s[72:75], s0 offen offset:1024 lds
    s_waitcnt lgkmcnt(2)
    v_mfma_f32_16x16x32_bf16 v[64:67], v[96:99], v[208:211], v[64:67]
    v_mfma_f32_16x16x32_bf16 v[68:71], v[96:99], v[212:215], v[68:71]
    ds_read_b64_tr_b16 v[108:109], v132 offset:24576
    ds_read_b64_tr_b16 v[110:111], v132 offset:25088
    v_mul_f32 v1, v1, v48
    v_mul_f32 v2, v2, v49
    v_mul_f32 v3, v3, v50
    s_waitcnt lgkmcnt(2)
    v_mfma_f32_16x16x32_bf16 v[80:83], v[100:103], v[208:211], v[80:83]
    v_mfma_f32_16x16x32_bf16 v[84:87], v[100:103], v[212:215], v[84:87]
    ds_read_b64_tr_b16 v[112:113], v133 offset:24576
    ds_read_b64_tr_b16 v[114:115], v133 offset:25088
    v_mul_f32 v4, v4, v51
    v_exp_f32 v1, v1
    v_exp_f32 v2, v2
    s_waitcnt lgkmcnt(2)
    v_mfma_f32_16x16x32_bf16 v[72:75], v[108:111], v[208:211], v[72:75]
    v_mfma_f32_16x16x32_bf16 v[76:79], v[108:111], v[212:215], v[76:79]
    ds_read_b64_tr_b16 v[96:97], v132 offset:20480
    ds_read_b64_tr_b16 v[98:99], v132 offset:20992
    v_exp_f32 v3, v3
    v_exp_f32 v4, v4
    v_mul_f32 v56, v48, v56
    s_waitcnt lgkmcnt(2)
    v_mfma_f32_16x16x32_bf16 v[88:91], v[112:115], v[208:211], v[88:91]
    v_mfma_f32_16x16x32_bf16 v[92:95], v[112:115], v[212:215], v[92:95]
    ds_read_b64_tr_b16 v[100:101], v133 offset:20480
    ds_read_b64_tr_b16 v[102:103], v133 offset:20992
    v_mul_f32 v57, v49, v57
    v_mul_f32 v58, v50, v58
    v_mul_f32 v59, v51, v59
    v_add_f32 v1, 1.0, v1
    s_add_u32 m0, s80, 2048
    s_add_u32 s0, s82, 14336
    buffer_load_dwordx4 v9, s[72:75], s0 offen lds
    buffer_load_dwordx4 v10, s[72:75], s0 offen offset:1024 lds
    s_waitcnt lgkmcnt(2)
    v_mfma_f32_16x16x32_bf16 v[64:67], v[96:99], v[216:219], v[64:67]
    v_mfma_f32_16x16x32_bf16 v[68:71], v[96:99], v[220:223], v[68:71]
    ds_read_b64_tr_b16 v[108:109], v132 offset:28672
    ds_read_b64_tr_b16 v[110:111], v132 offset:29184
    v_add_f32 v2, 1.0, v2
    v_add_f32 v3, 1.0, v3
    v_add_f32 v4, 1.0, v4
    s_waitcnt lgkmcnt(2)
    v_mfma_f32_16x16x32_bf16 v[80:83], v[100:103], v[216:219], v[80:83]
    v_mfma_f32_16x16x32_bf16 v[84:87], v[100:103], v[220:223], v[84:87]
    ds_read_b64_tr_b16 v[112:113], v133 offset:28672
    ds_read_b64_tr_b16 v[114:115], v133 offset:29184
    v_rcp_f32 v1, v1
    v_rcp_f32 v2, v2
    v_rcp_f32 v3, v3
    s_waitcnt lgkmcnt(2)
    v_mfma_f32_16x16x32_bf16 v[72:75], v[108:111], v[216:219], v[72:75]
    v_mfma_f32_16x16x32_bf16 v[76:79], v[108:111], v[220:223], v[76:79]
    ds_read_b64_tr_b16 v[96:97], v130 offset:16384
    ds_read_b64_tr_b16 v[98:99], v130 offset:16896
    v_rcp_f32 v4, v4
    v_mul_f32 v56, v56, v1
    v_mul_f32 v57, v57, v2
    s_waitcnt lgkmcnt(2)
    v_mfma_f32_16x16x32_bf16 v[88:91], v[112:115], v[216:219], v[88:91]
    v_mfma_f32_16x16x32_bf16 v[92:95], v[112:115], v[220:223], v[92:95]
    ds_read_b64_tr_b16 v[100:101], v131 offset:16384
    ds_read_b64_tr_b16 v[102:103], v131 offset:16896
    v_mul_f32 v58, v58, v3
    v_mul_f32 v59, v59, v4
    v_cvt_pk_bf16_f32 v140, v56, v57
    s_add_u32 m0, s80, 4096
    s_add_u32 s0, s82, 28672
    buffer_load_dwordx4 v9, s[72:75], s0 offen lds
    buffer_load_dwordx4 v10, s[72:75], s0 offen offset:1024 lds
    s_waitcnt lgkmcnt(2)
    v_mfma_f32_16x16x32_bf16 v[64:67], v[96:99], v[224:227], v[64:67]
    v_mfma_f32_16x16x32_bf16 v[68:71], v[96:99], v[228:231], v[68:71]
    ds_read_b64_tr_b16 v[108:109], v130 offset:24576
    ds_read_b64_tr_b16 v[110:111], v130 offset:25088
    v_cvt_pk_bf16_f32 v141, v58, v59
    v_mul_f32 v1, v52, v52
    v_mul_f32 v2, v53, v53
    v_mul_f32 v3, v54, v54
    s_waitcnt lgkmcnt(2)
    v_mfma_f32_16x16x32_bf16 v[80:83], v[100:103], v[224:227], v[80:83]
    v_mfma_f32_16x16x32_bf16 v[84:87], v[100:103], v[228:231], v[84:87]
    ds_read_b64_tr_b16 v[112:113], v131 offset:24576
    ds_read_b64_tr_b16 v[114:115], v131 offset:25088
    v_mul_f32 v4, v55, v55
    v_fmamk_f32 v1, v1, 0xbdd2d3e8, v15
    v_fmamk_f32 v2, v2, 0xbdd2d3e8, v15
    s_waitcnt lgkmcnt(2)
    v_mfma_f32_16x16x32_bf16 v[72:75], v[108:111], v[224:227], v[72:75]
    v_mfma_f32_16x16x32_bf16 v[76:79], v[108:111], v[228:231], v[76:79]
    ds_read_b64_tr_b16 v[96:97], v130 offset:20480
    ds_read_b64_tr_b16 v[98:99], v130 offset:20992
    v_fmamk_f32 v3, v3, 0xbdd2d3e8, v15
    v_fmamk_f32 v4, v4, 0xbdd2d3e8, v15
    v_mul_f32 v1, v1, v52
    s_waitcnt lgkmcnt(2)
    v_mfma_f32_16x16x32_bf16 v[88:91], v[112:115], v[224:227], v[88:91]
    v_mfma_f32_16x16x32_bf16 v[92:95], v[112:115], v[228:231], v[92:95]
    ds_read_b64_tr_b16 v[100:101], v131 offset:20480
    ds_read_b64_tr_b16 v[102:103], v131 offset:20992
    v_mul_f32 v2, v2, v53
    v_mul_f32 v3, v3, v54
    v_mul_f32 v4, v4, v55
    s_add_u32 m0, s80, 6144
    s_add_u32 s0, s82, 43008
    buffer_load_dwordx4 v9, s[72:75], s0 offen lds
    buffer_load_dwordx4 v10, s[72:75], s0 offen offset:1024 lds
    s_waitcnt lgkmcnt(2)
    v_mfma_f32_16x16x32_bf16 v[64:67], v[96:99], v[232:235], v[64:67]
    v_mfma_f32_16x16x32_bf16 v[68:71], v[96:99], v[236:239], v[68:71]
    ds_read_b64_tr_b16 v[108:109], v130 offset:28672
    ds_read_b64_tr_b16 v[110:111], v130 offset:29184
    v_exp_f32 v1, v1
    v_exp_f32 v2, v2
    v_exp_f32 v3, v3
    s_waitcnt lgkmcnt(2)
    v_mfma_f32_16x16x32_bf16 v[80:83], v[100:103], v[232:235], v[80:83]
    v_mfma_f32_16x16x32_bf16 v[84:87], v[100:103], v[236:239], v[84:87]
    ds_read_b64_tr_b16 v[112:113], v131 offset:28672
    ds_read_b64_tr_b16 v[114:115], v131 offset:29184
    v_exp_f32 v4, v4
    v_mul_f32 v60, v52, v60
    v_mul_f32 v61, v53, v61
    s_waitcnt lgkmcnt(2)
    v_mfma_f32_16x16x32_bf16 v[72:75], v[108:111], v[232:235], v[72:75]
    v_mfma_f32_16x16x32_bf16 v[76:79], v[108:111], v[236:239], v[76:79]
    ds_read_b64_tr_b16 v[96:97], v132 offset:32768
    ds_read_b64_tr_b16 v[98:99], v132 offset:33280
    v_mul_f32 v62, v54, v62
    v_mul_f32 v63, v55, v63
    v_add_f32 v1, 1.0, v1
    v_add_f32 v2, 1.0, v2
    s_waitcnt lgkmcnt(2)
    v_mfma_f32_16x16x32_bf16 v[88:91], v[112:115], v[232:235], v[88:91]
    v_mfma_f32_16x16x32_bf16 v[92:95], v[112:115], v[236:239], v[92:95]
    ds_read_b64_tr_b16 v[100:101], v133 offset:32768
    ds_read_b64_tr_b16 v[102:103], v133 offset:33280
    v_add_f32 v3, 1.0, v3
    v_add_f32 v4, 1.0, v4
    v_rcp_f32 v1, v1
    s_add_u32 m0, s80, 8192
    s_add_u32 s0, s82, 57344
    buffer_load_dwordx4 v9, s[72:75], s0 offen lds
    buffer_load_dwordx4 v10, s[72:75], s0 offen offset:1024 lds
    s_waitcnt lgkmcnt(2)
    v_mfma_f32_16x16x32_bf16 v[64:67], v[96:99], v[240:243], v[64:67]
    v_mfma_f32_16x16x32_bf16 v[68:71], v[96:99], v[244:247], v[68:71]
    ds_read_b64_tr_b16 v[108:109], v132 offset:40960
    ds_read_b64_tr_b16 v[110:111], v132 offset:41472
    v_rcp_f32 v2, v2
    v_rcp_f32 v3, v3
    v_rcp_f32 v4, v4
    s_waitcnt lgkmcnt(2)
    v_mfma_f32_16x16x32_bf16 v[80:83], v[100:103], v[240:243], v[80:83]
    v_mfma_f32_16x16x32_bf16 v[84:87], v[100:103], v[244:247], v[84:87]
    ds_read_b64_tr_b16 v[112:113], v133 offset:40960
    ds_read_b64_tr_b16 v[114:115], v133 offset:41472
    v_mul_f32 v60, v60, v1
    v_mul_f32 v61, v61, v2
    v_mul_f32 v62, v62, v3
    s_waitcnt lgkmcnt(2)
    v_mfma_f32_16x16x32_bf16 v[72:75], v[108:111], v[240:243], v[72:75]
    v_mfma_f32_16x16x32_bf16 v[76:79], v[108:111], v[244:247], v[76:79]
    ds_read_b64_tr_b16 v[96:97], v132 offset:36864
    ds_read_b64_tr_b16 v[98:99], v132 offset:37376
    v_mul_f32 v63, v63, v4
    v_cvt_pk_bf16_f32 v142, v60, v61
    v_cvt_pk_bf16_f32 v143, v62, v63
    s_waitcnt lgkmcnt(2)
    v_mfma_f32_16x16x32_bf16 v[88:91], v[112:115], v[240:243], v[88:91]
    v_mfma_f32_16x16x32_bf16 v[92:95], v[112:115], v[244:247], v[92:95]
    ds_read_b64_tr_b16 v[100:101], v133 offset:36864
    ds_read_b64_tr_b16 v[102:103], v133 offset:37376
    s_add_u32 s59, s63, 1024
    v_permlane16_swap_b32 v140, v142
    v_permlane16_swap_b32 v141, v143
    buffer_store_dwordx4 v[140:143], v134, s[28:31], s59 offen sc1
    s_add_u32 m0, s80, 10240
    s_add_u32 s0, s82, 71680
    buffer_load_dwordx4 v9, s[72:75], s0 offen lds
    buffer_load_dwordx4 v10, s[72:75], s0 offen offset:1024 lds
    s_waitcnt lgkmcnt(2)
    v_mfma_f32_16x16x32_bf16 v[64:67], v[96:99], v[248:251], v[64:67]
    v_mfma_f32_16x16x32_bf16 v[68:71], v[96:99], v[252:255], v[68:71]
    ds_read_b64_tr_b16 v[108:109], v132 offset:45056
    ds_read_b64_tr_b16 v[110:111], v132 offset:45568
    s_waitcnt lgkmcnt(2)
    v_mfma_f32_16x16x32_bf16 v[80:83], v[100:103], v[248:251], v[80:83]
    v_mfma_f32_16x16x32_bf16 v[84:87], v[100:103], v[252:255], v[84:87]
    ds_read_b64_tr_b16 v[112:113], v133 offset:45056
    ds_read_b64_tr_b16 v[114:115], v133 offset:45568
    s_waitcnt lgkmcnt(0)
    v_mfma_f32_16x16x32_bf16 v[72:75], v[108:111], v[248:251], v[72:75]
    v_mfma_f32_16x16x32_bf16 v[76:79], v[108:111], v[252:255], v[76:79]
    s_barrier
    v_mfma_f32_16x16x32_bf16 v[88:91], v[112:115], v[248:251], v[88:91]
    v_mfma_f32_16x16x32_bf16 v[92:95], v[112:115], v[252:255], v[92:95]
    s_branch gated_mix__mha_block__glu_gated_geglu__prompt_kernel_g_e2
gated_mix__mha_block__glu_gated_geglu__prompt_kernel_V0_7:
    s_waitcnt lgkmcnt(10)
    v_mfma_f32_16x16x32_bf16 v[16:19], v[144:147], v[108:111], 0
    v_mfma_f32_16x16x32_bf16 v[24:27], v[148:151], v[108:111], 0
    ds_read_b128 v[152:155], v126 offset:0
    ds_read_b128 v[156:159], v126 offset:2048
    ds_read_b64_tr_b16 v[96:97], v129 offset:4096
    ds_read_b64_tr_b16 v[98:99], v129 offset:4608
    s_add_u32 m0, s58, 32768
    s_add_u32 s64, s54, 256
    buffer_load_dwordx4 v120, s[32:35], s64 offen lds
    buffer_load_dwordx4 v121, s[32:35], s64 offen offset:1024 lds
    s_waitcnt lgkmcnt(12)
    v_mfma_f32_16x16x32_bf16 v[32:35], v[112:115], v[144:147], 0
    v_mfma_f32_16x16x32_bf16 v[36:39], v[112:115], v[148:151], 0
    ds_read_b64_tr_b16 v[100:101], v130 offset:4096
    ds_read_b64_tr_b16 v[102:103], v130 offset:4608
    s_add_u32 m0, s58, 40960
    s_add_u32 s64, s54, 57600
    buffer_load_dwordx4 v120, s[32:35], s64 offen lds
    buffer_load_dwordx4 v121, s[32:35], s64 offen offset:1024 lds
    s_add_u32 m0, s57, 81920
    s_add_u32 s64, s55, 344064
    buffer_load_dwordx4 v122, s[36:39], s64 offen lds
    s_waitcnt lgkmcnt(12)
    v_mfma_f32_16x16x32_bf16 v[48:51], v[116:119], v[144:147], 0
    v_mfma_f32_16x16x32_bf16 v[52:55], v[116:119], v[148:151], 0
    ds_read_b64_tr_b16 v[104:105], v131 offset:4096
    ds_read_b64_tr_b16 v[106:107], v131 offset:4608
    s_add_u32 m0, s57, 86016
    s_add_u32 s64, s55, 430080
    buffer_load_dwordx4 v122, s[36:39], s64 offen lds
    s_waitcnt lgkmcnt(12)
    v_mfma_f32_16x16x32_bf16 v[20:23], v[144:147], v[64:67], 0
    v_mfma_f32_16x16x32_bf16 v[28:31], v[148:151], v[64:67], 0
    ds_read_b64_tr_b16 v[108:109], v127 offset:4096
    ds_read_b64_tr_b16 v[110:111], v127 offset:4608
    s_add_u32 m0, s57, 131072
    s_add_u32 s64, s56, 458752
    buffer_load_dwordx4 v123, s[40:43], s64 offen lds
    s_waitcnt lgkmcnt(12)
    v_mfma_f32_16x16x32_bf16 v[40:43], v[68:71], v[144:147], 0
    v_mfma_f32_16x16x32_bf16 v[44:47], v[68:71], v[148:151], 0
    ds_read_b64_tr_b16 v[112:113], v130 offset:12288
    ds_read_b64_tr_b16 v[114:115], v130 offset:12800
    s_add_u32 m0, s57, 135168
    s_add_u32 s64, s56, 573440
    buffer_load_dwordx4 v123, s[40:43], s64 offen lds
    s_add_u32 m0, s57, 139264
    s_add_u32 s64, s56, 458752
    buffer_load_dwordx4 v123, s[44:47], s64 offen lds
    s_waitcnt lgkmcnt(12)
    v_mfma_f32_16x16x32_bf16 v[56:59], v[72:75], v[144:147], 0
    v_mfma_f32_16x16x32_bf16 v[60:63], v[72:75], v[148:151], 0
    ds_read_b64_tr_b16 v[116:117], v131 offset:12288
    ds_read_b64_tr_b16 v[118:119], v131 offset:12800
    s_add_u32 m0, s57, 143360
    s_add_u32 s64, s56, 573440
    buffer_load_dwordx4 v123, s[44:47], s64 offen lds
    s_waitcnt lgkmcnt(0)
    v_mfma_f32_16x16x32_bf16 v[16:19], v[152:155], v[96:99], v[16:19]
    v_mfma_f32_16x16x32_bf16 v[24:27], v[156:159], v[96:99], v[24:27]
    s_waitcnt vmcnt(16)
    s_barrier
    ds_read_b128 v[160:163], v125 offset:16384
    ds_read_b128 v[164:167], v125 offset:18432
    ds_read_b64_tr_b16 v[64:65], v129 offset:8192
    ds_read_b64_tr_b16 v[66:67], v129 offset:8704
    v_mfma_f32_16x16x32_bf16 v[32:35], v[100:103], v[152:155], v[32:35]
    v_mfma_f32_16x16x32_bf16 v[36:39], v[100:103], v[156:159], v[36:39]
    ds_read_b64_tr_b16 v[68:69], v130 offset:16384
    ds_read_b64_tr_b16 v[70:71], v130 offset:16896
    s_add_u32 m0, s58, 49152
    s_add_u32 s64, s54, 384
    buffer_load_dwordx4 v120, s[32:35], s64 offen lds
    buffer_load_dwordx4 v121, s[32:35], s64 offen offset:1024 lds
    v_mfma_f32_16x16x32_bf16 v[48:51], v[104:107], v[152:155], v[48:51]
    v_mfma_f32_16x16x32_bf16 v[52:55], v[104:107], v[156:159], v[52:55]
    ds_read_b64_tr_b16 v[72:73], v131 offset:16384
    ds_read_b64_tr_b16 v[74:75], v131 offset:16896
    s_add_u32 m0, s58, 57344
    s_add_u32 s64, s54, 57728
    buffer_load_dwordx4 v120, s[32:35], s64 offen lds
    buffer_load_dwordx4 v121, s[32:35], s64 offen offset:1024 lds
    v_mfma_f32_16x16x32_bf16 v[20:23], v[152:155], v[108:111], v[20:23]
    v_mfma_f32_16x16x32_bf16 v[28:31], v[156:159], v[108:111], v[28:31]
    ds_read_b64_tr_b16 v[96:97], v127 offset:8192
    ds_read_b64_tr_b16 v[98:99], v127 offset:8704
    v_mfma_f32_16x16x32_bf16 v[40:43], v[112:115], v[152:155], v[40:43]
    v_mfma_f32_16x16x32_bf16 v[44:47], v[112:115], v[156:159], v[44:47]
    ds_read_b64_tr_b16 v[100:101], v130 offset:24576
    ds_read_b64_tr_b16 v[102:103], v130 offset:25088
    s_add_u32 m0, s57, 90112
    s_add_u32 s64, s55, 516096
    buffer_load_dwordx4 v122, s[36:39], s64 offen lds
    v_mfma_f32_16x16x32_bf16 v[56:59], v[116:119], v[152:155], v[56:59]
    v_mfma_f32_16x16x32_bf16 v[60:63], v[116:119], v[156:159], v[60:63]
    ds_read_b64_tr_b16 v[104:105], v131 offset:24576
    ds_read_b64_tr_b16 v[106:107], v131 offset:25088
    s_add_u32 m0, s57, 94208
    s_add_u32 s64, s55, 602112
    buffer_load_dwordx4 v122, s[36:39], s64 offen lds
    s_waitcnt lgkmcnt(6)
    v_mfma_f32_16x16x32_bf16 v[16:19], v[160:163], v[64:67], v[16:19]
    v_mfma_f32_16x16x32_bf16 v[24:27], v[164:167], v[64:67], v[24:27]
    ds_read_b128 v[168:171], v126 offset:16384
    ds_read_b128 v[172:175], v126 offset:18432
    ds_read_b64_tr_b16 v[108:109], v129 offset:12288
    ds_read_b64_tr_b16 v[110:111], v129 offset:12800
    v_mfma_f32_16x16x32_bf16 v[32:35], v[68:71], v[160:163], v[32:35]
    v_mfma_f32_16x16x32_bf16 v[36:39], v[68:71], v[164:167], v[36:39]
    ds_read_b64_tr_b16 v[112:113], v130 offset:20480
    ds_read_b64_tr_b16 v[114:115], v130 offset:20992
    s_add_u32 m0, s57, 147456
    s_add_u32 s64, s56, 688128
    buffer_load_dwordx4 v123, s[40:43], s64 offen lds
    v_mfma_f32_16x16x32_bf16 v[48:51], v[72:75], v[160:163], v[48:51]
    v_mfma_f32_16x16x32_bf16 v[52:55], v[72:75], v[164:167], v[52:55]
    ds_read_b64_tr_b16 v[116:117], v131 offset:20480
    ds_read_b64_tr_b16 v[118:119], v131 offset:20992
    s_add_u32 m0, s57, 151552
    s_add_u32 s64, s56, 802816
    buffer_load_dwordx4 v123, s[40:43], s64 offen lds
    s_waitcnt lgkmcnt(8)
    v_mfma_f32_16x16x32_bf16 v[20:23], v[160:163], v[96:99], v[20:23]
    v_mfma_f32_16x16x32_bf16 v[28:31], v[164:167], v[96:99], v[28:31]
    ds_read_b64_tr_b16 v[64:65], v127 offset:12288
    ds_read_b64_tr_b16 v[66:67], v127 offset:12800
    v_mfma_f32_16x16x32_bf16 v[40:43], v[100:103], v[160:163], v[40:43]
    v_mfma_f32_16x16x32_bf16 v[44:47], v[100:103], v[164:167], v[44:47]
    ds_read_b64_tr_b16 v[68:69], v130 offset:28672
    ds_read_b64_tr_b16 v[70:71], v130 offset:29184
    s_add_u32 m0, s57, 155648
    s_add_u32 s64, s56, 688128
    buffer_load_dwordx4 v123, s[44:47], s64 offen lds
    v_mfma_f32_16x16x32_bf16 v[56:59], v[104:107], v[160:163], v[56:59]
    v_mfma_f32_16x16x32_bf16 v[60:63], v[104:107], v[164:167], v[60:63]
    ds_read_b64_tr_b16 v[72:73], v131 offset:28672
    ds_read_b64_tr_b16 v[74:75], v131 offset:29184
    s_add_u32 m0, s57, 159744
    s_add_u32 s64, s56, 802816
    buffer_load_dwordx4 v123, s[44:47], s64 offen lds
    s_waitcnt lgkmcnt(0)
    v_mfma_f32_16x16x32_bf16 v[16:19], v[168:171], v[108:111], v[16:19]
    v_mfma_f32_16x16x32_bf16 v[24:27], v[172:175], v[108:111], v[24:27]
    s_waitcnt vmcnt(10)
    s_barrier
    ds_read_b128 v[176:179], v125 offset:32768
    ds_read_b128 v[180:183], v125 offset:34816
    ds_read_b64_tr_b16 v[96:97], v129 offset:16384
    ds_read_b64_tr_b16 v[98:99], v129 offset:16896
    v_mfma_f32_16x16x32_bf16 v[32:35], v[112:115], v[168:171], v[32:35]
    v_mfma_f32_16x16x32_bf16 v[36:39], v[112:115], v[172:175], v[36:39]
    ds_read_b64_tr_b16 v[100:101], v130 offset:32768
    ds_read_b64_tr_b16 v[102:103], v130 offset:33280
    s_add_u32 m0, s58, 0
    s_add_u32 s64, s54, 512
    buffer_load_dwordx4 v120, s[32:35], s64 offen lds
    buffer_load_dwordx4 v121, s[32:35], s64 offen offset:1024 lds
    v_mfma_f32_16x16x32_bf16 v[48:51], v[116:119], v[168:171], v[48:51]
    v_mfma_f32_16x16x32_bf16 v[52:55], v[116:119], v[172:175], v[52:55]
    ds_read_b64_tr_b16 v[104:105], v131 offset:32768
    ds_read_b64_tr_b16 v[106:107], v131 offset:33280
    s_add_u32 m0, s58, 8192
    s_add_u32 s64, s54, 57856
    buffer_load_dwordx4 v120, s[32:35], s64 offen lds
    buffer_load_dwordx4 v121, s[32:35], s64 offen offset:1024 lds
    v_mfma_f32_16x16x32_bf16 v[20:23], v[168:171], v[64:67], v[20:23]
    v_mfma_f32_16x16x32_bf16 v[28:31], v[172:175], v[64:67], v[28:31]
    ds_read_b64_tr_b16 v[108:109], v127 offset:16384
    ds_read_b64_tr_b16 v[110:111], v127 offset:16896
    v_mfma_f32_16x16x32_bf16 v[40:43], v[68:71], v[168:171], v[40:43]
    v_mfma_f32_16x16x32_bf16 v[44:47], v[68:71], v[172:175], v[44:47]
    ds_read_b64_tr_b16 v[112:113], v130 offset:40960
    ds_read_b64_tr_b16 v[114:115], v130 offset:41472
    s_add_u32 m0, s57, 65536
    s_add_u32 s64, s55, 688128
    buffer_load_dwordx4 v122, s[36:39], s64 offen lds
    v_mfma_f32_16x16x32_bf16 v[56:59], v[72:75], v[168:171], v[56:59]
    v_mfma_f32_16x16x32_bf16 v[60:63], v[72:75], v[172:175], v[60:63]
    ds_read_b64_tr_b16 v[116:117], v131 offset:40960
    ds_read_b64_tr_b16 v[118:119], v131 offset:41472
    s_add_u32 m0, s57, 69632
    s_add_u32 s64, s55, 774144
    buffer_load_dwordx4 v122, s[36:39], s64 offen lds
    s_waitcnt lgkmcnt(6)
    v_mfma_f32_16x16x32_bf16 v[16:19], v[176:179], v[96:99], v[16:19]
    v_mfma_f32_16x16x32_bf16 v[24:27], v[180:183], v[96:99], v[24:27]
    ds_read_b128 v[184:187], v126 offset:32768
    ds_read_b128 v[188:191], v126 offset:34816
    ds_read_b64_tr_b16 v[64:65], v129 offset:20480
    ds_read_b64_tr_b16 v[66:67], v129 offset:20992
    v_mfma_f32_16x16x32_bf16 v[32:35], v[100:103], v[176:179], v[32:35]
    v_mfma_f32_16x16x32_bf16 v[36:39], v[100:103], v[180:183], v[36:39]
    ds_read_b64_tr_b16 v[68:69], v130 offset:36864
    ds_read_b64_tr_b16 v[70:71], v130 offset:37376
    s_add_u32 m0, s57, 98304
    s_add_u32 s64, s56, 917504
    buffer_load_dwordx4 v123, s[40:43], s64 offen lds
    v_mfma_f32_16x16x32_bf16 v[48:51], v[104:107], v[176:179], v[48:51]
    v_mfma_f32_16x16x32_bf16 v[52:55], v[104:107], v[180:183], v[52:55]
    ds_read_b64_tr_b16 v[72:73], v131 offset:36864
    ds_read_b64_tr_b16 v[74:75], v131 offset:37376
    s_add_u32 m0, s57, 102400
    s_add_u32 s64, s56, 1032192
    buffer_load_dwordx4 v123, s[40:43], s64 offen lds
    s_waitcnt lgkmcnt(8)
    v_mfma_f32_16x16x32_bf16 v[20:23], v[176:179], v[108:111], v[20:23]
    v_mfma_f32_16x16x32_bf16 v[28:31], v[180:183], v[108:111], v[28:31]
    ds_read_b64_tr_b16 v[96:97], v127 offset:20480
    ds_read_b64_tr_b16 v[98:99], v127 offset:20992
    v_mov_b32 v1, 0
    v_mfma_f32_16x16x32_bf16 v[40:43], v[112:115], v[176:179], v[40:43]
    v_mfma_f32_16x16x32_bf16 v[44:47], v[112:115], v[180:183], v[44:47]
    ds_read_b64_tr_b16 v[100:101], v130 offset:45056
    ds_read_b64_tr_b16 v[102:103], v130 offset:45568
    s_add_u32 m0, s57, 106496
    s_add_u32 s64, s56, 917504
    buffer_load_dwordx4 v123, s[44:47], s64 offen lds
    v_dot2_f32_bf16 v1, v136, v140, v1
    v_mfma_f32_16x16x32_bf16 v[56:59], v[116:119], v[176:179], v[56:59]
    v_mfma_f32_16x16x32_bf16 v[60:63], v[116:119], v[180:183], v[60:63]
    ds_read_b64_tr_b16 v[104:105], v131 offset:45056
    ds_read_b64_tr_b16 v[106:107], v131 offset:45568
    s_add_u32 m0, s57, 110592
    s_add_u32 s64, s56, 1032192
    buffer_load_dwordx4 v123, s[44:47], s64 offen lds
    v_dot2_f32_bf16 v1, v137, v141, v1
    s_waitcnt lgkmcnt(0)
    v_mfma_f32_16x16x32_bf16 v[16:19], v[184:187], v[64:67], v[16:19]
    v_mfma_f32_16x16x32_bf16 v[24:27], v[188:191], v[64:67], v[24:27]
    s_waitcnt vmcnt(10)
    s_barrier
    ds_read_b128 v[192:195], v125 offset:49152
    ds_read_b128 v[196:199], v125 offset:51200
    ds_read_b64_tr_b16 v[108:109], v129 offset:24576
    ds_read_b64_tr_b16 v[110:111], v129 offset:25088
    v_dot2_f32_bf16 v1, v138, v142, v1
    v_mfma_f32_16x16x32_bf16 v[32:35], v[68:71], v[184:187], v[32:35]
    v_mfma_f32_16x16x32_bf16 v[36:39], v[68:71], v[188:191], v[36:39]
    ds_read_b64_tr_b16 v[112:113], v130 offset:49152
    ds_read_b64_tr_b16 v[114:115], v130 offset:49664
    s_add_u32 m0, s58, 16384
    s_add_u32 s64, s54, 640
    buffer_load_dwordx4 v120, s[32:35], s64 offen lds
    buffer_load_dwordx4 v121, s[32:35], s64 offen offset:1024 lds
    v_dot2_f32_bf16 v1, v139, v143, v1
    s_nop 2
    v_add_f32_dpp v1, v1, v1 row_shr:1 row_mask:0xf bank_mask:0xf
    v_mfma_f32_16x16x32_bf16 v[48:51], v[72:75], v[184:187], v[48:51]
    v_mfma_f32_16x16x32_bf16 v[52:55], v[72:75], v[188:191], v[52:55]
    ds_read_b64_tr_b16 v[116:117], v131 offset:49152
    ds_read_b64_tr_b16 v[118:119], v131 offset:49664
    s_add_u32 m0, s58, 24576
    s_add_u32 s64, s54, 57984
    buffer_load_dwordx4 v120, s[32:35], s64 offen lds
    buffer_load_dwordx4 v121, s[32:35], s64 offen offset:1024 lds
    v_add_f32_dpp v1, v1, v1 row_shr:2 row_mask:0xf bank_mask:0xf
    v_mfma_f32_16x16x32_bf16 v[20:23], v[184:187], v[96:99], v[20:23]
    v_mfma_f32_16x16x32_bf16 v[28:31], v[188:191], v[96:99], v[28:31]
    ds_read_b64_tr_b16 v[64:65], v127 offset:24576
    ds_read_b64_tr_b16 v[66:67], v127 offset:25088
    v_add_f32_dpp v1, v1, v1 row_shr:4 row_mask:0xf bank_mask:0xf
    v_mfma_f32_16x16x32_bf16 v[40:43], v[100:103], v[184:187], v[40:43]
    v_mfma_f32_16x16x32_bf16 v[44:47], v[100:103], v[188:191], v[44:47]
    ds_read_b64_tr_b16 v[68:69], v130 offset:57344
    ds_read_b64_tr_b16 v[70:71], v130 offset:57856
    s_add_u32 m0, s57, 73728
    s_add_u32 s64, s55, 860160
    buffer_load_dwordx4 v122, s[36:39], s64 offen lds
    v_add_f32_dpp v1, v1, v1 row_shr:8 row_mask:0xf bank_mask:0xf
    v_mfma_f32_16x16x32_bf16 v[56:59], v[104:107], v[184:187], v[56:59]
    v_mfma_f32_16x16x32_bf16 v[60:63], v[104:107], v[188:191], v[60:63]
    ds_read_b64_tr_b16 v[72:73], v131 offset:57344
    ds_read_b64_tr_b16 v[74:75], v131 offset:57856
    s_add_u32 m0, s57, 77824
    s_add_u32 s64, s55, 946176
    buffer_load_dwordx4 v122, s[36:39], s64 offen lds
    v_add_f32_dpp v1, v1, v1 row_bcast:15 row_mask:0xa bank_mask:0xf
    s_waitcnt lgkmcnt(6)
    v_mfma_f32_16x16x32_bf16 v[16:19], v[192:195], v[108:111], v[16:19]
    v_mfma_f32_16x16x32_bf16 v[24:27], v[196:199], v[108:111], v[24:27]
    ds_read_b128 v[200:203], v126 offset:49152
    ds_read_b128 v[204:207], v126 offset:51200
    ds_read_b64_tr_b16 v[96:97], v129 offset:28672
    ds_read_b64_tr_b16 v[98:99], v129 offset:29184
    v_add_f32_dpp v1, v1, v1 row_bcast:31 row_mask:0xc bank_mask:0xf
    v_mul_f32 v1, 0xbfb8aa3b, v1
    v_mfma_f32_16x16x32_bf16 v[32:35], v[112:115], v[192:195], v[32:35]
    v_mfma_f32_16x16x32_bf16 v[36:39], v[112:115], v[196:199], v[36:39]
    ds_read_b64_tr_b16 v[100:101], v130 offset:53248
    ds_read_b64_tr_b16 v[102:103], v130 offset:53760
    s_add_u32 m0, s57, 114688
    s_add_u32 s64, s56, 1146880
    buffer_load_dwordx4 v123, s[40:43], s64 offen lds
    v_exp_f32 v1, v1
    v_mfma_f32_16x16x32_bf16 v[48:51], v[116:119], v[192:195], v[48:51]
    v_mfma_f32_16x16x32_bf16 v[52:55], v[116:119], v[196:199], v[52:55]
    ds_read_b64_tr_b16 v[104:105], v131 offset:53248
    ds_read_b64_tr_b16 v[106:107], v131 offset:53760
    s_add_u32 m0, s57, 118784
    s_add_u32 s64, s56, 1261568
    buffer_load_dwordx4 v123, s[40:43], s64 offen lds
    s_lshl_b32 s3, s3, 2
    s_waitcnt lgkmcnt(8)
    v_mfma_f32_16x16x32_bf16 v[20:23], v[192:195], v[64:67], v[20:23]
    v_mfma_f32_16x16x32_bf16 v[28:31], v[196:199], v[64:67], v[28:31]
    ds_read_b64_tr_b16 v[108:109], v127 offset:28672
    ds_read_b64_tr_b16 v[110:111], v127 offset:29184
    v_add_f32 v1, 1.0, v1
    v_mfma_f32_16x16x32_bf16 v[40:43], v[68:71], v[192:195], v[40:43]
    v_mfma_f32_16x16x32_bf16 v[44:47], v[68:71], v[196:199], v[44:47]
    ds_read_b64_tr_b16 v[112:113], v130 offset:61440
    ds_read_b64_tr_b16 v[114:115], v130 offset:61952
    s_add_u32 m0, s57, 122880
    s_add_u32 s64, s56, 1146880
    buffer_load_dwordx4 v123, s[44:47], s64 offen lds
    v_rcp_f32 v1, v1
    v_mfma_f32_16x16x32_bf16 v[56:59], v[72:75], v[192:195], v[56:59]
    v_mfma_f32_16x16x32_bf16 v[60:63], v[72:75], v[196:199], v[60:63]
    ds_read_b64_tr_b16 v[116:117], v131 offset:61440
    ds_read_b64_tr_b16 v[118:119], v131 offset:61952
    s_add_u32 m0, s57, 126976
    s_add_u32 s64, s56, 1261568
    buffer_load_dwordx4 v123, s[44:47], s64 offen lds
    s_add_u32 s3, s3, 14942208
    s_mov_b32 exec_lo, 0
    s_mov_b32 exec_hi, 0x80000000
    buffer_store_dword v1, off, s[28:31], s3 sc1
    s_mov_b64 exec, -1
    s_waitcnt lgkmcnt(0)
    v_mfma_f32_16x16x32_bf16 v[16:19], v[200:203], v[96:99], v[16:19]
    v_mfma_f32_16x16x32_bf16 v[24:27], v[204:207], v[96:99], v[24:27]
    s_waitcnt vmcnt(11)
    s_barrier
    ds_read_b128 v[208:211], v125 offset:0
    ds_read_b128 v[212:215], v125 offset:2048
    ds_read_b64_tr_b16 v[64:65], v129 offset:0
    ds_read_b64_tr_b16 v[66:67], v129 offset:512
    s_lshl_b32 s0, s52, 2
    s_add_u32 s0, s0, s60
    v_mfma_f32_16x16x32_bf16 v[32:35], v[100:103], v[200:203], v[32:35]
    v_mfma_f32_16x16x32_bf16 v[36:39], v[100:103], v[204:207], v[36:39]
    ds_read_b64_tr_b16 v[68:69], v130 offset:0
    ds_read_b64_tr_b16 v[70:71], v130 offset:512
    s_add_u32 m0, s58, 32768
    s_add_u32 s64, s54, 768
    buffer_load_dwordx4 v120, s[32:35], s64 offen lds
    buffer_load_dwordx4 v121, s[32:35], s64 offen offset:1024 lds
    s_mul_i32 s62, s0, 28672
    s_mul_i32 s63, s0, 114688
    s_lshl_b32 s0, s53, 13
    v_mfma_f32_16x16x32_bf16 v[48:51], v[104:107], v[200:203], v[48:51]
    v_mfma_f32_16x16x32_bf16 v[52:55], v[104:107], v[204:207], v[52:55]
    ds_read_b64_tr_b16 v[72:73], v131 offset:0
    ds_read_b64_tr_b16 v[74:75], v131 offset:512
    s_add_u32 m0, s58, 40960
    s_add_u32 s64, s54, 58112
    buffer_load_dwordx4 v120, s[32:35], s64 offen lds
    buffer_load_dwordx4 v121, s[32:35], s64 offen offset:1024 lds
    s_add_u32 s63, s63, s0
    s_add_u32 s63, s63, 5505024
    s_lshl_b32 s0, s53, 10
    v_mfma_f32_16x16x32_bf16 v[20:23], v[200:203], v[108:111], v[20:23]
    v_mfma_f32_16x16x32_bf16 v[28:31], v[204:207], v[108:111], v[28:31]
    ds_read_b64_tr_b16 v[96:97], v127 offset:0
    ds_read_b64_tr_b16 v[98:99], v127 offset:512
    s_add_u32 s62, s62, s0
    s_add_u32 s62, s62, 3662848
    v_lshrrev_b32 v135, 5, v0
    v_mfma_f32_16x16x32_bf16 v[40:43], v[112:115], v[200:203], v[40:43]
    v_mfma_f32_16x16x32_bf16 v[44:47], v[112:115], v[204:207], v[44:47]
    ds_read_b64_tr_b16 v[100:101], v130 offset:8192
    ds_read_b64_tr_b16 v[102:103], v130 offset:8704
    s_add_u32 m0, s57, 81920
    s_add_u32 s64, s55, 1032192
    buffer_load_dwordx4 v122, s[36:39], s64 offen lds
    v_mul_u32_u24 v135, 6656, v135
    v_add_u32 v135, v135, v134
    s_and_b32 s0, s2, 7
    v_mfma_f32_16x16x32_bf16 v[56:59], v[116:119], v[200:203], v[56:59]
    v_mfma_f32_16x16x32_bf16 v[60:63], v[116:119], v[204:207], v[60:63]
    ds_read_b64_tr_b16 v[104:105], v131 offset:8192
    ds_read_b64_tr_b16 v[106:107], v131 offset:8704
    s_add_u32 m0, s57, 86016
    s_add_u32 s64, s55, 1118208
    buffer_load_dwordx4 v122, s[36:39], s64 offen lds
    s_lshr_b32 s1, s2, 3
    s_lshl_b32 s66, s0, 1
    s_lshr_b32 s67, s2, 7
    s_waitcnt lgkmcnt(6)
    v_mfma_f32_16x16x32_bf16 v[16:19], v[208:211], v[64:67], v[16:19]
    v_mfma_f32_16x16x32_bf16 v[24:27], v[212:215], v[64:67], v[24:27]
    ds_read_b128 v[216:219], v126 offset:0
    ds_read_b128 v[220:223], v126 offset:2048
    ds_read_b64_tr_b16 v[108:109], v129 offset:4096
    ds_read_b64_tr_b16 v[110:111], v129 offset:4608
    s_add_u32 s66, s66, s67
    s_and_b32 s67, s1, 15
    s_and_b32 s70, s26, 3
    v_mfma_f32_16x16x32_bf16 v[32:35], v[68:71], v[208:211], v[32:35]
    v_mfma_f32_16x16x32_bf16 v[36:39], v[68:71], v[212:215], v[36:39]
    ds_read_b64_tr_b16 v[112:113], v130 offset:4096
    ds_read_b64_tr_b16 v[114:115], v130 offset:4608
    s_add_u32 m0, s57, 131072
    s_add_u32 s64, s56, 1376256
    buffer_load_dwordx4 v123, s[40:43], s64 offen lds
    s_lshl_b32 s0, s26, 8
    s_add_u32 s0, s0, 155648
    v_lshl_add_u32 v14, v0, 2, s0
    v_mfma_f32_16x16x32_bf16 v[48:51], v[72:75], v[208:211], v[48:51]
    v_mfma_f32_16x16x32_bf16 v[52:55], v[72:75], v[212:215], v[52:55]
    ds_read_b64_tr_b16 v[116:117], v131 offset:4096
    ds_read_b64_tr_b16 v[118:119], v131 offset:4608
    s_add_u32 m0, s57, 135168
    s_add_u32 s64, s56, 1490944
    buffer_load_dwordx4 v123, s[40:43], s64 offen lds
    s_lshr_b32 s0, s2, 3
    s_bitcmp1_b32 s2, 0
    s_cselect_b32 s1, 32, 0
    s_cselect_b32 s69, 24, 32
    s_cmp_ge_u32 s0, s69
    s_cselect_b32 s69, 7, 0
    s_waitcnt lgkmcnt(8)
    v_mfma_f32_16x16x32_bf16 v[20:23], v[208:211], v[96:99], v[20:23]
    v_mfma_f32_16x16x32_bf16 v[28:31], v[212:215], v[96:99], v[28:31]
    ds_read_b64_tr_b16 v[64:65], v127 offset:4096
    ds_read_b64_tr_b16 v[66:67], v127 offset:4608
    s_add_u32 s0, s0, s1
    s_mul_i32 s68, s0, 9363
    s_lshr_b32 s68, s68, 16
    v_mfma_f32_16x16x32_bf16 v[40:43], v[100:103], v[208:211], v[40:43]
    v_mfma_f32_16x16x32_bf16 v[44:47], v[100:103], v[212:215], v[44:47]
    ds_read_b64_tr_b16 v[68:69], v130 offset:12288
    ds_read_b64_tr_b16 v[70:71], v130 offset:12800
    s_add_u32 m0, s57, 139264
    s_add_u32 s64, s56, 1376256
    buffer_load_dwordx4 v123, s[44:47], s64 offen lds
    s_mul_i32 s1, s68, 7
    s_sub_u32 s0, s0, s1
    s_or_b32 s69, s69, s0
    v_mfma_f32_16x16x32_bf16 v[56:59], v[104:107], v[208:211], v[56:59]
    v_mfma_f32_16x16x32_bf16 v[60:63], v[104:107], v[212:215], v[60:63]
    ds_read_b64_tr_b16 v[72:73], v131 offset:12288
    ds_read_b64_tr_b16 v[74:75], v131 offset:12800
    s_add_u32 m0, s57, 143360
    s_add_u32 s64, s56, 1490944
    buffer_load_dwordx4 v123, s[44:47], s64 offen lds
    s_min_u32 s68, s68, 7
    s_bfe_u32 s0, s2, 0x20001
    s_lshl_b32 s0, s0, 3
    s_waitcnt lgkmcnt(0)
    v_mfma_f32_16x16x32_bf16 v[16:19], v[216:219], v[108:111], v[16:19]
    v_mfma_f32_16x16x32_bf16 v[24:27], v[220:223], v[108:111], v[24:27]
    s_waitcnt vmcnt(11)
    s_barrier
    ds_read_b128 v[224:227], v125 offset:16384
    ds_read_b128 v[228:231], v125 offset:18432
    ds_read_b64_tr_b16 v[96:97], v129 offset:8192
    ds_read_b64_tr_b16 v[98:99], v129 offset:8704
    s_add_u32 s68, s68, s0
    s_mul_i32 s0, s66, 28
    s_add_u32 s1, s0, 27
    v_mfma_f32_16x16x32_bf16 v[32:35], v[112:115], v[216:219], v[32:35]
    v_mfma_f32_16x16x32_bf16 v[36:39], v[112:115], v[220:223], v[36:39]
    ds_read_b64_tr_b16 v[100:101], v130 offset:16384
    ds_read_b64_tr_b16 v[102:103], v130 offset:16896
    s_add_u32 m0, s57, 49152
    s_add_u32 s64, s56, 128
    buffer_load_dwordx4 v123, s[40:43], s64 offen lds
    s_lshr_b32 s80, s0, 6
    s_lshr_b32 s81, s1, 6
    s_sub_u32 s81, s81, s80
    v_mfma_f32_16x16x32_bf16 v[48:51], v[116:119], v[216:219], v[48:51]
    v_mfma_f32_16x16x32_bf16 v[52:55], v[116:119], v[220:223], v[52:55]
    ds_read_b64_tr_b16 v[104:105], v131 offset:16384
    ds_read_b64_tr_b16 v[106:107], v131 offset:16896
    s_add_u32 m0, s57, 53248
    s_add_u32 s64, s56, 114816
    buffer_load_dwordx4 v123, s[40:43], s64 offen lds
    v_and_b32 v5, 1, v0
    v_mul_u32_u24 v5, s81, v5
    v_bfe_u32 v6, v0, 1, 1
    v_mfma_f32_16x16x32_bf16 v[20:23], v[216:219], v[64:67], v[20:23]
    v_mfma_f32_16x16x32_bf16 v[28:31], v[220:223], v[64:67], v[28:31]
    ds_read_b64_tr_b16 v[108:109], v127 offset:8192
    ds_read_b64_tr_b16 v[110:111], v127 offset:8704
    v_mad_u32_u24 v5, v6, 7, v5
    v_bfe_u32 v6, v0, 2, 2
    v_lshl_add_u32 v5, v6, 4, v5
    v_mfma_f32_16x16x32_bf16 v[40:43], v[68:71], v[216:219], v[40:43]
    v_mfma_f32_16x16x32_bf16 v[44:47], v[68:71], v[220:223], v[44:47]
    ds_read_b64_tr_b16 v[112:113], v130 offset:24576
    ds_read_b64_tr_b16 v[114:115], v130 offset:25088
    s_add_u32 m0, s57, 57344
    s_add_u32 s64, s56, 128
    buffer_load_dwordx4 v123, s[44:47], s64 offen lds
    s_lshl_b32 s81, s70, 6
    s_add_u32 s81, s81, s80
    v_add_u32 v5, s81, v5
    v_mfma_f32_16x16x32_bf16 v[56:59], v[72:75], v[216:219], v[56:59]
    v_mfma_f32_16x16x32_bf16 v[60:63], v[72:75], v[220:223], v[60:63]
    ds_read_b64_tr_b16 v[116:117], v131 offset:24576
    ds_read_b64_tr_b16 v[118:119], v131 offset:25088
    s_add_u32 m0, s57, 61440
    s_add_u32 s64, s56, 114816
    buffer_load_dwordx4 v123, s[44:47], s64 offen lds
    s_lshl_b32 s81, s67, 4
    s_lshr_b32 s0, s66, 3
    s_add_u32 s0, s0, s81
    s_waitcnt lgkmcnt(6)
    v_mfma_f32_16x16x32_bf16 v[16:19], v[224:227], v[96:99], v[16:19]
    v_mfma_f32_16x16x32_bf16 v[24:27], v[228:231], v[96:99], v[24:27]
    ds_read_b128 v[232:235], v126 offset:16384
    ds_read_b128 v[236:239], v126 offset:18432
    ds_read_b64_tr_b16 v[64:65], v129 offset:12288
    ds_read_b64_tr_b16 v[66:67], v129 offset:12800
    s_add_u32 s0, s0, 14
    v_writelane_b32 v5, s0, 16
    v_lshlrev_b32 v5, 7, v5
    v_mfma_f32_16x16x32_bf16 v[32:35], v[100:103], v[224:227], v[32:35]
    v_mfma_f32_16x16x32_bf16 v[36:39], v[100:103], v[228:231], v[36:39]
    ds_read_b64_tr_b16 v[68:69], v130 offset:20480
    ds_read_b64_tr_b16 v[70:71], v130 offset:20992
    s_add_u32 m0, s57, 147456
    s_add_u32 s64, s56, 229504
    buffer_load_dwordx4 v123, s[40:43], s64 offen lds
    v_add_u32 v12, 15728640, v5
    v_lshrrev_b32 v5, 5, v0
    v_mul_u32_u24 v5, 6656, v5
    v_mfma_f32_16x16x32_bf16 v[48:51], v[104:107], v[224:227], v[48:51]
    v_mfma_f32_16x16x32_bf16 v[52:55], v[104:107], v[228:231], v[52:55]
    ds_read_b64_tr_b16 v[72:73], v131 offset:20480
    ds_read_b64_tr_b16 v[74:75], v131 offset:20992
    s_add_u32 m0, s57, 151552
    s_add_u32 s64, s56, 344192
    buffer_load_dwordx4 v123, s[40:43], s64 offen lds
    v_add_u32 v10, v5, v134
    s_mul_i32 s86, s66, 7
    s_lshr_b32 s86, s86, 1
    s_waitcnt lgkmcnt(8)
    v_mfma_f32_16x16x32_bf16 v[20:23], v[224:227], v[108:111], v[20:23]
    v_mfma_f32_16x16x32_bf16 v[28:31], v[228:231], v[108:111], v[28:31]
    ds_read_b64_tr_b16 v[96:97], v127 offset:12288
    ds_read_b64_tr_b16 v[98:99], v127 offset:12800
    s_lshl_b32 s86, s86, 9
    s_mul_i32 s1, s70, 458752
    s_add_u32 s0, s1, s86
    v_mfma_f32_16x16x32_bf16 v[40:43], v[112:115], v[224:227], v[40:43]
    v_mfma_f32_16x16x32_bf16 v[44:47], v[112:115], v[228:231], v[44:47]
    ds_read_b64_tr_b16 v[100:101], v130 offset:28672
    ds_read_b64_tr_b16 v[102:103], v130 offset:29184
    s_add_u32 m0, s57, 155648
    s_add_u32 s64, s56, 229504
    buffer_load_dwordx4 v123, s[44:47], s64 offen lds
    s_add_u32 s0, s0, 1835008
    s_add_u32 s72, s28, s0
    s_addc_u32 s73, s29, 0
    s_mov_b32 s74, 458752
    v_mfma_f32_16x16x32_bf16 v[56:59], v[116:119], v[224:227], v[56:59]
    v_mfma_f32_16x16x32_bf16 v[60:63], v[116:119], v[228:231], v[60:63]
    ds_read_b64_tr_b16 v[104:105], v131 offset:28672
    ds_read_b64_tr_b16 v[106:107], v131 offset:29184
    s_add_u32 m0, s57, 159744
    s_add_u32 s64, s56, 344192
    buffer_load_dwordx4 v123, s[44:47], s64 offen lds
    s_mov_b32 s75, 0x00020000
    s_mul_i32 s0, s66, 448
    s_add_u32 s0, s0, s1
    s_lshl_b32 s18, s2, 3
    s_add_u32 s18, s18, s26
    s_lshl_b32 s19, s18, 7
    v_lshl_add_u32 v13, v0, 18, s19
    s_mov_b32 s4, s16
    s_mov_b32 s5, s17
    s_mov_b32 s6, 1605632
    s_mov_b32 s7, 0x00020000
    s_mov_b32 s12, s8
    s_mov_b32 s13, s9
    s_mov_b32 s14, 401408
    s_mov_b32 s15, 0x00020000
    s_mov_b64 exec, 0x7f
    buffer_load_dword v11, v13, s[4:7], 0 offen
    buffer_load_dword v11, v13, s[12:15], 0 offen
    s_mov_b64 exec, -1
    s_waitcnt lgkmcnt(0)
    v_mfma_f32_16x16x32_bf16 v[16:19], v[232:235], v[64:67], v[16:19]
    v_mfma_f32_16x16x32_bf16 v[24:27], v[236:239], v[64:67], v[24:27]
    s_waitcnt vmcnt(10)
    s_barrier
    s_mov_b32 s48, s22
    s_mov_b32 s49, s23
    s_mov_b32 s50, 256
    s_mov_b32 s51, 0x00020000
    s_cmp_lg_u32 s26, 0
    s_cbranch_scc1 gated_mix__mha_block__glu_gated_geglu__prompt_kernel_skip14
    s_and_b32 s3, s2, 3
    s_lshl_b32 s3, s3, 6
    v_mov_b32 v13, 1
    s_mov_b64 exec, 1
    buffer_atomic_add v13, off, s[48:51], s3 sc1
    s_mov_b64 exec, -1
gated_mix__mha_block__glu_gated_geglu__prompt_kernel_skip14:
    ds_read_b128 v[240:243], v125 offset:32768
    ds_read_b128 v[244:247], v125 offset:34816
    ds_read_b64_tr_b16 v[108:109], v129 offset:16384
    ds_read_b64_tr_b16 v[110:111], v129 offset:16896
    s_add_u32 s0, s0, 3670016
    s_add_u32 s76, s28, s0
    s_addc_u32 s77, s29, 0
    s_mov_b32 s78, 458752
    v_mfma_f32_16x16x32_bf16 v[32:35], v[68:71], v[232:235], v[32:35]
    v_mfma_f32_16x16x32_bf16 v[36:39], v[68:71], v[236:239], v[36:39]
    ds_read_b64_tr_b16 v[112:113], v130 offset:32768
    ds_read_b64_tr_b16 v[114:115], v130 offset:33280
    s_add_u32 m0, s57, 0
    s_add_u32 s64, s56, 458880
    buffer_load_dwordx4 v123, s[40:43], s64 offen lds
    s_mov_b32 s79, 0x00020000
    s_lshl_b32 s1, s67, 2
    s_add_u32 s0, s70, 1
    v_mfma_f32_16x16x32_bf16 v[48:51], v[72:75], v[232:235], v[48:51]
    v_mfma_f32_16x16x32_bf16 v[52:55], v[72:75], v[236:239], v[52:55]
    ds_read_b64_tr_b16 v[116:117], v131 offset:32768
    ds_read_b64_tr_b16 v[118:119], v131 offset:33280
    s_add_u32 m0, s57, 4096
    s_add_u32 s64, s56, 573568
    buffer_load_dwordx4 v123, s[40:43], s64 offen lds
    s_and_b32 s0, s0, 3
    s_add_u32 s0, s0, s1
    s_mul_i32 s0, s0, 28672
    v_mfma_f32_16x16x32_bf16 v[20:23], v[232:235], v[96:99], v[20:23]
    v_mfma_f32_16x16x32_bf16 v[28:31], v[236:239], v[96:99], v[28:31]
    ds_read_b64_tr_b16 v[64:65], v127 offset:16384
    ds_read_b64_tr_b16 v[66:67], v127 offset:16896
    s_add_u32 s80, s0, s86
    s_add_u32 s0, s70, 2
    s_and_b32 s0, s0, 3
    v_mfma_f32_16x16x32_bf16 v[40:43], v[100:103], v[232:235], v[40:43]
    v_mfma_f32_16x16x32_bf16 v[44:47], v[100:103], v[236:239], v[44:47]
    ds_read_b64_tr_b16 v[68:69], v130 offset:40960
    ds_read_b64_tr_b16 v[70:71], v130 offset:41472
    s_add_u32 m0, s57, 8192
    s_add_u32 s64, s56, 458880
    buffer_load_dwordx4 v123, s[44:47], s64 offen lds
    s_add_u32 s0, s0, s1
    s_mul_i32 s0, s0, 28672
    s_add_u32 s81, s0, s86
    v_mfma_f32_16x16x32_bf16 v[56:59], v[104:107], v[232:235], v[56:59]
    v_mfma_f32_16x16x32_bf16 v[60:63], v[104:107], v[236:239], v[60:63]
    ds_read_b64_tr_b16 v[72:73], v131 offset:40960
    ds_read_b64_tr_b16 v[74:75], v131 offset:41472
    s_add_u32 m0, s57, 12288
    s_add_u32 s64, s56, 573568
    buffer_load_dwordx4 v123, s[44:47], s64 offen lds
    s_add_u32 s0, s70, 3
    s_and_b32 s0, s0, 3
    s_add_u32 s0, s0, s1
    s_waitcnt lgkmcnt(6)
    v_mfma_f32_16x16x32_bf16 v[16:19], v[240:243], v[108:111], v[16:19]
    v_mfma_f32_16x16x32_bf16 v[24:27], v[244:247], v[108:111], v[24:27]
    ds_read_b128 v[248:251], v126 offset:32768
    ds_read_b128 v[252:255], v126 offset:34816
    ds_read_b64_tr_b16 v[96:97], v129 offset:20480
    ds_read_b64_tr_b16 v[98:99], v129 offset:20992
    s_mul_i32 s0, s0, 28672
    s_add_u32 s82, s0, s86
    s_add_u32 s0, s70, 4
    v_mfma_f32_16x16x32_bf16 v[32:35], v[112:115], v[240:243], v[32:35]
    v_mfma_f32_16x16x32_bf16 v[36:39], v[112:115], v[244:247], v[36:39]
    ds_read_b64_tr_b16 v[100:101], v130 offset:36864
    ds_read_b64_tr_b16 v[102:103], v130 offset:37376
    s_add_u32 m0, s57, 98304
    s_add_u32 s64, s56, 688256
    buffer_load_dwordx4 v123, s[40:43], s64 offen lds
    s_and_b32 s0, s0, 3
    s_add_u32 s0, s0, s1
    s_mul_i32 s0, s0, 28672
    v_mfma_f32_16x16x32_bf16 v[48:51], v[116:119], v[240:243], v[48:51]
    v_mfma_f32_16x16x32_bf16 v[52:55], v[116:119], v[244:247], v[52:55]
    ds_read_b64_tr_b16 v[104:105], v131 offset:36864
    ds_read_b64_tr_b16 v[106:107], v131 offset:37376
    s_add_u32 m0, s57, 102400
    s_add_u32 s64, s56, 802944
    buffer_load_dwordx4 v123, s[40:43], s64 offen lds
    s_add_u32 s83, s0, s86
    s_add_u32 s0, s1, s70
    s_lshl_b32 s60, s0, 7
    s_waitcnt lgkmcnt(8)
    v_mfma_f32_16x16x32_bf16 v[20:23], v[240:243], v[64:67], v[20:23]
    v_mfma_f32_16x16x32_bf16 v[28:31], v[244:247], v[64:67], v[28:31]
    ds_read_b64_tr_b16 v[108:109], v127 offset:20480
    ds_read_b64_tr_b16 v[110:111], v127 offset:20992
    s_add_u32 s61, s60, 14942208
    s_lshl_b32 s0, s0, 4
    s_add_u32 s0, s0, s66
    v_mfma_f32_16x16x32_bf16 v[40:43], v[68:71], v[240:243], v[40:43]
    v_mfma_f32_16x16x32_bf16 v[44:47], v[68:71], v[244:247], v[44:47]
    ds_read_b64_tr_b16 v[112:113], v130 offset:45056
    ds_read_b64_tr_b16 v[114:115], v130 offset:45568
    s_add_u32 m0, s57, 106496
    s_add_u32 s64, s56, 688256
    buffer_load_dwordx4 v123, s[44:47], s64 offen lds
    s_lshl_b32 s86, s0, 11
    s_add_u32 s86, s86, 12845056
    s_lshl_b32 s87, s0, 7
    v_mfma_f32_16x16x32_bf16 v[56:59], v[72:75], v[240:243], v[56:59]
    v_mfma_f32_16x16x32_bf16 v[60:63], v[72:75], v[244:247], v[60:63]
    ds_read_b64_tr_b16 v[116:117], v131 offset:45056
    ds_read_b64_tr_b16 v[118:119], v131 offset:45568
    s_add_u32 m0, s57, 110592
    s_add_u32 s64, s56, 802944
    buffer_load_dwordx4 v123, s[44:47], s64 offen lds
    s_add_u32 s87, s87, 15761408
    s_mov_b32 s84, 0x0fffffff
    s_mov_b32 s85, 0x0fffffff
    s_waitcnt lgkmcnt(6)
    v_mfma_f32_16x16x32_bf16 v[16:19], v[248:251], v[96:99], v[16:19]
    v_mfma_f32_16x16x32_bf16 v[24:27], v[252:255], v[96:99], v[24:27]
    v_mfma_f32_16x16x32_bf16 v[32:35], v[100:103], v[248:251], v[32:35]
    v_mfma_f32_16x16x32_bf16 v[36:39], v[100:103], v[252:255], v[36:39]
    v_mfma_f32_16x16x32_bf16 v[48:51], v[104:107], v[248:251], v[48:51]
    v_mfma_f32_16x16x32_bf16 v[52:55], v[104:107], v[252:255], v[52:55]
    s_waitcnt lgkmcnt(0)
    v_mfma_f32_16x16x32_bf16 v[20:23], v[248:251], v[108:111], v[20:23]
    v_mfma_f32_16x16x32_bf16 v[28:31], v[252:255], v[108:111], v[28:31]
    s_waitcnt vmcnt(10)
    s_barrier
    ds_read_b64_tr_b16 v[96:97], v132 offset:49152
    ds_read_b64_tr_b16 v[98:99], v132 offset:49664
    v_mfma_f32_16x16x32_bf16 v[40:43], v[112:115], v[248:251], v[40:43]
    v_mfma_f32_16x16x32_bf16 v[44:47], v[112:115], v[252:255], v[44:47]
    ds_read_b64_tr_b16 v[100:101], v133 offset:49152
    ds_read_b64_tr_b16 v[102:103], v133 offset:49664
    v_mfma_f32_16x16x32_bf16 v[56:59], v[116:119], v[248:251], v[56:59]
    v_mfma_f32_16x16x32_bf16 v[60:63], v[116:119], v[252:255], v[60:63]
    s_waitcnt lgkmcnt(2)
    v_mfma_f32_16x16x32_bf16 v[64:67], v[96:99], v[144:147], 0
    v_mfma_f32_16x16x32_bf16 v[68:71], v[96:99], v[148:151], 0
    ds_read_b64_tr_b16 v[108:109], v132 offset:57344
    ds_read_b64_tr_b16 v[110:111], v132 offset:57856
    v_cvt_pk_bf16_f32 v136, v16, v17
    v_cvt_pk_bf16_f32 v137, v18, v19
    v_cvt_pk_bf16_f32 v138, v20, v21
    v_cvt_pk_bf16_f32 v139, v22, v23
    v_cvt_pk_bf16_f32 v140, v24, v25
    v_cvt_pk_bf16_f32 v141, v26, v27
    v_cvt_pk_bf16_f32 v142, v28, v29
    v_cvt_pk_bf16_f32 v143, v30, v31
    s_waitcnt lgkmcnt(2)
    v_mfma_f32_16x16x32_bf16 v[80:83], v[100:103], v[144:147], 0
    v_mfma_f32_16x16x32_bf16 v[84:87], v[100:103], v[148:151], 0
    ds_read_b64_tr_b16 v[112:113], v133 offset:57344
    ds_read_b64_tr_b16 v[114:115], v133 offset:57856
    s_add_u32 s59, s62, 14336
    v_permlane16_swap_b32 v136, v138
    v_permlane16_swap_b32 v137, v139
    v_permlane16_swap_b32 v140, v142
    v_permlane16_swap_b32 v141, v143
    v_permlane32_swap_b32 v136, v138
    v_permlane32_swap_b32 v137, v139
    v_permlane32_swap_b32 v140, v142
    s_waitcnt lgkmcnt(2)
    v_mfma_f32_16x16x32_bf16 v[72:75], v[108:111], v[144:147], 0
    v_mfma_f32_16x16x32_bf16 v[76:79], v[108:111], v[148:151], 0
    ds_read_b64_tr_b16 v[96:97], v132 offset:53248
    ds_read_b64_tr_b16 v[98:99], v132 offset:53760
    v_permlane32_swap_b32 v141, v143
    buffer_store_dwordx4 v[136:139], v135, s[28:31], s62 offen sc1
    buffer_store_dwordx4 v[140:143], v135, s[28:31], s59 offen sc1
    s_waitcnt lgkmcnt(2)
    v_mfma_f32_16x16x32_bf16 v[88:91], v[112:115], v[144:147], 0
    v_mfma_f32_16x16x32_bf16 v[92:95], v[112:115], v[148:151], 0
    ds_read_b64_tr_b16 v[100:101], v133 offset:53248
    ds_read_b64_tr_b16 v[102:103], v133 offset:53760
    s_waitcnt lgkmcnt(2)
    v_mfma_f32_16x16x32_bf16 v[64:67], v[96:99], v[152:155], v[64:67]
    v_mfma_f32_16x16x32_bf16 v[68:71], v[96:99], v[156:159], v[68:71]
    ds_read_b64_tr_b16 v[108:109], v132 offset:61440
    ds_read_b64_tr_b16 v[110:111], v132 offset:61952
    s_waitcnt lgkmcnt(2)
    v_mfma_f32_16x16x32_bf16 v[80:83], v[100:103], v[152:155], v[80:83]
    v_mfma_f32_16x16x32_bf16 v[84:87], v[100:103], v[156:159], v[84:87]
    ds_read_b64_tr_b16 v[112:113], v133 offset:61440
    ds_read_b64_tr_b16 v[114:115], v133 offset:61952
    s_waitcnt lgkmcnt(2)
    v_mfma_f32_16x16x32_bf16 v[72:75], v[108:111], v[152:155], v[72:75]
    v_mfma_f32_16x16x32_bf16 v[76:79], v[108:111], v[156:159], v[76:79]
    ds_read_b64_tr_b16 v[96:97], v130 offset:49152
    ds_read_b64_tr_b16 v[98:99], v130 offset:49664
    s_waitcnt lgkmcnt(2)
    v_mfma_f32_16x16x32_bf16 v[88:91], v[112:115], v[152:155], v[88:91]
    v_mfma_f32_16x16x32_bf16 v[92:95], v[112:115], v[156:159], v[92:95]
    ds_read_b64_tr_b16 v[100:101], v131 offset:49152
    ds_read_b64_tr_b16 v[102:103], v131 offset:49664
    v_add_u32 v144, 28672, v134
    v_add_u32 v145, 57344, v134
    v_add_u32 v146, 86016, v134
    v_add_u32 v147, 14336, v10
    v_add_u32 v148, 28672, v10
    v_add_u32 v149, 43008, v10
    s_waitcnt lgkmcnt(2)
    v_mfma_f32_16x16x32_bf16 v[64:67], v[96:99], v[160:163], v[64:67]
    v_mfma_f32_16x16x32_bf16 v[68:71], v[96:99], v[164:167], v[68:71]
    ds_read_b64_tr_b16 v[108:109], v130 offset:57344
    ds_read_b64_tr_b16 v[110:111], v130 offset:57856
    s_add_u32 m0, s57, 16384
    s_add_u32 s64, s56, 917632
    buffer_load_dwordx4 v123, s[40:43], s64 offen lds
    v_mul_f32 v1, v32, v32
    v_mul_f32 v2, v33, v33
    v_mul_f32 v3, v34, v34
    s_waitcnt lgkmcnt(2)
    v_mfma_f32_16x16x32_bf16 v[80:83], v[100:103], v[160:163], v[80:83]
    v_mfma_f32_16x16x32_bf16 v[84:87], v[100:103], v[164:167], v[84:87]
    ds_read_b64_tr_b16 v[112:113], v131 offset:57344
    ds_read_b64_tr_b16 v[114:115], v131 offset:57856
    s_add_u32 m0, s57, 20480
    s_add_u32 s64, s56, 1032320
    buffer_load_dwordx4 v123, s[40:43], s64 offen lds
    v_mul_f32 v4, v35, v35
    v_fmamk_f32 v1, v1, 0xbdd2d3e8, v15
    v_fmamk_f32 v2, v2, 0xbdd2d3e8, v15
    v_fmamk_f32 v3, v3, 0xbdd2d3e8, v15
    v_add_u32 v150, 57344, v10
    v_add_u32 v151, 71680, v10
    v_add_u32 v152, 86016, v10
    v_add_u32 v153, 100352, v10
    s_add_u32 s0, s70, 1
    s_and_b32 s0, s0, 3
    s_waitcnt lgkmcnt(2)
    v_mfma_f32_16x16x32_bf16 v[72:75], v[108:111], v[160:163], v[72:75]
    v_mfma_f32_16x16x32_bf16 v[76:79], v[108:111], v[164:167], v[76:79]
    ds_read_b64_tr_b16 v[96:97], v130 offset:53248
    ds_read_b64_tr_b16 v[98:99], v130 offset:53760
    s_add_u32 m0, s57, 24576
    s_add_u32 s64, s56, 917632
    buffer_load_dwordx4 v123, s[44:47], s64 offen lds
    v_fmamk_f32 v4, v4, 0xbdd2d3e8, v15
    v_mul_f32 v1, v1, v32
    v_mul_f32 v2, v2, v33
    s_waitcnt lgkmcnt(2)
    v_mfma_f32_16x16x32_bf16 v[88:91], v[112:115], v[160:163], v[88:91]
    v_mfma_f32_16x16x32_bf16 v[92:95], v[112:115], v[164:167], v[92:95]
    ds_read_b64_tr_b16 v[100:101], v131 offset:53248
    ds_read_b64_tr_b16 v[102:103], v131 offset:53760
    s_add_u32 m0, s57, 28672
    s_add_u32 s64, s56, 1032320
    buffer_load_dwordx4 v123, s[44:47], s64 offen lds
    v_mul_f32 v3, v3, v34
    v_mul_f32 v4, v4, v35
    v_exp_f32 v1, v1
    s_mul_i32 s0, s0, 12288
    s_add_u32 s0, s0, 106496
    v_add_u32 v154, s0, v134
    s_add_u32 s0, s70, 2
    s_and_b32 s0, s0, 3
    s_mul_i32 s0, s0, 12288
    s_waitcnt lgkmcnt(2)
    v_mfma_f32_16x16x32_bf16 v[64:67], v[96:99], v[168:171], v[64:67]
    v_mfma_f32_16x16x32_bf16 v[68:71], v[96:99], v[172:175], v[68:71]
    ds_read_b64_tr_b16 v[108:109], v130 offset:61440
    ds_read_b64_tr_b16 v[110:111], v130 offset:61952
    s_add_u32 m0, s57, 114688
    s_add_u32 s64, s56, 1147008
    buffer_load_dwordx4 v123, s[40:43], s64 offen lds
    v_exp_f32 v2, v2
    v_exp_f32 v3, v3
    v_exp_f32 v4, v4
    s_waitcnt lgkmcnt(2)
    v_mfma_f32_16x16x32_bf16 v[80:83], v[100:103], v[168:171], v[80:83]
    v_mfma_f32_16x16x32_bf16 v[84:87], v[100:103], v[172:175], v[84:87]
    ds_read_b64_tr_b16 v[112:113], v131 offset:61440
    ds_read_b64_tr_b16 v[114:115], v131 offset:61952
    s_add_u32 m0, s57, 118784
    s_add_u32 s64, s56, 1261696
    buffer_load_dwordx4 v123, s[40:43], s64 offen lds
    v_mul_f32 v40, v32, v40
    v_mul_f32 v41, v33, v41
    v_mul_f32 v42, v34, v42
    v_mul_f32 v43, v35, v43
    s_waitcnt lgkmcnt(0)
    s_add_u32 s0, s0, 110592
    v_add_u32 v155, s0, v134
    s_add_u32 s0, s70, 3
    s_and_b32 s0, s0, 3
    s_mul_i32 s0, s0, 12288
    s_add_u32 s0, s0, 114688
    v_add_u32 v156, s0, v134
    v_mfma_f32_16x16x32_bf16 v[72:75], v[108:111], v[168:171], v[72:75]
    v_mfma_f32_16x16x32_bf16 v[76:79], v[108:111], v[172:175], v[76:79]
    s_waitcnt vmcnt(8)
    s_barrier
    ds_read_b64_tr_b16 v[96:97], v132 offset:0
    ds_read_b64_tr_b16 v[98:99], v132 offset:512
    s_add_u32 m0, s57, 122880
    s_add_u32 s64, s56, 1147008
    buffer_load_dwordx4 v123, s[44:47], s64 offen lds
    v_add_f32 v1, 1.0, v1
    v_add_f32 v2, 1.0, v2
    v_add_f32 v3, 1.0, v3
    v_mfma_f32_16x16x32_bf16 v[88:91], v[112:115], v[168:171], v[88:91]
    v_mfma_f32_16x16x32_bf16 v[92:95], v[112:115], v[172:175], v[92:95]
    ds_read_b64_tr_b16 v[100:101], v133 offset:0
    ds_read_b64_tr_b16 v[102:103], v133 offset:512
    s_add_u32 m0, s57, 126976
    s_add_u32 s64, s56, 1261696
    buffer_load_dwordx4 v123, s[44:47], s64 offen lds
    v_add_f32 v4, 1.0, v4
    v_rcp_f32 v1, v1
    v_rcp_f32 v2, v2
    s_lshl_b32 s3, s26, 9
    s_add_u32 s3, s3, 155648
    v_lshl_add_u32 v8, v0, 3, s3
    v_mov_b64 v[6:7], 0
    ds_write_b64 v8, v[6:7]
    ds_write_b64 v8, v[6:7] offset:4096
    s_add_u32 s0, s70, 4
    s_and_b32 s0, s0, 3
    s_mul_i32 s0, s0, 12288
    s_add_u32 s0, s0, 106496
    v_add_u32 v157, s0, v134
    s_lshl_b32 s0, s70, 8
    s_waitcnt lgkmcnt(4)
    v_mfma_f32_16x16x32_bf16 v[64:67], v[96:99], v[176:179], v[64:67]
    v_mfma_f32_16x16x32_bf16 v[68:71], v[96:99], v[180:183], v[68:71]
    ds_read_b64_tr_b16 v[108:109], v132 offset:8192
    ds_read_b64_tr_b16 v[110:111], v132 offset:8704
    s_add_u32 m0, s57, 32768
    s_add_u32 s64, s56, 1376384
    buffer_load_dwordx4 v123, s[40:43], s64 offen lds
    v_rcp_f32 v3, v3
    v_rcp_f32 v4, v4
    v_mul_f32 v40, v40, v1
    s_waitcnt lgkmcnt(4)
    v_mfma_f32_16x16x32_bf16 v[80:83], v[100:103], v[176:179], v[80:83]
    v_mfma_f32_16x16x32_bf16 v[84:87], v[100:103], v[180:183], v[84:87]
    ds_read_b64_tr_b16 v[112:113], v133 offset:8192
    ds_read_b64_tr_b16 v[114:115], v133 offset:8704
    s_add_u32 m0, s57, 36864
    s_add_u32 s64, s56, 1491072
    buffer_load_dwordx4 v123, s[40:43], s64 offen lds
    v_mul_f32 v41, v41, v2
    v_mul_f32 v42, v42, v3
    v_mul_f32 v43, v43, v4
    v_cvt_pk_bf16_f32 v136, v40, v41
    s_add_u32 s0, s0, 157696
    v_lshl_add_u32 v158, v0, 2, s0
    v_and_b32 v159, 3, v0
    v_lshlrev_b32 v159, 8, v159
    v_add_u32 v159, 157696, v159
    s_and_b32 s0, s66, 1
    s_waitcnt lgkmcnt(2)
    v_mfma_f32_16x16x32_bf16 v[72:75], v[108:111], v[176:179], v[72:75]
    v_mfma_f32_16x16x32_bf16 v[76:79], v[108:111], v[180:183], v[76:79]
    s_waitcnt vmcnt(10)
    s_barrier
    s_cmp_lg_u32 s26, 0
    s_cbranch_scc1 gated_mix__mha_block__glu_gated_geglu__prompt_kernel_skip15
    v_mov_b32 v5, 1
    s_mov_b64 exec, 1
    buffer_store_dword v5, off, s[28:31], s27 sc1
    s_mov_b64 exec, -1
gated_mix__mha_block__glu_gated_geglu__prompt_kernel_skip15:
    ds_read_b64_tr_b16 v[96:97], v132 offset:4096
    ds_read_b64_tr_b16 v[98:99], v132 offset:4608
    s_add_u32 m0, s57, 40960
    s_add_u32 s64, s56, 1376384
    buffer_load_dwordx4 v123, s[44:47], s64 offen lds
    v_cvt_pk_bf16_f32 v137, v42, v43
    v_mul_f32 v1, v36, v36
    v_mul_f32 v2, v37, v37
    s_waitcnt lgkmcnt(2)
    v_mfma_f32_16x16x32_bf16 v[88:91], v[112:115], v[176:179], v[88:91]
    v_mfma_f32_16x16x32_bf16 v[92:95], v[112:115], v[180:183], v[92:95]
    ds_read_b64_tr_b16 v[100:101], v133 offset:4096
    ds_read_b64_tr_b16 v[102:103], v133 offset:4608
    s_add_u32 m0, s57, 45056
    s_add_u32 s64, s56, 1491072
    buffer_load_dwordx4 v123, s[44:47], s64 offen lds
    v_mul_f32 v3, v38, v38
    v_mul_f32 v4, v39, v39
    v_fmamk_f32 v1, v1, 0xbdd2d3e8, v15
    v_lshrrev_b32 v120, 5, v0
    v_or_b32 v121, s0, v120
    v_xor_b32 v121, s0, v121
    v_add_u32 v121, -1, v121
    v_xor_b32 v120, 1, v120
    v_and_b32 v120, s0, v120
    s_waitcnt lgkmcnt(2)
    v_mfma_f32_16x16x32_bf16 v[64:67], v[96:99], v[184:187], v[64:67]
    v_mfma_f32_16x16x32_bf16 v[68:71], v[96:99], v[188:191], v[68:71]
    ds_read_b64_tr_b16 v[108:109], v132 offset:12288
    ds_read_b64_tr_b16 v[110:111], v132 offset:12800
    v_fmamk_f32 v2, v2, 0xbdd2d3e8, v15
    v_fmamk_f32 v3, v3, 0xbdd2d3e8, v15
    v_fmamk_f32 v4, v4, 0xbdd2d3e8, v15
    s_waitcnt lgkmcnt(2)
    v_mfma_f32_16x16x32_bf16 v[80:83], v[100:103], v[184:187], v[80:83]
    v_mfma_f32_16x16x32_bf16 v[84:87], v[100:103], v[188:191], v[84:87]
    ds_read_b64_tr_b16 v[112:113], v133 offset:12288
    ds_read_b64_tr_b16 v[114:115], v133 offset:12800
    v_mul_f32 v1, v1, v36
    v_mul_f32 v2, v2, v37
    v_mul_f32 v3, v3, v38
    v_mul_f32 v4, v4, v39
    v_add_u32 v120, -1, v120
    v_and_b32 v122, 31, v0
    v_lshlrev_b32 v122, 2, v122
    v_and_b32 v13, 31, v0
    v_cmp_eq_u32 s[0:1], 28, v13
    v_mov_b32 v13, 0x3f803f80
    s_nop 0
    v_cndmask_b32 v13, 0, v13, s[0:1]
    s_waitcnt lgkmcnt(2)
    v_mfma_f32_16x16x32_bf16 v[72:75], v[108:111], v[184:187], v[72:75]
    v_mfma_f32_16x16x32_bf16 v[76:79], v[108:111], v[188:191], v[76:79]
    ds_read_b64_tr_b16 v[96:97], v130 offset:0
    ds_read_b64_tr_b16 v[98:99], v130 offset:512
    v_exp_f32 v1, v1
    v_exp_f32 v2, v2
    v_exp_f32 v3, v3
    s_waitcnt lgkmcnt(2)
    v_mfma_f32_16x16x32_bf16 v[88:91], v[112:115], v[184:187], v[88:91]
    v_mfma_f32_16x16x32_bf16 v[92:95], v[112:115], v[188:191], v[92:95]
    ds_read_b64_tr_b16 v[100:101], v131 offset:0
    ds_read_b64_tr_b16 v[102:103], v131 offset:512
    v_exp_f32 v4, v4
    v_mul_f32 v44, v36, v44
    v_mul_f32 v45, v37, v45
    v_mov_b32 v160, v13
    v_mov_b32 v161, v13
    s_waitcnt lgkmcnt(2)
    v_mfma_f32_16x16x32_bf16 v[64:67], v[96:99], v[192:195], v[64:67]
    v_mfma_f32_16x16x32_bf16 v[68:71], v[96:99], v[196:199], v[68:71]
    ds_read_b64_tr_b16 v[108:109], v130 offset:8192
    ds_read_b64_tr_b16 v[110:111], v130 offset:8704
    v_mul_f32 v46, v38, v46
    v_mul_f32 v47, v39, v47
    v_add_f32 v1, 1.0, v1
    s_waitcnt lgkmcnt(2)
    v_mfma_f32_16x16x32_bf16 v[80:83], v[100:103], v[192:195], v[80:83]
    v_mfma_f32_16x16x32_bf16 v[84:87], v[100:103], v[196:199], v[84:87]
    ds_read_b64_tr_b16 v[112:113], v131 offset:8192
    ds_read_b64_tr_b16 v[114:115], v131 offset:8704
    v_add_f32 v2, 1.0, v2
    v_add_f32 v3, 1.0, v3
    v_add_f32 v4, 1.0, v4
    v_rcp_f32 v1, v1
    v_mov_b32 v162, v13
    v_mov_b32 v163, v13
    s_waitcnt lgkmcnt(2)
    v_mfma_f32_16x16x32_bf16 v[72:75], v[108:111], v[192:195], v[72:75]
    v_mfma_f32_16x16x32_bf16 v[76:79], v[108:111], v[196:199], v[76:79]
    ds_read_b64_tr_b16 v[96:97], v130 offset:4096
    ds_read_b64_tr_b16 v[98:99], v130 offset:4608
    v_rcp_f32 v2, v2
    v_rcp_f32 v3, v3
    v_rcp_f32 v4, v4
    s_waitcnt lgkmcnt(2)
    v_mfma_f32_16x16x32_bf16 v[88:91], v[112:115], v[192:195], v[88:91]
    v_mfma_f32_16x16x32_bf16 v[92:95], v[112:115], v[196:199], v[92:95]
    ds_read_b64_tr_b16 v[100:101], v131 offset:4096
    ds_read_b64_tr_b16 v[102:103], v131 offset:4608
    v_mul_f32 v44, v44, v1
    v_mul_f32 v45, v45, v2
    v_mul_f32 v46, v46, v3
    v_and_b32 v8, 3, v0
    v_lshlrev_b32 v8, 6, v8
    buffer_load_dword v7, v8, s[48:51], 0 offen sc1
    v_mov_b32 v164, v13
    v_mov_b32 v165, v13
    s_waitcnt lgkmcnt(2)
    v_mfma_f32_16x16x32_bf16 v[64:67], v[96:99], v[200:203], v[64:67]
    v_mfma_f32_16x16x32_bf16 v[68:71], v[96:99], v[204:207], v[68:71]
    ds_read_b64_tr_b16 v[108:109], v130 offset:12288
    ds_read_b64_tr_b16 v[110:111], v130 offset:12800
    v_mul_f32 v47, v47, v4
    v_cvt_pk_bf16_f32 v138, v44, v45
    v_cvt_pk_bf16_f32 v139, v46, v47
    s_add_u32 s59, s63, 0
    s_waitcnt lgkmcnt(2)
    v_mfma_f32_16x16x32_bf16 v[80:83], v[100:103], v[200:203], v[80:83]
    v_mfma_f32_16x16x32_bf16 v[84:87], v[100:103], v[204:207], v[84:87]
    ds_read_b64_tr_b16 v[112:113], v131 offset:12288
    ds_read_b64_tr_b16 v[114:115], v131 offset:12800
    v_permlane16_swap_b32 v136, v138
    v_permlane16_swap_b32 v137, v139
    buffer_store_dwordx4 v[136:139], v134, s[28:31], s59 offen sc1
    s_waitcnt lgkmcnt(0)
    v_mov_b32 v166, v13
    v_mov_b32 v167, v13
    v_mfma_f32_16x16x32_bf16 v[72:75], v[108:111], v[200:203], v[72:75]
    v_mfma_f32_16x16x32_bf16 v[76:79], v[108:111], v[204:207], v[76:79]
    s_waitcnt vmcnt(2)
    s_barrier
    ds_read_b64_tr_b16 v[96:97], v132 offset:16384
    ds_read_b64_tr_b16 v[98:99], v132 offset:16896
    v_mul_f32 v1, v48, v48
    v_mul_f32 v2, v49, v49
    v_mul_f32 v3, v50, v50
    v_mfma_f32_16x16x32_bf16 v[88:91], v[112:115], v[200:203], v[88:91]
    v_mfma_f32_16x16x32_bf16 v[92:95], v[112:115], v[204:207], v[92:95]
    ds_read_b64_tr_b16 v[100:101], v133 offset:16384
    ds_read_b64_tr_b16 v[102:103], v133 offset:16896
    v_mul_f32 v4, v51, v51
    v_fmamk_f32 v1, v1, 0xbdd2d3e8, v15
    v_fmamk_f32 v2, v2, 0xbdd2d3e8, v15
    v_mov_b32 v168, v13
    v_mov_b32 v169, v13
    s_waitcnt lgkmcnt(2)
    v_mfma_f32_16x16x32_bf16 v[64:67], v[96:99], v[208:211], v[64:67]
    v_mfma_f32_16x16x32_bf16 v[68:71], v[96:99], v[212:215], v[68:71]
    ds_read_b64_tr_b16 v[108:109], v132 offset:24576
    ds_read_b64_tr_b16 v[110:111], v132 offset:25088
    v_fmamk_f32 v3, v3, 0xbdd2d3e8, v15
    v_fmamk_f32 v4, v4, 0xbdd2d3e8, v15
    v_mul_f32 v1, v1, v48
    v_mul_f32 v2, v2, v49
    s_waitcnt lgkmcnt(2)
    v_mfma_f32_16x16x32_bf16 v[80:83], v[100:103], v[208:211], v[80:83]
    v_mfma_f32_16x16x32_bf16 v[84:87], v[100:103], v[212:215], v[84:87]
    ds_read_b64_tr_b16 v[112:113], v133 offset:24576
    ds_read_b64_tr_b16 v[114:115], v133 offset:25088
    v_mul_f32 v3, v3, v50
    v_mul_f32 v4, v4, v51
    v_exp_f32 v1, v1
    v_mov_b32 v170, v13
    v_mov_b32 v171, v13
    s_waitcnt lgkmcnt(2)
    v_mfma_f32_16x16x32_bf16 v[72:75], v[108:111], v[208:211], v[72:75]
    v_mfma_f32_16x16x32_bf16 v[76:79], v[108:111], v[212:215], v[76:79]
    ds_read_b64_tr_b16 v[96:97], v132 offset:20480
    ds_read_b64_tr_b16 v[98:99], v132 offset:20992
    v_exp_f32 v2, v2
    v_exp_f32 v3, v3
    v_exp_f32 v4, v4
    s_waitcnt lgkmcnt(2)
    v_mfma_f32_16x16x32_bf16 v[88:91], v[112:115], v[208:211], v[88:91]
    v_mfma_f32_16x16x32_bf16 v[92:95], v[112:115], v[212:215], v[92:95]
    ds_read_b64_tr_b16 v[100:101], v133 offset:20480
    ds_read_b64_tr_b16 v[102:103], v133 offset:20992
    v_mul_f32 v56, v48, v56
    v_mul_f32 v57, v49, v57
    v_mul_f32 v58, v50, v58
    v_mov_b32 v172, v13
    v_mov_b32 v173, v13
    s_waitcnt lgkmcnt(2)
    v_mfma_f32_16x16x32_bf16 v[64:67], v[96:99], v[216:219], v[64:67]
    v_mfma_f32_16x16x32_bf16 v[68:71], v[96:99], v[220:223], v[68:71]
    ds_read_b64_tr_b16 v[108:109], v132 offset:28672
    ds_read_b64_tr_b16 v[110:111], v132 offset:29184
    v_mul_f32 v59, v51, v59
    v_add_f32 v1, 1.0, v1
    v_add_f32 v2, 1.0, v2
    v_add_f32 v3, 1.0, v3
    s_waitcnt lgkmcnt(2)
    v_mfma_f32_16x16x32_bf16 v[80:83], v[100:103], v[216:219], v[80:83]
    v_mfma_f32_16x16x32_bf16 v[84:87], v[100:103], v[220:223], v[84:87]
    ds_read_b64_tr_b16 v[112:113], v133 offset:28672
    ds_read_b64_tr_b16 v[114:115], v133 offset:29184
    v_add_f32 v4, 1.0, v4
    v_rcp_f32 v1, v1
    v_rcp_f32 v2, v2
    v_mov_b32 v174, v13
    v_mov_b32 v175, v13
    s_waitcnt lgkmcnt(2)
    v_mfma_f32_16x16x32_bf16 v[72:75], v[108:111], v[216:219], v[72:75]
    v_mfma_f32_16x16x32_bf16 v[76:79], v[108:111], v[220:223], v[76:79]
    ds_read_b64_tr_b16 v[96:97], v130 offset:16384
    ds_read_b64_tr_b16 v[98:99], v130 offset:16896
    v_rcp_f32 v3, v3
    v_rcp_f32 v4, v4
    v_mul_f32 v56, v56, v1
    s_waitcnt lgkmcnt(2)
    v_mfma_f32_16x16x32_bf16 v[88:91], v[112:115], v[216:219], v[88:91]
    v_mfma_f32_16x16x32_bf16 v[92:95], v[112:115], v[220:223], v[92:95]
    ds_read_b64_tr_b16 v[100:101], v131 offset:16384
    ds_read_b64_tr_b16 v[102:103], v131 offset:16896
    v_mul_f32 v57, v57, v2
    v_mul_f32 v58, v58, v3
    v_mul_f32 v59, v59, v4
    v_mov_b32 v176, v13
    v_mov_b32 v177, v13
    s_waitcnt lgkmcnt(2)
    v_mfma_f32_16x16x32_bf16 v[64:67], v[96:99], v[224:227], v[64:67]
    v_mfma_f32_16x16x32_bf16 v[68:71], v[96:99], v[228:231], v[68:71]
    ds_read_b64_tr_b16 v[108:109], v130 offset:24576
    ds_read_b64_tr_b16 v[110:111], v130 offset:25088
    v_cvt_pk_bf16_f32 v140, v56, v57
    v_cvt_pk_bf16_f32 v141, v58, v59
    v_mul_f32 v1, v52, v52
    v_mul_f32 v2, v53, v53
    s_waitcnt lgkmcnt(2)
    v_mfma_f32_16x16x32_bf16 v[80:83], v[100:103], v[224:227], v[80:83]
    v_mfma_f32_16x16x32_bf16 v[84:87], v[100:103], v[228:231], v[84:87]
    ds_read_b64_tr_b16 v[112:113], v131 offset:24576
    ds_read_b64_tr_b16 v[114:115], v131 offset:25088
    v_mul_f32 v3, v54, v54
    v_mul_f32 v4, v55, v55
    v_fmamk_f32 v1, v1, 0xbdd2d3e8, v15
    v_mov_b32 v178, v13
    v_mov_b32 v179, v13
    s_waitcnt lgkmcnt(2)
    v_mfma_f32_16x16x32_bf16 v[72:75], v[108:111], v[224:227], v[72:75]
    v_mfma_f32_16x16x32_bf16 v[76:79], v[108:111], v[228:231], v[76:79]
    ds_read_b64_tr_b16 v[96:97], v130 offset:20480
    ds_read_b64_tr_b16 v[98:99], v130 offset:20992
    v_fmamk_f32 v2, v2, 0xbdd2d3e8, v15
    v_fmamk_f32 v3, v3, 0xbdd2d3e8, v15
    v_fmamk_f32 v4, v4, 0xbdd2d3e8, v15
    s_waitcnt lgkmcnt(2)
    v_mfma_f32_16x16x32_bf16 v[88:91], v[112:115], v[224:227], v[88:91]
    v_mfma_f32_16x16x32_bf16 v[92:95], v[112:115], v[228:231], v[92:95]
    ds_read_b64_tr_b16 v[100:101], v131 offset:20480
    ds_read_b64_tr_b16 v[102:103], v131 offset:20992
    v_mul_f32 v1, v1, v52
    v_mul_f32 v2, v2, v53
    v_mul_f32 v3, v3, v54
    v_mov_b32 v180, v13
    v_mov_b32 v181, v13
    s_waitcnt lgkmcnt(2)
    v_mfma_f32_16x16x32_bf16 v[64:67], v[96:99], v[232:235], v[64:67]
    v_mfma_f32_16x16x32_bf16 v[68:71], v[96:99], v[236:239], v[68:71]
    ds_read_b64_tr_b16 v[108:109], v130 offset:28672
    ds_read_b64_tr_b16 v[110:111], v130 offset:29184
    v_mul_f32 v4, v4, v55
    v_exp_f32 v1, v1
    v_exp_f32 v2, v2
    v_exp_f32 v3, v3
    s_waitcnt lgkmcnt(2)
    v_mfma_f32_16x16x32_bf16 v[80:83], v[100:103], v[232:235], v[80:83]
    v_mfma_f32_16x16x32_bf16 v[84:87], v[100:103], v[236:239], v[84:87]
    ds_read_b64_tr_b16 v[112:113], v131 offset:28672
    ds_read_b64_tr_b16 v[114:115], v131 offset:29184
    v_exp_f32 v4, v4
    v_mul_f32 v60, v52, v60
    v_mul_f32 v61, v53, v61
    v_mov_b32 v182, v13
    v_mov_b32 v183, v13
    s_waitcnt lgkmcnt(2)
    v_mfma_f32_16x16x32_bf16 v[72:75], v[108:111], v[232:235], v[72:75]
    v_mfma_f32_16x16x32_bf16 v[76:79], v[108:111], v[236:239], v[76:79]
    ds_read_b64_tr_b16 v[96:97], v132 offset:32768
    ds_read_b64_tr_b16 v[98:99], v132 offset:33280
    v_mul_f32 v62, v54, v62
    v_mul_f32 v63, v55, v63
    v_add_f32 v1, 1.0, v1
    s_waitcnt lgkmcnt(2)
    v_mfma_f32_16x16x32_bf16 v[88:91], v[112:115], v[232:235], v[88:91]
    v_mfma_f32_16x16x32_bf16 v[92:95], v[112:115], v[236:239], v[92:95]
    ds_read_b64_tr_b16 v[100:101], v133 offset:32768
    ds_read_b64_tr_b16 v[102:103], v133 offset:33280
    v_add_f32 v2, 1.0, v2
    v_add_f32 v3, 1.0, v3
    v_add_f32 v4, 1.0, v4
    s_waitcnt vmcnt(1)
    v_cmp_gt_u32 vcc, 64, v7
    s_nop 0
    s_cbranch_vccz gated_mix__mha_block__glu_gated_geglu__prompt_kernel_ok16
    s_mov_b32 s3, 131072
gated_mix__mha_block__glu_gated_geglu__prompt_kernel_again17:
    buffer_load_dword v7, v8, s[48:51], 0 offen sc1
    s_waitcnt vmcnt(0)
    v_cmp_gt_u32 vcc, 64, v7
    s_nop 0
    s_cbranch_vccz gated_mix__mha_block__glu_gated_geglu__prompt_kernel_ok16
    s_sub_u32 s3, s3, 1
    s_cbranch_scc0 gated_mix__mha_block__glu_gated_geglu__prompt_kernel_again17
gated_mix__mha_block__glu_gated_geglu__prompt_kernel_ok16:
    v_mov_b32 v184, v13
    v_mov_b32 v185, v13
    s_waitcnt lgkmcnt(2)
    v_mfma_f32_16x16x32_bf16 v[64:67], v[96:99], v[240:243], v[64:67]
    v_mfma_f32_16x16x32_bf16 v[68:71], v[96:99], v[244:247], v[68:71]
    ds_read_b64_tr_b16 v[108:109], v132 offset:40960
    ds_read_b64_tr_b16 v[110:111], v132 offset:41472
    v_rcp_f32 v1, v1
    v_rcp_f32 v2, v2
    v_rcp_f32 v3, v3
    v_rcp_f32 v4, v4
    s_waitcnt lgkmcnt(2)
    v_mfma_f32_16x16x32_bf16 v[80:83], v[100:103], v[240:243], v[80:83]
    v_mfma_f32_16x16x32_bf16 v[84:87], v[100:103], v[244:247], v[84:87]
    ds_read_b64_tr_b16 v[112:113], v133 offset:40960
    ds_read_b64_tr_b16 v[114:115], v133 offset:41472
    v_mul_f32 v60, v60, v1
    v_mul_f32 v61, v61, v2
    v_mul_f32 v62, v62, v3
    v_mov_b32 v186, v13
    v_mov_b32 v187, v13
    s_mov_b64 exec, 0x1ffff
    buffer_load_dword v6, v12, s[28:31], 0 offen sc1
    s_mov_b64 exec, -1
    s_waitcnt lgkmcnt(2)
    v_mfma_f32_16x16x32_bf16 v[72:75], v[108:111], v[240:243], v[72:75]
    v_mfma_f32_16x16x32_bf16 v[76:79], v[108:111], v[244:247], v[76:79]
    ds_read_b64_tr_b16 v[96:97], v132 offset:36864
    ds_read_b64_tr_b16 v[98:99], v132 offset:37376
    v_mul_f32 v63, v63, v4
    v_cvt_pk_bf16_f32 v142, v60, v61
    v_cvt_pk_bf16_f32 v143, v62, v63
    s_waitcnt lgkmcnt(2)
    v_mfma_f32_16x16x32_bf16 v[88:91], v[112:115], v[240:243], v[88:91]
    v_mfma_f32_16x16x32_bf16 v[92:95], v[112:115], v[244:247], v[92:95]
    ds_read_b64_tr_b16 v[100:101], v133 offset:36864
    ds_read_b64_tr_b16 v[102:103], v133 offset:37376
    s_add_u32 s59, s63, 1024
    v_permlane16_swap_b32 v140, v142
    v_permlane16_swap_b32 v141, v143
    buffer_store_dwordx4 v[140:143], v134, s[28:31], s59 offen sc1
    v_mov_b32 v188, v13
    v_mov_b32 v189, v13
    s_waitcnt lgkmcnt(2)
    v_mfma_f32_16x16x32_bf16 v[64:67], v[96:99], v[248:251], v[64:67]
    v_mfma_f32_16x16x32_bf16 v[68:71], v[96:99], v[252:255], v[68:71]
    ds_read_b64_tr_b16 v[108:109], v132 offset:45056
    ds_read_b64_tr_b16 v[110:111], v132 offset:45568
    s_waitcnt lgkmcnt(2)
    v_mfma_f32_16x16x32_bf16 v[80:83], v[100:103], v[248:251], v[80:83]
    v_mfma_f32_16x16x32_bf16 v[84:87], v[100:103], v[252:255], v[84:87]
    ds_read_b64_tr_b16 v[112:113], v133 offset:45056
    ds_read_b64_tr_b16 v[114:115], v133 offset:45568
    s_waitcnt lgkmcnt(0)
    v_mov_b32 v190, v13
    v_mov_b32 v191, v13
    v_mfma_f32_16x16x32_bf16 v[72:75], v[108:111], v[248:251], v[72:75]
    v_mfma_f32_16x16x32_bf16 v[76:79], v[108:111], v[252:255], v[76:79]
    s_barrier
    v_mfma_f32_16x16x32_bf16 v[88:91], v[112:115], v[248:251], v[88:91]
    v_mfma_f32_16x16x32_bf16 v[92:95], v[112:115], v[252:255], v[92:95]
    s_waitcnt vmcnt(1)
    s_branch gated_mix__mha_block__glu_gated_geglu__prompt_kernel_a_e2
gated_mix__mha_block__glu_gated_geglu__prompt_kernel_V1_8:
    s_waitcnt lgkmcnt(10)
    v_mfma_f32_16x16x32_bf16 v[16:19], v[144:147], v[108:111], 0
    v_mfma_f32_16x16x32_bf16 v[24:27], v[148:151], v[108:111], 0
    ds_read_b128 v[152:155], v126 offset:0
    ds_read_b128 v[156:159], v126 offset:2048
    ds_read_b64_tr_b16 v[96:97], v129 offset:4096
    ds_read_b64_tr_b16 v[98:99], v129 offset:4608
    s_waitcnt lgkmcnt(12)
    v_mfma_f32_16x16x32_bf16 v[32:35], v[112:115], v[144:147], 0
    v_mfma_f32_16x16x32_bf16 v[36:39], v[112:115], v[148:151], 0
    ds_read_b64_tr_b16 v[100:101], v130 offset:4096
    ds_read_b64_tr_b16 v[102:103], v130 offset:4608
    s_waitcnt lgkmcnt(12)
    v_mfma_f32_16x16x32_bf16 v[48:51], v[116:119], v[144:147], 0
    v_mfma_f32_16x16x32_bf16 v[52:55], v[116:119], v[148:151], 0
    ds_read_b64_tr_b16 v[104:105], v131 offset:4096
    ds_read_b64_tr_b16 v[106:107], v131 offset:4608
    s_waitcnt lgkmcnt(12)
    v_mfma_f32_16x16x32_bf16 v[20:23], v[144:147], v[64:67], 0
    v_mfma_f32_16x16x32_bf16 v[28:31], v[148:151], v[64:67], 0
    ds_read_b64_tr_b16 v[108:109], v127 offset:4096
    ds_read_b64_tr_b16 v[110:111], v127 offset:4608
    s_waitcnt lgkmcnt(12)
    v_mfma_f32_16x16x32_bf16 v[40:43], v[68:71], v[144:147], 0
    v_mfma_f32_16x16x32_bf16 v[44:47], v[68:71], v[148:151], 0
    ds_read_b64_tr_b16 v[112:113], v130 offset:12288
    ds_read_b64_tr_b16 v[114:115], v130 offset:12800
    s_waitcnt lgkmcnt(12)
    v_mfma_f32_16x16x32_bf16 v[56:59], v[72:75], v[144:147], 0
    v_mfma_f32_16x16x32_bf16 v[60:63], v[72:75], v[148:151], 0
    ds_read_b64_tr_b16 v[116:117], v131 offset:12288
    ds_read_b64_tr_b16 v[118:119], v131 offset:12800
    s_waitcnt lgkmcnt(0)
    v_mfma_f32_16x16x32_bf16 v[16:19], v[152:155], v[96:99], v[16:19]
    v_mfma_f32_16x16x32_bf16 v[24:27], v[156:159], v[96:99], v[24:27]
    s_waitcnt vmcnt(6)
    s_barrier
    ds_read_b128 v[160:163], v125 offset:16384
    ds_read_b128 v[164:167], v125 offset:18432
    ds_read_b64_tr_b16 v[64:65], v129 offset:8192
    ds_read_b64_tr_b16 v[66:67], v129 offset:8704
    v_mfma_f32_16x16x32_bf16 v[32:35], v[100:103], v[152:155], v[32:35]
    v_mfma_f32_16x16x32_bf16 v[36:39], v[100:103], v[156:159], v[36:39]
    ds_read_b64_tr_b16 v[68:69], v130 offset:16384
    ds_read_b64_tr_b16 v[70:71], v130 offset:16896
    v_mfma_f32_16x16x32_bf16 v[48:51], v[104:107], v[152:155], v[48:51]
    v_mfma_f32_16x16x32_bf16 v[52:55], v[104:107], v[156:159], v[52:55]
    ds_read_b64_tr_b16 v[72:73], v131 offset:16384
    ds_read_b64_tr_b16 v[74:75], v131 offset:16896
    v_mfma_f32_16x16x32_bf16 v[20:23], v[152:155], v[108:111], v[20:23]
    v_mfma_f32_16x16x32_bf16 v[28:31], v[156:159], v[108:111], v[28:31]
    ds_read_b64_tr_b16 v[96:97], v127 offset:8192
    ds_read_b64_tr_b16 v[98:99], v127 offset:8704
    v_mfma_f32_16x16x32_bf16 v[40:43], v[112:115], v[152:155], v[40:43]
    v_mfma_f32_16x16x32_bf16 v[44:47], v[112:115], v[156:159], v[44:47]
    ds_read_b64_tr_b16 v[100:101], v130 offset:24576
    ds_read_b64_tr_b16 v[102:103], v130 offset:25088
    v_mfma_f32_16x16x32_bf16 v[56:59], v[116:119], v[152:155], v[56:59]
    v_mfma_f32_16x16x32_bf16 v[60:63], v[116:119], v[156:159], v[60:63]
    ds_read_b64_tr_b16 v[104:105], v131 offset:24576
    ds_read_b64_tr_b16 v[106:107], v131 offset:25088
    s_waitcnt lgkmcnt(6)
    v_mfma_f32_16x16x32_bf16 v[16:19], v[160:163], v[64:67], v[16:19]
    v_mfma_f32_16x16x32_bf16 v[24:27], v[164:167], v[64:67], v[24:27]
    ds_read_b128 v[168:171], v126 offset:16384
    ds_read_b128 v[172:175], v126 offset:18432
    ds_read_b64_tr_b16 v[108:109], v129 offset:12288
    ds_read_b64_tr_b16 v[110:111], v129 offset:12800
    v_mfma_f32_16x16x32_bf16 v[32:35], v[68:71], v[160:163], v[32:35]
    v_mfma_f32_16x16x32_bf16 v[36:39], v[68:71], v[164:167], v[36:39]
    ds_read_b64_tr_b16 v[112:113], v130 offset:20480
    ds_read_b64_tr_b16 v[114:115], v130 offset:20992
    v_mfma_f32_16x16x32_bf16 v[48:51], v[72:75], v[160:163], v[48:51]
    v_mfma_f32_16x16x32_bf16 v[52:55], v[72:75], v[164:167], v[52:55]
    ds_read_b64_tr_b16 v[116:117], v131 offset:20480
    ds_read_b64_tr_b16 v[118:119], v131 offset:20992
    s_waitcnt lgkmcnt(8)
    v_mfma_f32_16x16x32_bf16 v[20:23], v[160:163], v[96:99], v[20:23]
    v_mfma_f32_16x16x32_bf16 v[28:31], v[164:167], v[96:99], v[28:31]
    ds_read_b64_tr_b16 v[64:65], v127 offset:12288
    ds_read_b64_tr_b16 v[66:67], v127 offset:12800
    v_mfma_f32_16x16x32_bf16 v[40:43], v[100:103], v[160:163], v[40:43]
    v_mfma_f32_16x16x32_bf16 v[44:47], v[100:103], v[164:167], v[44:47]
    ds_read_b64_tr_b16 v[68:69], v130 offset:28672
    ds_read_b64_tr_b16 v[70:71], v130 offset:29184
    v_mfma_f32_16x16x32_bf16 v[56:59], v[104:107], v[160:163], v[56:59]
    v_mfma_f32_16x16x32_bf16 v[60:63], v[104:107], v[164:167], v[60:63]
    ds_read_b64_tr_b16 v[72:73], v131 offset:28672
    ds_read_b64_tr_b16 v[74:75], v131 offset:29184
    s_waitcnt lgkmcnt(0)
    v_mfma_f32_16x16x32_bf16 v[16:19], v[168:171], v[108:111], v[16:19]
    v_mfma_f32_16x16x32_bf16 v[24:27], v[172:175], v[108:111], v[24:27]
    s_barrier
    ds_read_b128 v[176:179], v125 offset:32768
    ds_read_b128 v[180:183], v125 offset:34816
    ds_read_b64_tr_b16 v[96:97], v129 offset:16384
    ds_read_b64_tr_b16 v[98:99], v129 offset:16896
    v_mfma_f32_16x16x32_bf16 v[32:35], v[112:115], v[168:171], v[32:35]
    v_mfma_f32_16x16x32_bf16 v[36:39], v[112:115], v[172:175], v[36:39]
    ds_read_b64_tr_b16 v[100:101], v130 offset:32768
    ds_read_b64_tr_b16 v[102:103], v130 offset:33280
    v_mfma_f32_16x16x32_bf16 v[48:51], v[116:119], v[168:171], v[48:51]
    v_mfma_f32_16x16x32_bf16 v[52:55], v[116:119], v[172:175], v[52:55]
    ds_read_b64_tr_b16 v[104:105], v131 offset:32768
    ds_read_b64_tr_b16 v[106:107], v131 offset:33280
    v_mfma_f32_16x16x32_bf16 v[20:23], v[168:171], v[64:67], v[20:23]
    v_mfma_f32_16x16x32_bf16 v[28:31], v[172:175], v[64:67], v[28:31]
    ds_read_b64_tr_b16 v[108:109], v127 offset:16384
    ds_read_b64_tr_b16 v[110:111], v127 offset:16896
    v_mfma_f32_16x16x32_bf16 v[40:43], v[68:71], v[168:171], v[40:43]
    v_mfma_f32_16x16x32_bf16 v[44:47], v[68:71], v[172:175], v[44:47]
    ds_read_b64_tr_b16 v[112:113], v130 offset:40960
    ds_read_b64_tr_b16 v[114:115], v130 offset:41472
    v_mfma_f32_16x16x32_bf16 v[56:59], v[72:75], v[168:171], v[56:59]
    v_mfma_f32_16x16x32_bf16 v[60:63], v[72:75], v[172:175], v[60:63]
    ds_read_b64_tr_b16 v[116:117], v131 offset:40960
    ds_read_b64_tr_b16 v[118:119], v131 offset:41472
    s_waitcnt lgkmcnt(6)
    v_mfma_f32_16x16x32_bf16 v[16:19], v[176:179], v[96:99], v[16:19]
    v_mfma_f32_16x16x32_bf16 v[24:27], v[180:183], v[96:99], v[24:27]
    ds_read_b128 v[184:187], v126 offset:32768
    ds_read_b128 v[188:191], v126 offset:34816
    ds_read_b64_tr_b16 v[64:65], v129 offset:20480
    ds_read_b64_tr_b16 v[66:67], v129 offset:20992
    v_mfma_f32_16x16x32_bf16 v[32:35], v[100:103], v[176:179], v[32:35]
    v_mfma_f32_16x16x32_bf16 v[36:39], v[100:103], v[180:183], v[36:39]
    ds_read_b64_tr_b16 v[68:69], v130 offset:36864
    ds_read_b64_tr_b16 v[70:71], v130 offset:37376
    v_mfma_f32_16x16x32_bf16 v[48:51], v[104:107], v[176:179], v[48:51]
    v_mfma_f32_16x16x32_bf16 v[52:55], v[104:107], v[180:183], v[52:55]
    ds_read_b64_tr_b16 v[72:73], v131 offset:36864
    ds_read_b64_tr_b16 v[74:75], v131 offset:37376
    s_waitcnt lgkmcnt(8)
    v_mfma_f32_16x16x32_bf16 v[20:23], v[176:179], v[108:111], v[20:23]
    v_mfma_f32_16x16x32_bf16 v[28:31], v[180:183], v[108:111], v[28:31]
    ds_read_b64_tr_b16 v[96:97], v127 offset:20480
    ds_read_b64_tr_b16 v[98:99], v127 offset:20992
    v_mov_b32 v1, 0
    v_mfma_f32_16x16x32_bf16 v[40:43], v[112:115], v[176:179], v[40:43]
    v_mfma_f32_16x16x32_bf16 v[44:47], v[112:115], v[180:183], v[44:47]
    ds_read_b64_tr_b16 v[100:101], v130 offset:45056
    ds_read_b64_tr_b16 v[102:103], v130 offset:45568
    s_waitcnt vmcnt(0)
    v_dot2_f32_bf16 v1, v136, v140, v1
    v_mfma_f32_16x16x32_bf16 v[56:59], v[116:119], v[176:179], v[56:59]
    v_mfma_f32_16x16x32_bf16 v[60:63], v[116:119], v[180:183], v[60:63]
    ds_read_b64_tr_b16 v[104:105], v131 offset:45056
    ds_read_b64_tr_b16 v[106:107], v131 offset:45568
    v_dot2_f32_bf16 v1, v137, v141, v1
    s_waitcnt lgkmcnt(0)
    v_mfma_f32_16x16x32_bf16 v[16:19], v[184:187], v[64:67], v[16:19]
    v_mfma_f32_16x16x32_bf16 v[24:27], v[188:191], v[64:67], v[24:27]
    s_barrier
    ds_read_b128 v[192:195], v125 offset:49152
    ds_read_b128 v[196:199], v125 offset:51200
    ds_read_b64_tr_b16 v[108:109], v129 offset:24576
    ds_read_b64_tr_b16 v[110:111], v129 offset:25088
    v_dot2_f32_bf16 v1, v138, v142, v1
    v_mfma_f32_16x16x32_bf16 v[32:35], v[68:71], v[184:187], v[32:35]
    v_mfma_f32_16x16x32_bf16 v[36:39], v[68:71], v[188:191], v[36:39]
    ds_read_b64_tr_b16 v[112:113], v130 offset:49152
    ds_read_b64_tr_b16 v[114:115], v130 offset:49664
    v_dot2_f32_bf16 v1, v139, v143, v1
    s_nop 2
    v_add_f32_dpp v1, v1, v1 row_shr:1 row_mask:0xf bank_mask:0xf
    v_mfma_f32_16x16x32_bf16 v[48:51], v[72:75], v[184:187], v[48:51]
    v_mfma_f32_16x16x32_bf16 v[52:55], v[72:75], v[188:191], v[52:55]
    ds_read_b64_tr_b16 v[116:117], v131 offset:49152
    ds_read_b64_tr_b16 v[118:119], v131 offset:49664
    v_add_f32_dpp v1, v1, v1 row_shr:2 row_mask:0xf bank_mask:0xf
    v_mfma_f32_16x16x32_bf16 v[20:23], v[184:187], v[96:99], v[20:23]
    v_mfma_f32_16x16x32_bf16 v[28:31], v[188:191], v[96:99], v[28:31]
    ds_read_b64_tr_b16 v[64:65], v127 offset:24576
    ds_read_b64_tr_b16 v[66:67], v127 offset:25088
    v_add_f32_dpp v1, v1, v1 row_shr:4 row_mask:0xf bank_mask:0xf
    v_mfma_f32_16x16x32_bf16 v[40:43], v[100:103], v[184:187], v[40:43]
    v_mfma_f32_16x16x32_bf16 v[44:47], v[100:103], v[188:191], v[44:47]
    ds_read_b64_tr_b16 v[68:69], v130 offset:57344
    ds_read_b64_tr_b16 v[70:71], v130 offset:57856
    v_add_f32_dpp v1, v1, v1 row_shr:8 row_mask:0xf bank_mask:0xf
    v_mfma_f32_16x16x32_bf16 v[56:59], v[104:107], v[184:187], v[56:59]
    v_mfma_f32_16x16x32_bf16 v[60:63], v[104:107], v[188:191], v[60:63]
    ds_read_b64_tr_b16 v[72:73], v131 offset:57344
    ds_read_b64_tr_b16 v[74:75], v131 offset:57856
    v_add_f32_dpp v1, v1, v1 row_bcast:15 row_mask:0xa bank_mask:0xf
    s_waitcnt lgkmcnt(6)
    v_mfma_f32_16x16x32_bf16 v[16:19], v[192:195], v[108:111], v[16:19]
    v_mfma_f32_16x16x32_bf16 v[24:27], v[196:199], v[108:111], v[24:27]
    ds_read_b128 v[200:203], v126 offset:49152
    ds_read_b128 v[204:207], v126 offset:51200
    ds_read_b64_tr_b16 v[96:97], v129 offset:28672
    ds_read_b64_tr_b16 v[98:99], v129 offset:29184
    v_add_f32_dpp v1, v1, v1 row_bcast:31 row_mask:0xc bank_mask:0xf
    v_mul_f32 v1, 0xbfb8aa3b, v1
    v_mfma_f32_16x16x32_bf16 v[32:35], v[112:115], v[192:195], v[32:35]
    v_mfma_f32_16x16x32_bf16 v[36:39], v[112:115], v[196:199], v[36:39]
    ds_read_b64_tr_b16 v[100:101], v130 offset:53248
    ds_read_b64_tr_b16 v[102:103], v130 offset:53760
    v_exp_f32 v1, v1
    v_mfma_f32_16x16x32_bf16 v[48:51], v[116:119], v[192:195], v[48:51]
    v_mfma_f32_16x16x32_bf16 v[52:55], v[116:119], v[196:199], v[52:55]
    ds_read_b64_tr_b16 v[104:105], v131 offset:53248
    ds_read_b64_tr_b16 v[106:107], v131 offset:53760
    s_lshl_b32 s3, s3, 2
    s_waitcnt lgkmcnt(8)
    v_mfma_f32_16x16x32_bf16 v[20:23], v[192:195], v[64:67], v[20:23]
    v_mfma_f32_16x16x32_bf16 v[28:31], v[196:199], v[64:67], v[28:31]
    ds_read_b64_tr_b16 v[108:109], v127 offset:28672
    ds_read_b64_tr_b16 v[110:111], v127 offset:29184
    v_add_f32 v1, 1.0, v1
    v_mfma_f32_16x16x32_bf16 v[40:43], v[68:71], v[192:195], v[40:43]
    v_mfma_f32_16x16x32_bf16 v[44:47], v[68:71], v[196:199], v[44:47]
    ds_read_b64_tr_b16 v[112:113], v130 offset:61440
    ds_read_b64_tr_b16 v[114:115], v130 offset:61952
    v_rcp_f32 v1, v1
    v_mfma_f32_16x16x32_bf16 v[56:59], v[72:75], v[192:195], v[56:59]
    v_mfma_f32_16x16x32_bf16 v[60:63], v[72:75], v[196:199], v[60:63]
    ds_read_b64_tr_b16 v[116:117], v131 offset:61440
    ds_read_b64_tr_b16 v[118:119], v131 offset:61952
    s_add_u32 s3, s3, 14942208
    s_mov_b32 exec_lo, 0
    s_mov_b32 exec_hi, 0x80000000
    buffer_store_dword v1, off, s[28:31], s3 sc1
    s_mov_b64 exec, -1
    s_waitcnt lgkmcnt(0)
    v_mfma_f32_16x16x32_bf16 v[16:19], v[200:203], v[96:99], v[16:19]
    v_mfma_f32_16x16x32_bf16 v[24:27], v[204:207], v[96:99], v[24:27]
    s_barrier
    ds_read_b128 v[208:211], v125 offset:0
    ds_read_b128 v[212:215], v125 offset:2048
    ds_read_b64_tr_b16 v[64:65], v129 offset:0
    ds_read_b64_tr_b16 v[66:67], v129 offset:512
    s_lshl_b32 s0, s52, 2
    v_mfma_f32_16x16x32_bf16 v[32:35], v[100:103], v[200:203], v[32:35]
    v_mfma_f32_16x16x32_bf16 v[36:39], v[100:103], v[204:207], v[36:39]
    ds_read_b64_tr_b16 v[68:69], v130 offset:0
    ds_read_b64_tr_b16 v[70:71], v130 offset:512
    s_add_u32 s0, s0, s60
    v_mfma_f32_16x16x32_bf16 v[48:51], v[104:107], v[200:203], v[48:51]
    v_mfma_f32_16x16x32_bf16 v[52:55], v[104:107], v[204:207], v[52:55]
    ds_read_b64_tr_b16 v[72:73], v131 offset:0
    ds_read_b64_tr_b16 v[74:75], v131 offset:512
    s_mul_i32 s62, s0, 28672
    v_mfma_f32_16x16x32_bf16 v[20:23], v[200:203], v[108:111], v[20:23]
    v_mfma_f32_16x16x32_bf16 v[28:31], v[204:207], v[108:111], v[28:31]
    ds_read_b64_tr_b16 v[96:97], v127 offset:0
    ds_read_b64_tr_b16 v[98:99], v127 offset:512
    s_mul_i32 s63, s0, 114688
    s_lshl_b32 s0, s53, 13
    v_mfma_f32_16x16x32_bf16 v[40:43], v[112:115], v[200:203], v[40:43]
    v_mfma_f32_16x16x32_bf16 v[44:47], v[112:115], v[204:207], v[44:47]
    ds_read_b64_tr_b16 v[100:101], v130 offset:8192
    ds_read_b64_tr_b16 v[102:103], v130 offset:8704
    s_add_u32 s63, s63, s0
    v_mfma_f32_16x16x32_bf16 v[56:59], v[116:119], v[200:203], v[56:59]
    v_mfma_f32_16x16x32_bf16 v[60:63], v[116:119], v[204:207], v[60:63]
    ds_read_b64_tr_b16 v[104:105], v131 offset:8192
    ds_read_b64_tr_b16 v[106:107], v131 offset:8704
    s_add_u32 s63, s63, 5507072
    s_waitcnt lgkmcnt(6)
    v_mfma_f32_16x16x32_bf16 v[16:19], v[208:211], v[64:67], v[16:19]
    v_mfma_f32_16x16x32_bf16 v[24:27], v[212:215], v[64:67], v[24:27]
    ds_read_b128 v[216:219], v126 offset:0
    ds_read_b128 v[220:223], v126 offset:2048
    ds_read_b64_tr_b16 v[108:109], v129 offset:4096
    ds_read_b64_tr_b16 v[110:111], v129 offset:4608
    s_lshl_b32 s0, s53, 10
    v_mfma_f32_16x16x32_bf16 v[32:35], v[68:71], v[208:211], v[32:35]
    v_mfma_f32_16x16x32_bf16 v[36:39], v[68:71], v[212:215], v[36:39]
    ds_read_b64_tr_b16 v[112:113], v130 offset:4096
    ds_read_b64_tr_b16 v[114:115], v130 offset:4608
    s_add_u32 s62, s62, s0
    s_add_u32 s62, s62, 3663360
    v_mfma_f32_16x16x32_bf16 v[48:51], v[72:75], v[208:211], v[48:51]
    v_mfma_f32_16x16x32_bf16 v[52:55], v[72:75], v[212:215], v[52:55]
    ds_read_b64_tr_b16 v[116:117], v131 offset:4096
    ds_read_b64_tr_b16 v[118:119], v131 offset:4608
    v_lshrrev_b32 v135, 5, v0
    s_waitcnt lgkmcnt(8)
    v_mfma_f32_16x16x32_bf16 v[20:23], v[208:211], v[96:99], v[20:23]
    v_mfma_f32_16x16x32_bf16 v[28:31], v[212:215], v[96:99], v[28:31]
    ds_read_b64_tr_b16 v[64:65], v127 offset:4096
    ds_read_b64_tr_b16 v[66:67], v127 offset:4608
    v_mul_u32_u24 v135, 6656, v135
    v_mfma_f32_16x16x32_bf16 v[40:43], v[100:103], v[208:211], v[40:43]
    v_mfma_f32_16x16x32_bf16 v[44:47], v[100:103], v[212:215], v[44:47]
    ds_read_b64_tr_b16 v[68:69], v130 offset:12288
    ds_read_b64_tr_b16 v[70:71], v130 offset:12800
    v_add_u32 v135, v135, v134
    v_mfma_f32_16x16x32_bf16 v[56:59], v[104:107], v[208:211], v[56:59]
    v_mfma_f32_16x16x32_bf16 v[60:63], v[104:107], v[212:215], v[60:63]
    ds_read_b64_tr_b16 v[72:73], v131 offset:12288
    ds_read_b64_tr_b16 v[74:75], v131 offset:12800
    s_mov_b32 s72, s16
    s_mov_b32 s73, s17
    s_waitcnt lgkmcnt(0)
    v_mfma_f32_16x16x32_bf16 v[16:19], v[216:219], v[108:111], v[16:19]
    v_mfma_f32_16x16x32_bf16 v[24:27], v[220:223], v[108:111], v[24:27]
    s_barrier
    ds_read_b128 v[224:227], v125 offset:16384
    ds_read_b128 v[228:231], v125 offset:18432
    ds_read_b64_tr_b16 v[96:97], v129 offset:8192
    ds_read_b64_tr_b16 v[98:99], v129 offset:8704
    s_mov_b32 s74, 1605632
    v_mfma_f32_16x16x32_bf16 v[32:35], v[112:115], v[216:219], v[32:35]
    v_mfma_f32_16x16x32_bf16 v[36:39], v[112:115], v[220:223], v[36:39]
    ds_read_b64_tr_b16 v[100:101], v130 offset:16384
    ds_read_b64_tr_b16 v[102:103], v130 offset:16896
    s_mov_b32 s75, 0x00020000
    v_mfma_f32_16x16x32_bf16 v[48:51], v[116:119], v[216:219], v[48:51]
    v_mfma_f32_16x16x32_bf16 v[52:55], v[116:119], v[220:223], v[52:55]
    ds_read_b64_tr_b16 v[104:105], v131 offset:16384
    ds_read_b64_tr_b16 v[106:107], v131 offset:16896
    v_lshrrev_b32 v5, 3, v0
    v_mfma_f32_16x16x32_bf16 v[20:23], v[216:219], v[64:67], v[20:23]
    v_mfma_f32_16x16x32_bf16 v[28:31], v[220:223], v[64:67], v[28:31]
    ds_read_b64_tr_b16 v[108:109], v127 offset:8192
    ds_read_b64_tr_b16 v[110:111], v127 offset:8704
    v_mul_u32_u24 v6, 896, v5
    v_lshrrev_b32 v5, 2, v0
    v_mfma_f32_16x16x32_bf16 v[40:43], v[68:71], v[216:219], v[40:43]
    v_mfma_f32_16x16x32_bf16 v[44:47], v[68:71], v[220:223], v[44:47]
    ds_read_b64_tr_b16 v[112:113], v130 offset:24576
    ds_read_b64_tr_b16 v[114:115], v130 offset:25088
    v_and_b32 v5, 4, v5
    v_mfma_f32_16x16x32_bf16 v[56:59], v[72:75], v[216:219], v[56:59]
    v_mfma_f32_16x16x32_bf16 v[60:63], v[72:75], v[220:223], v[60:63]
    ds_read_b64_tr_b16 v[116:117], v131 offset:24576
    ds_read_b64_tr_b16 v[118:119], v131 offset:25088
    v_and_b32 v7, 7, v0
    s_waitcnt lgkmcnt(6)
    v_mfma_f32_16x16x32_bf16 v[16:19], v[224:227], v[96:99], v[16:19]
    v_mfma_f32_16x16x32_bf16 v[24:27], v[228:231], v[96:99], v[24:27]
    ds_read_b128 v[232:235], v126 offset:16384
    ds_read_b128 v[236:239], v126 offset:18432
    ds_read_b64_tr_b16 v[64:65], v129 offset:12288
    ds_read_b64_tr_b16 v[66:67], v129 offset:12800
    v_xor_b32 v5, v5, v7
    v_mfma_f32_16x16x32_bf16 v[32:35], v[100:103], v[224:227], v[32:35]
    v_mfma_f32_16x16x32_bf16 v[36:39], v[100:103], v[228:231], v[36:39]
    ds_read_b64_tr_b16 v[68:69], v130 offset:20480
    ds_read_b64_tr_b16 v[70:71], v130 offset:20992
    v_lshl_add_u32 v9, v5, 4, v6
    v_add_u32 v10, 6144, v9
    v_mfma_f32_16x16x32_bf16 v[48:51], v[104:107], v[224:227], v[48:51]
    v_mfma_f32_16x16x32_bf16 v[52:55], v[104:107], v[228:231], v[52:55]
    ds_read_b64_tr_b16 v[72:73], v131 offset:20480
    ds_read_b64_tr_b16 v[74:75], v131 offset:20992
    s_and_b32 s70, s26, 3
    s_waitcnt lgkmcnt(8)
    v_mfma_f32_16x16x32_bf16 v[20:23], v[224:227], v[108:111], v[20:23]
    v_mfma_f32_16x16x32_bf16 v[28:31], v[228:231], v[108:111], v[28:31]
    ds_read_b64_tr_b16 v[96:97], v127 offset:12288
    ds_read_b64_tr_b16 v[98:99], v127 offset:12800
    s_mul_i32 s81, s70, 14336
    v_mfma_f32_16x16x32_bf16 v[40:43], v[112:115], v[224:227], v[40:43]
    v_mfma_f32_16x16x32_bf16 v[44:47], v[112:115], v[228:231], v[44:47]
    ds_read_b64_tr_b16 v[100:101], v130 offset:28672
    ds_read_b64_tr_b16 v[102:103], v130 offset:29184
    s_mul_i32 s80, s70, 12288
    v_mfma_f32_16x16x32_bf16 v[56:59], v[116:119], v[224:227], v[56:59]
    v_mfma_f32_16x16x32_bf16 v[60:63], v[116:119], v[228:231], v[60:63]
    ds_read_b64_tr_b16 v[104:105], v131 offset:28672
    ds_read_b64_tr_b16 v[106:107], v131 offset:29184
    s_add_u32 s80, s80, 57344
    s_lshr_b32 s0, s2, 3
    s_lshl_b32 s18, s2, 3
    s_add_u32 s18, s18, s26
    s_lshl_b32 s19, s18, 7
    v_lshl_add_u32 v13, v0, 18, s19
    s_mov_b32 s4, s16
    s_mov_b32 s5, s17
    s_mov_b32 s6, 1605632
    s_mov_b32 s7, 0x00020000
    s_mov_b32 s12, s8
    s_mov_b32 s13, s9
    s_mov_b32 s14, 401408
    s_mov_b32 s15, 0x00020000
    s_mov_b64 exec, 0x7f
    buffer_load_dword v11, v13, s[4:7], 0 offen
    buffer_load_dword v11, v13, s[12:15], 0 offen
    s_mov_b64 exec, -1
    s_waitcnt lgkmcnt(0)
    v_mfma_f32_16x16x32_bf16 v[16:19], v[232:235], v[64:67], v[16:19]
    v_mfma_f32_16x16x32_bf16 v[24:27], v[236:239], v[64:67], v[24:27]
    s_waitcnt vmcnt(2)
    s_barrier
    s_mov_b32 s48, s22
    s_mov_b32 s49, s23
    s_mov_b32 s50, 256
    s_mov_b32 s51, 0x00020000
    ds_read_b128 v[240:243], v125 offset:32768
    ds_read_b128 v[244:247], v125 offset:34816
    ds_read_b64_tr_b16 v[108:109], v129 offset:16384
    ds_read_b64_tr_b16 v[110:111], v129 offset:16896
    s_bitcmp1_b32 s2, 0
    s_cselect_b32 s1, 32, 0
    s_cselect_b32 s69, 24, 32
    v_mfma_f32_16x16x32_bf16 v[32:35], v[68:71], v[232:235], v[32:35]
    v_mfma_f32_16x16x32_bf16 v[36:39], v[68:71], v[236:239], v[36:39]
    ds_read_b64_tr_b16 v[112:113], v130 offset:32768
    ds_read_b64_tr_b16 v[114:115], v130 offset:33280
    s_cmp_ge_u32 s0, s69
    s_cselect_b32 s69, 7, 0
    v_mfma_f32_16x16x32_bf16 v[48:51], v[72:75], v[232:235], v[48:51]
    v_mfma_f32_16x16x32_bf16 v[52:55], v[72:75], v[236:239], v[52:55]
    ds_read_b64_tr_b16 v[116:117], v131 offset:32768
    ds_read_b64_tr_b16 v[118:119], v131 offset:33280
    s_add_u32 s0, s0, s1
    v_mfma_f32_16x16x32_bf16 v[20:23], v[232:235], v[96:99], v[20:23]
    v_mfma_f32_16x16x32_bf16 v[28:31], v[236:239], v[96:99], v[28:31]
    ds_read_b64_tr_b16 v[64:65], v127 offset:16384
    ds_read_b64_tr_b16 v[66:67], v127 offset:16896
    s_mul_i32 s68, s0, 9363
    s_lshr_b32 s68, s68, 16
    v_mfma_f32_16x16x32_bf16 v[40:43], v[100:103], v[232:235], v[40:43]
    v_mfma_f32_16x16x32_bf16 v[44:47], v[100:103], v[236:239], v[44:47]
    ds_read_b64_tr_b16 v[68:69], v130 offset:40960
    ds_read_b64_tr_b16 v[70:71], v130 offset:41472
    s_mul_i32 s1, s68, 7
    v_mfma_f32_16x16x32_bf16 v[56:59], v[104:107], v[232:235], v[56:59]
    v_mfma_f32_16x16x32_bf16 v[60:63], v[104:107], v[236:239], v[60:63]
    ds_read_b64_tr_b16 v[72:73], v131 offset:40960
    ds_read_b64_tr_b16 v[74:75], v131 offset:41472
    s_sub_u32 s0, s0, s1
    s_waitcnt lgkmcnt(6)
    v_mfma_f32_16x16x32_bf16 v[16:19], v[240:243], v[108:111], v[16:19]
    v_mfma_f32_16x16x32_bf16 v[24:27], v[244:247], v[108:111], v[24:27]
    ds_read_b128 v[248:251], v126 offset:32768
    ds_read_b128 v[252:255], v126 offset:34816
    ds_read_b64_tr_b16 v[96:97], v129 offset:20480
    ds_read_b64_tr_b16 v[98:99], v129 offset:20992
    s_or_b32 s69, s69, s0
    v_mfma_f32_16x16x32_bf16 v[32:35], v[112:115], v[240:243], v[32:35]
    v_mfma_f32_16x16x32_bf16 v[36:39], v[112:115], v[244:247], v[36:39]
    ds_read_b64_tr_b16 v[100:101], v130 offset:36864
    ds_read_b64_tr_b16 v[102:103], v130 offset:37376
    s_min_u32 s68, s68, 7
    s_bfe_u32 s0, s2, 0x20001
    v_mfma_f32_16x16x32_bf16 v[48:51], v[116:119], v[240:243], v[48:51]
    v_mfma_f32_16x16x32_bf16 v[52:55], v[116:119], v[244:247], v[52:55]
    ds_read_b64_tr_b16 v[104:105], v131 offset:36864
    ds_read_b64_tr_b16 v[106:107], v131 offset:37376
    s_lshl_b32 s0, s0, 3
    s_waitcnt lgkmcnt(8)
    v_mfma_f32_16x16x32_bf16 v[20:23], v[240:243], v[64:67], v[20:23]
    v_mfma_f32_16x16x32_bf16 v[28:31], v[244:247], v[64:67], v[28:31]
    ds_read_b64_tr_b16 v[108:109], v127 offset:20480
    ds_read_b64_tr_b16 v[110:111], v127 offset:20992
    s_add_u32 s68, s68, s0
    v_mfma_f32_16x16x32_bf16 v[40:43], v[68:71], v[240:243], v[40:43]
    v_mfma_f32_16x16x32_bf16 v[44:47], v[68:71], v[244:247], v[44:47]
    ds_read_b64_tr_b16 v[112:113], v130 offset:45056
    ds_read_b64_tr_b16 v[114:115], v130 offset:45568
    s_lshl_b32 s0, s69, 7
    v_mfma_f32_16x16x32_bf16 v[56:59], v[72:75], v[240:243], v[56:59]
    v_mfma_f32_16x16x32_bf16 v[60:63], v[72:75], v[244:247], v[60:63]
    ds_read_b64_tr_b16 v[116:117], v131 offset:45056
    ds_read_b64_tr_b16 v[118:119], v131 offset:45568
    s_mul_i32 s82, s70, 401408
    s_add_u32 s82, s82, s0
    s_waitcnt lgkmcnt(6)
    v_mfma_f32_16x16x32_bf16 v[16:19], v[248:251], v[96:99], v[16:19]
    v_mfma_f32_16x16x32_bf16 v[24:27], v[252:255], v[96:99], v[24:27]
    v_mfma_f32_16x16x32_bf16 v[32:35], v[100:103], v[248:251], v[32:35]
    v_mfma_f32_16x16x32_bf16 v[36:39], v[100:103], v[252:255], v[36:39]
    v_mfma_f32_16x16x32_bf16 v[48:51], v[104:107], v[248:251], v[48:51]
    v_mfma_f32_16x16x32_bf16 v[52:55], v[104:107], v[252:255], v[52:55]
    s_waitcnt lgkmcnt(0)
    v_mfma_f32_16x16x32_bf16 v[20:23], v[248:251], v[108:111], v[20:23]
    v_mfma_f32_16x16x32_bf16 v[28:31], v[252:255], v[108:111], v[28:31]
    s_barrier
    ds_read_b64_tr_b16 v[96:97], v132 offset:49152
    ds_read_b64_tr_b16 v[98:99], v132 offset:49664
    v_mfma_f32_16x16x32_bf16 v[40:43], v[112:115], v[248:251], v[40:43]
    v_mfma_f32_16x16x32_bf16 v[44:47], v[112:115], v[252:255], v[44:47]
    ds_read_b64_tr_b16 v[100:101], v133 offset:49152
    ds_read_b64_tr_b16 v[102:103], v133 offset:49664
    v_mfma_f32_16x16x32_bf16 v[56:59], v[116:119], v[248:251], v[56:59]
    v_mfma_f32_16x16x32_bf16 v[60:63], v[116:119], v[252:255], v[60:63]
    s_waitcnt lgkmcnt(2)
    v_mfma_f32_16x16x32_bf16 v[64:67], v[96:99], v[144:147], 0
    v_mfma_f32_16x16x32_bf16 v[68:71], v[96:99], v[148:151], 0
    ds_read_b64_tr_b16 v[108:109], v132 offset:57344
    ds_read_b64_tr_b16 v[110:111], v132 offset:57856
    v_cvt_pk_bf16_f32 v136, v16, v17
    v_cvt_pk_bf16_f32 v137, v18, v19
    v_cvt_pk_bf16_f32 v138, v20, v21
    v_cvt_pk_bf16_f32 v139, v22, v23
    v_cvt_pk_bf16_f32 v140, v24, v25
    v_cvt_pk_bf16_f32 v141, v26, v27
    v_cvt_pk_bf16_f32 v142, v28, v29
    v_cvt_pk_bf16_f32 v143, v30, v31
    s_waitcnt lgkmcnt(2)
    v_mfma_f32_16x16x32_bf16 v[80:83], v[100:103], v[144:147], 0
    v_mfma_f32_16x16x32_bf16 v[84:87], v[100:103], v[148:151], 0
    ds_read_b64_tr_b16 v[112:113], v133 offset:57344
    ds_read_b64_tr_b16 v[114:115], v133 offset:57856
    s_add_u32 s59, s62, 14336
    v_permlane16_swap_b32 v136, v138
    v_permlane16_swap_b32 v137, v139
    v_permlane16_swap_b32 v140, v142
    v_permlane16_swap_b32 v141, v143
    v_permlane32_swap_b32 v136, v138
    v_permlane32_swap_b32 v137, v139
    v_permlane32_swap_b32 v140, v142
    s_waitcnt lgkmcnt(2)
    v_mfma_f32_16x16x32_bf16 v[72:75], v[108:111], v[144:147], 0
    v_mfma_f32_16x16x32_bf16 v[76:79], v[108:111], v[148:151], 0
    ds_read_b64_tr_b16 v[96:97], v132 offset:53248
    ds_read_b64_tr_b16 v[98:99], v132 offset:53760
    v_permlane32_swap_b32 v141, v143
    buffer_store_dwordx4 v[136:139], v135, s[28:31], s62 offen sc1
    buffer_store_dwordx4 v[140:143], v135, s[28:31], s59 offen sc1
    s_waitcnt lgkmcnt(2)
    v_mfma_f32_16x16x32_bf16 v[88:91], v[112:115], v[144:147], 0
    v_mfma_f32_16x16x32_bf16 v[92:95], v[112:115], v[148:151], 0
    ds_read_b64_tr_b16 v[100:101], v133 offset:53248
    ds_read_b64_tr_b16 v[102:103], v133 offset:53760
    s_waitcnt lgkmcnt(2)
    v_mfma_f32_16x16x32_bf16 v[64:67], v[96:99], v[152:155], v[64:67]
    v_mfma_f32_16x16x32_bf16 v[68:71], v[96:99], v[156:159], v[68:71]
    ds_read_b64_tr_b16 v[108:109], v132 offset:61440
    ds_read_b64_tr_b16 v[110:111], v132 offset:61952
    s_waitcnt lgkmcnt(2)
    v_mfma_f32_16x16x32_bf16 v[80:83], v[100:103], v[152:155], v[80:83]
    v_mfma_f32_16x16x32_bf16 v[84:87], v[100:103], v[156:159], v[84:87]
    ds_read_b64_tr_b16 v[112:113], v133 offset:61440
    ds_read_b64_tr_b16 v[114:115], v133 offset:61952
    s_waitcnt lgkmcnt(2)
    v_mfma_f32_16x16x32_bf16 v[72:75], v[108:111], v[152:155], v[72:75]
    v_mfma_f32_16x16x32_bf16 v[76:79], v[108:111], v[156:159], v[76:79]
    ds_read_b64_tr_b16 v[96:97], v130 offset:49152
    ds_read_b64_tr_b16 v[98:99], v130 offset:49664
    s_waitcnt lgkmcnt(2)
    v_mfma_f32_16x16x32_bf16 v[88:91], v[112:115], v[152:155], v[88:91]
    v_mfma_f32_16x16x32_bf16 v[92:95], v[112:115], v[156:159], v[92:95]
    ds_read_b64_tr_b16 v[100:101], v131 offset:49152
    ds_read_b64_tr_b16 v[102:103], v131 offset:49664
    s_waitcnt lgkmcnt(2)
    v_mfma_f32_16x16x32_bf16 v[64:67], v[96:99], v[160:163], v[64:67]
    v_mfma_f32_16x16x32_bf16 v[68:71], v[96:99], v[164:167], v[68:71]
    ds_read_b64_tr_b16 v[108:109], v130 offset:57344
    ds_read_b64_tr_b16 v[110:111], v130 offset:57856
    v_mul_f32 v1, v32, v32
    v_mul_f32 v2, v33, v33
    v_mul_f32 v3, v34, v34
    s_waitcnt lgkmcnt(2)
    v_mfma_f32_16x16x32_bf16 v[80:83], v[100:103], v[160:163], v[80:83]
    v_mfma_f32_16x16x32_bf16 v[84:87], v[100:103], v[164:167], v[84:87]
    ds_read_b64_tr_b16 v[112:113], v131 offset:57344
    ds_read_b64_tr_b16 v[114:115], v131 offset:57856
    v_mul_f32 v4, v35, v35
    v_fmamk_f32 v1, v1, 0xbdd2d3e8, v15
    v_fmamk_f32 v2, v2, 0xbdd2d3e8, v15
    v_fmamk_f32 v3, v3, 0xbdd2d3e8, v15
    s_waitcnt lgkmcnt(2)
    v_mfma_f32_16x16x32_bf16 v[72:75], v[108:111], v[160:163], v[72:75]
    v_mfma_f32_16x16x32_bf16 v[76:79], v[108:111], v[164:167], v[76:79]
    ds_read_b64_tr_b16 v[96:97], v130 offset:53248
    ds_read_b64_tr_b16 v[98:99], v130 offset:53760
    v_fmamk_f32 v4, v4, 0xbdd2d3e8, v15
    v_mul_f32 v1, v1, v32
    v_mul_f32 v2, v2, v33
    s_waitcnt lgkmcnt(2)
    v_mfma_f32_16x16x32_bf16 v[88:91], v[112:115], v[160:163], v[88:91]
    v_mfma_f32_16x16x32_bf16 v[92:95], v[112:115], v[164:167], v[92:95]
    ds_read_b64_tr_b16 v[100:101], v131 offset:53248
    ds_read_b64_tr_b16 v[102:103], v131 offset:53760
    v_mul_f32 v3, v3, v34
    v_mul_f32 v4, v4, v35
    v_exp_f32 v1, v1
    s_waitcnt lgkmcnt(2)
    v_mfma_f32_16x16x32_bf16 v[64:67], v[96:99], v[168:171], v[64:67]
    v_mfma_f32_16x16x32_bf16 v[68:71], v[96:99], v[172:175], v[68:71]
    ds_read_b64_tr_b16 v[108:109], v130 offset:61440
    ds_read_b64_tr_b16 v[110:111], v130 offset:61952
    v_exp_f32 v2, v2
    v_exp_f32 v3, v3
    v_exp_f32 v4, v4
    s_waitcnt lgkmcnt(2)
    v_mfma_f32_16x16x32_bf16 v[80:83], v[100:103], v[168:171], v[80:83]
    v_mfma_f32_16x16x32_bf16 v[84:87], v[100:103], v[172:175], v[84:87]
    ds_read_b64_tr_b16 v[112:113], v131 offset:61440
    ds_read_b64_tr_b16 v[114:115], v131 offset:61952
    v_mul_f32 v40, v32, v40
    v_mul_f32 v41, v33, v41
    v_mul_f32 v42, v34, v42
    v_mul_f32 v43, v35, v43
    s_waitcnt lgkmcnt(0)
    v_mfma_f32_16x16x32_bf16 v[72:75], v[108:111], v[168:171], v[72:75]
    v_mfma_f32_16x16x32_bf16 v[76:79], v[108:111], v[172:175], v[76:79]
    s_barrier
    ds_read_b64_tr_b16 v[96:97], v132 offset:0
    ds_read_b64_tr_b16 v[98:99], v132 offset:512
    v_add_f32 v1, 1.0, v1
    v_add_f32 v2, 1.0, v2
    v_add_f32 v3, 1.0, v3
    v_mfma_f32_16x16x32_bf16 v[88:91], v[112:115], v[168:171], v[88:91]
    v_mfma_f32_16x16x32_bf16 v[92:95], v[112:115], v[172:175], v[92:95]
    ds_read_b64_tr_b16 v[100:101], v133 offset:0
    ds_read_b64_tr_b16 v[102:103], v133 offset:512
    v_add_f32 v4, 1.0, v4
    v_rcp_f32 v1, v1
    v_rcp_f32 v2, v2
    s_lshl_b32 s3, s26, 9
    s_add_u32 s3, s3, 155648
    v_lshl_add_u32 v8, v0, 3, s3
    v_mov_b64 v[6:7], 0
    ds_write_b64 v8, v[6:7]
    ds_write_b64 v8, v[6:7] offset:4096
    s_waitcnt lgkmcnt(4)
    v_mfma_f32_16x16x32_bf16 v[64:67], v[96:99], v[176:179], v[64:67]
    v_mfma_f32_16x16x32_bf16 v[68:71], v[96:99], v[180:183], v[68:71]
    ds_read_b64_tr_b16 v[108:109], v132 offset:8192
    ds_read_b64_tr_b16 v[110:111], v132 offset:8704
    v_rcp_f32 v3, v3
    v_rcp_f32 v4, v4
    v_mul_f32 v40, v40, v1
    s_waitcnt lgkmcnt(4)
    v_mfma_f32_16x16x32_bf16 v[80:83], v[100:103], v[176:179], v[80:83]
    v_mfma_f32_16x16x32_bf16 v[84:87], v[100:103], v[180:183], v[84:87]
    ds_read_b64_tr_b16 v[112:113], v133 offset:8192
    ds_read_b64_tr_b16 v[114:115], v133 offset:8704
    v_mul_f32 v41, v41, v2
    v_mul_f32 v42, v42, v3
    v_mul_f32 v43, v43, v4
    v_cvt_pk_bf16_f32 v136, v40, v41
    s_waitcnt lgkmcnt(2)
    v_mfma_f32_16x16x32_bf16 v[72:75], v[108:111], v[176:179], v[72:75]
    v_mfma_f32_16x16x32_bf16 v[76:79], v[108:111], v[180:183], v[76:79]
    s_waitcnt vmcnt(0)
    s_barrier
    ds_read_b64_tr_b16 v[96:97], v132 offset:4096
    ds_read_b64_tr_b16 v[98:99], v132 offset:4608
    v_cvt_pk_bf16_f32 v137, v42, v43
    v_mul_f32 v1, v36, v36
    v_mul_f32 v2, v37, v37
    s_waitcnt lgkmcnt(2)
    v_mfma_f32_16x16x32_bf16 v[88:91], v[112:115], v[176:179], v[88:91]
    v_mfma_f32_16x16x32_bf16 v[92:95], v[112:115], v[180:183], v[92:95]
    ds_read_b64_tr_b16 v[100:101], v133 offset:4096
    ds_read_b64_tr_b16 v[102:103], v133 offset:4608
    v_mul_f32 v3, v38, v38
    v_mul_f32 v4, v39, v39
    v_fmamk_f32 v1, v1, 0xbdd2d3e8, v15
    s_waitcnt lgkmcnt(2)
    v_mfma_f32_16x16x32_bf16 v[64:67], v[96:99], v[184:187], v[64:67]
    v_mfma_f32_16x16x32_bf16 v[68:71], v[96:99], v[188:191], v[68:71]
    ds_read_b64_tr_b16 v[108:109], v132 offset:12288
    ds_read_b64_tr_b16 v[110:111], v132 offset:12800
    v_fmamk_f32 v2, v2, 0xbdd2d3e8, v15
    v_fmamk_f32 v3, v3, 0xbdd2d3e8, v15
    v_fmamk_f32 v4, v4, 0xbdd2d3e8, v15
    s_waitcnt lgkmcnt(2)
    v_mfma_f32_16x16x32_bf16 v[80:83], v[100:103], v[184:187], v[80:83]
    v_mfma_f32_16x16x32_bf16 v[84:87], v[100:103], v[188:191], v[84:87]
    ds_read_b64_tr_b16 v[112:113], v133 offset:12288
    ds_read_b64_tr_b16 v[114:115], v133 offset:12800
    v_mul_f32 v1, v1, v36
    v_mul_f32 v2, v2, v37
    v_mul_f32 v3, v3, v38
    v_mul_f32 v4, v4, v39
    s_waitcnt lgkmcnt(2)
    v_mfma_f32_16x16x32_bf16 v[72:75], v[108:111], v[184:187], v[72:75]
    v_mfma_f32_16x16x32_bf16 v[76:79], v[108:111], v[188:191], v[76:79]
    ds_read_b64_tr_b16 v[96:97], v130 offset:0
    ds_read_b64_tr_b16 v[98:99], v130 offset:512
    v_exp_f32 v1, v1
    v_exp_f32 v2, v2
    v_exp_f32 v3, v3
    s_waitcnt lgkmcnt(2)
    v_mfma_f32_16x16x32_bf16 v[88:91], v[112:115], v[184:187], v[88:91]
    v_mfma_f32_16x16x32_bf16 v[92:95], v[112:115], v[188:191], v[92:95]
    ds_read_b64_tr_b16 v[100:101], v131 offset:0
    ds_read_b64_tr_b16 v[102:103], v131 offset:512
    v_exp_f32 v4, v4
    v_mul_f32 v44, v36, v44
    v_mul_f32 v45, v37, v45
    s_waitcnt lgkmcnt(2)
    v_mfma_f32_16x16x32_bf16 v[64:67], v[96:99], v[192:195], v[64:67]
    v_mfma_f32_16x16x32_bf16 v[68:71], v[96:99], v[196:199], v[68:71]
    ds_read_b64_tr_b16 v[108:109], v130 offset:8192
    ds_read_b64_tr_b16 v[110:111], v130 offset:8704
    v_mul_f32 v46, v38, v46
    v_mul_f32 v47, v39, v47
    v_add_f32 v1, 1.0, v1
    s_waitcnt lgkmcnt(2)
    v_mfma_f32_16x16x32_bf16 v[80:83], v[100:103], v[192:195], v[80:83]
    v_mfma_f32_16x16x32_bf16 v[84:87], v[100:103], v[196:199], v[84:87]
    ds_read_b64_tr_b16 v[112:113], v131 offset:8192
    ds_read_b64_tr_b16 v[114:115], v131 offset:8704
    v_add_f32 v2, 1.0, v2
    v_add_f32 v3, 1.0, v3
    v_add_f32 v4, 1.0, v4
    v_rcp_f32 v1, v1
    s_waitcnt lgkmcnt(2)
    v_mfma_f32_16x16x32_bf16 v[72:75], v[108:111], v[192:195], v[72:75]
    v_mfma_f32_16x16x32_bf16 v[76:79], v[108:111], v[196:199], v[76:79]
    ds_read_b64_tr_b16 v[96:97], v130 offset:4096
    ds_read_b64_tr_b16 v[98:99], v130 offset:4608
    v_rcp_f32 v2, v2
    v_rcp_f32 v3, v3
    v_rcp_f32 v4, v4
    s_waitcnt lgkmcnt(2)
    v_mfma_f32_16x16x32_bf16 v[88:91], v[112:115], v[192:195], v[88:91]
    v_mfma_f32_16x16x32_bf16 v[92:95], v[112:115], v[196:199], v[92:95]
    ds_read_b64_tr_b16 v[100:101], v131 offset:4096
    ds_read_b64_tr_b16 v[102:103], v131 offset:4608
    v_mul_f32 v44, v44, v1
    v_mul_f32 v45, v45, v2
    v_mul_f32 v46, v46, v3
    s_waitcnt lgkmcnt(2)
    v_mfma_f32_16x16x32_bf16 v[64:67], v[96:99], v[200:203], v[64:67]
    v_mfma_f32_16x16x32_bf16 v[68:71], v[96:99], v[204:207], v[68:71]
    ds_read_b64_tr_b16 v[108:109], v130 offset:12288
    ds_read_b64_tr_b16 v[110:111], v130 offset:12800
    v_mul_f32 v47, v47, v4
    v_cvt_pk_bf16_f32 v138, v44, v45
    v_cvt_pk_bf16_f32 v139, v46, v47
    s_add_u32 s59, s63, 0
    s_waitcnt lgkmcnt(2)
    v_mfma_f32_16x16x32_bf16 v[80:83], v[100:103], v[200:203], v[80:83]
    v_mfma_f32_16x16x32_bf16 v[84:87], v[100:103], v[204:207], v[84:87]
    ds_read_b64_tr_b16 v[112:113], v131 offset:12288
    ds_read_b64_tr_b16 v[114:115], v131 offset:12800
    v_permlane16_swap_b32 v136, v138
    v_permlane16_swap_b32 v137, v139
    buffer_store_dwordx4 v[136:139], v134, s[28:31], s59 offen sc1
    s_waitcnt lgkmcnt(0)
    v_mfma_f32_16x16x32_bf16 v[72:75], v[108:111], v[200:203], v[72:75]
    v_mfma_f32_16x16x32_bf16 v[76:79], v[108:111], v[204:207], v[76:79]
    s_barrier
    ds_read_b64_tr_b16 v[96:97], v132 offset:16384
    ds_read_b64_tr_b16 v[98:99], v132 offset:16896
    v_mul_f32 v1, v48, v48
    v_mul_f32 v2, v49, v49
    v_mul_f32 v3, v50, v50
    v_mfma_f32_16x16x32_bf16 v[88:91], v[112:115], v[200:203], v[88:91]
    v_mfma_f32_16x16x32_bf16 v[92:95], v[112:115], v[204:207], v[92:95]
    ds_read_b64_tr_b16 v[100:101], v133 offset:16384
    ds_read_b64_tr_b16 v[102:103], v133 offset:16896
    v_mul_f32 v4, v51, v51
    v_fmamk_f32 v1, v1, 0xbdd2d3e8, v15
    v_fmamk_f32 v2, v2, 0xbdd2d3e8, v15
    s_add_u32 m0, s80, 0
    s_add_u32 s0, s82, 0
    buffer_load_dwordx4 v9, s[72:75], s0 offen lds
    buffer_load_dwordx4 v10, s[72:75], s0 offen offset:1024 lds
    s_waitcnt lgkmcnt(2)
    v_mfma_f32_16x16x32_bf16 v[64:67], v[96:99], v[208:211], v[64:67]
    v_mfma_f32_16x16x32_bf16 v[68:71], v[96:99], v[212:215], v[68:71]
    ds_read_b64_tr_b16 v[108:109], v132 offset:24576
    ds_read_b64_tr_b16 v[110:111], v132 offset:25088
    v_fmamk_f32 v3, v3, 0xbdd2d3e8, v15
    v_fmamk_f32 v4, v4, 0xbdd2d3e8, v15
    v_mul_f32 v1, v1, v48
    v_mul_f32 v2, v2, v49
    s_waitcnt lgkmcnt(2)
    v_mfma_f32_16x16x32_bf16 v[80:83], v[100:103], v[208:211], v[80:83]
    v_mfma_f32_16x16x32_bf16 v[84:87], v[100:103], v[212:215], v[84:87]
    ds_read_b64_tr_b16 v[112:113], v133 offset:24576
    ds_read_b64_tr_b16 v[114:115], v133 offset:25088
    v_mul_f32 v3, v3, v50
    v_mul_f32 v4, v4, v51
    v_exp_f32 v1, v1
    s_waitcnt lgkmcnt(2)
    v_mfma_f32_16x16x32_bf16 v[72:75], v[108:111], v[208:211], v[72:75]
    v_mfma_f32_16x16x32_bf16 v[76:79], v[108:111], v[212:215], v[76:79]
    ds_read_b64_tr_b16 v[96:97], v132 offset:20480
    ds_read_b64_tr_b16 v[98:99], v132 offset:20992
    v_exp_f32 v2, v2
    v_exp_f32 v3, v3
    v_exp_f32 v4, v4
    s_waitcnt lgkmcnt(2)
    v_mfma_f32_16x16x32_bf16 v[88:91], v[112:115], v[208:211], v[88:91]
    v_mfma_f32_16x16x32_bf16 v[92:95], v[112:115], v[212:215], v[92:95]
    ds_read_b64_tr_b16 v[100:101], v133 offset:20480
    ds_read_b64_tr_b16 v[102:103], v133 offset:20992
    v_mul_f32 v56, v48, v56
    v_mul_f32 v57, v49, v57
    v_mul_f32 v58, v50, v58
    s_add_u32 m0, s80, 2048
    s_add_u32 s0, s82, 14336
    buffer_load_dwordx4 v9, s[72:75], s0 offen lds
    buffer_load_dwordx4 v10, s[72:75], s0 offen offset:1024 lds
    s_waitcnt lgkmcnt(2)
    v_mfma_f32_16x16x32_bf16 v[64:67], v[96:99], v[216:219], v[64:67]
    v_mfma_f32_16x16x32_bf16 v[68:71], v[96:99], v[220:223], v[68:71]
    ds_read_b64_tr_b16 v[108:109], v132 offset:28672
    ds_read_b64_tr_b16 v[110:111], v132 offset:29184
    v_mul_f32 v59, v51, v59
    v_add_f32 v1, 1.0, v1
    v_add_f32 v2, 1.0, v2
    v_add_f32 v3, 1.0, v3
    s_waitcnt lgkmcnt(2)
    v_mfma_f32_16x16x32_bf16 v[80:83], v[100:103], v[216:219], v[80:83]
    v_mfma_f32_16x16x32_bf16 v[84:87], v[100:103], v[220:223], v[84:87]
    ds_read_b64_tr_b16 v[112:113], v133 offset:28672
    ds_read_b64_tr_b16 v[114:115], v133 offset:29184
    v_add_f32 v4, 1.0, v4
    v_rcp_f32 v1, v1
    v_rcp_f32 v2, v2
    s_waitcnt lgkmcnt(2)
    v_mfma_f32_16x16x32_bf16 v[72:75], v[108:111], v[216:219], v[72:75]
    v_mfma_f32_16x16x32_bf16 v[76:79], v[108:111], v[220:223], v[76:79]
    ds_read_b64_tr_b16 v[96:97], v130 offset:16384
    ds_read_b64_tr_b16 v[98:99], v130 offset:16896
    v_rcp_f32 v3, v3
    v_rcp_f32 v4, v4
    v_mul_f32 v56, v56, v1
    s_waitcnt lgkmcnt(2)
    v_mfma_f32_16x16x32_bf16 v[88:91], v[112:115], v[216:219], v[88:91]
    v_mfma_f32_16x16x32_bf16 v[92:95], v[112:115], v[220:223], v[92:95]
    ds_read_b64_tr_b16 v[100:101], v131 offset:16384
    ds_read_b64_tr_b16 v[102:103], v131 offset:16896
    v_mul_f32 v57, v57, v2
    v_mul_f32 v58, v58, v3
    v_mul_f32 v59, v59, v4
    s_add_u32 m0, s80, 4096
    s_add_u32 s0, s82, 28672
    buffer_load_dwordx4 v9, s[72:75], s0 offen lds
    buffer_load_dwordx4 v10, s[72:75], s0 offen offset:1024 lds
    s_waitcnt lgkmcnt(2)
    v_mfma_f32_16x16x32_bf16 v[64:67], v[96:99], v[224:227], v[64:67]
    v_mfma_f32_16x16x32_bf16 v[68:71], v[96:99], v[228:231], v[68:71]
    ds_read_b64_tr_b16 v[108:109], v130 offset:24576
    ds_read_b64_tr_b16 v[110:111], v130 offset:25088
    v_cvt_pk_bf16_f32 v140, v56, v57
    v_cvt_pk_bf16_f32 v141, v58, v59
    v_mul_f32 v1, v52, v52
    v_mul_f32 v2, v53, v53
    s_waitcnt lgkmcnt(2)
    v_mfma_f32_16x16x32_bf16 v[80:83], v[100:103], v[224:227], v[80:83]
    v_mfma_f32_16x16x32_bf16 v[84:87], v[100:103], v[228:231], v[84:87]
    ds_read_b64_tr_b16 v[112:113], v131 offset:24576
    ds_read_b64_tr_b16 v[114:115], v131 offset:25088
    v_mul_f32 v3, v54, v54
    v_mul_f32 v4, v55, v55
    v_fmamk_f32 v1, v1, 0xbdd2d3e8, v15
    s_waitcnt lgkmcnt(2)
    v_mfma_f32_16x16x32_bf16 v[72:75], v[108:111], v[224:227], v[72:75]
    v_mfma_f32_16x16x32_bf16 v[76:79], v[108:111], v[228:231], v[76:79]
    ds_read_b64_tr_b16 v[96:97], v130 offset:20480
    ds_read_b64_tr_b16 v[98:99], v130 offset:20992
    v_fmamk_f32 v2, v2, 0xbdd2d3e8, v15
    v_fmamk_f32 v3, v3, 0xbdd2d3e8, v15
    v_fmamk_f32 v4, v4, 0xbdd2d3e8, v15
    s_waitcnt lgkmcnt(2)
    v_mfma_f32_16x16x32_bf16 v[88:91], v[112:115], v[224:227], v[88:91]
    v_mfma_f32_16x16x32_bf16 v[92:95], v[112:115], v[228:231], v[92:95]
    ds_read_b64_tr_b16 v[100:101], v131 offset:20480
    ds_read_b64_tr_b16 v[102:103], v131 offset:20992
    v_mul_f32 v1, v1, v52
    v_mul_f32 v2, v2, v53
    v_mul_f32 v3, v3, v54
    s_add_u32 m0, s80, 6144
    s_add_u32 s0, s82, 43008
    buffer_load_dwordx4 v9, s[72:75], s0 offen lds
    buffer_load_dwordx4 v10, s[72:75], s0 offen offset:1024 lds
    s_waitcnt lgkmcnt(2)
    v_mfma_f32_16x16x32_bf16 v[64:67], v[96:99], v[232:235], v[64:67]
    v_mfma_f32_16x16x32_bf16 v[68:71], v[96:99], v[236:239], v[68:71]
    ds_read_b64_tr_b16 v[108:109], v130 offset:28672
    ds_read_b64_tr_b16 v[110:111], v130 offset:29184
    v_mul_f32 v4, v4, v55
    v_exp_f32 v1, v1
    v_exp_f32 v2, v2
    v_exp_f32 v3, v3
    s_waitcnt lgkmcnt(2)
    v_mfma_f32_16x16x32_bf16 v[80:83], v[100:103], v[232:235], v[80:83]
    v_mfma_f32_16x16x32_bf16 v[84:87], v[100:103], v[236:239], v[84:87]
    ds_read_b64_tr_b16 v[112:113], v131 offset:28672
    ds_read_b64_tr_b16 v[114:115], v131 offset:29184
    v_exp_f32 v4, v4
    v_mul_f32 v60, v52, v60
    v_mul_f32 v61, v53, v61
    s_waitcnt lgkmcnt(2)
    v_mfma_f32_16x16x32_bf16 v[72:75], v[108:111], v[232:235], v[72:75]
    v_mfma_f32_16x16x32_bf16 v[76:79], v[108:111], v[236:239], v[76:79]
    ds_read_b64_tr_b16 v[96:97], v132 offset:32768
    ds_read_b64_tr_b16 v[98:99], v132 offset:33280
    v_mul_f32 v62, v54, v62
    v_mul_f32 v63, v55, v63
    v_add_f32 v1, 1.0, v1
    s_waitcnt lgkmcnt(2)
    v_mfma_f32_16x16x32_bf16 v[88:91], v[112:115], v[232:235], v[88:91]
    v_mfma_f32_16x16x32_bf16 v[92:95], v[112:115], v[236:239], v[92:95]
    ds_read_b64_tr_b16 v[100:101], v133 offset:32768
    ds_read_b64_tr_b16 v[102:103], v133 offset:33280
    v_add_f32 v2, 1.0, v2
    v_add_f32 v3, 1.0, v3
    v_add_f32 v4, 1.0, v4
    s_add_u32 m0, s80, 8192
    s_add_u32 s0, s82, 57344
    buffer_load_dwordx4 v9, s[72:75], s0 offen lds
    buffer_load_dwordx4 v10, s[72:75], s0 offen offset:1024 lds
    s_waitcnt lgkmcnt(2)
    v_mfma_f32_16x16x32_bf16 v[64:67], v[96:99], v[240:243], v[64:67]
    v_mfma_f32_16x16x32_bf16 v[68:71], v[96:99], v[244:247], v[68:71]
    ds_read_b64_tr_b16 v[108:109], v132 offset:40960
    ds_read_b64_tr_b16 v[110:111], v132 offset:41472
    v_rcp_f32 v1, v1
    v_rcp_f32 v2, v2
    v_rcp_f32 v3, v3
    v_rcp_f32 v4, v4
    s_waitcnt lgkmcnt(2)
    v_mfma_f32_16x16x32_bf16 v[80:83], v[100:103], v[240:243], v[80:83]
    v_mfma_f32_16x16x32_bf16 v[84:87], v[100:103], v[244:247], v[84:87]
    ds_read_b64_tr_b16 v[112:113], v133 offset:40960
    ds_read_b64_tr_b16 v[114:115], v133 offset:41472
    v_mul_f32 v60, v60, v1
    v_mul_f32 v61, v61, v2
    v_mul_f32 v62, v62, v3
    s_waitcnt lgkmcnt(2)
    v_mfma_f32_16x16x32_bf16 v[72:75], v[108:111], v[240:243], v[72:75]
    v_mfma_f32_16x16x32_bf16 v[76:79], v[108:111], v[244:247], v[76:79]
    ds_read_b64_tr_b16 v[96:97], v132 offset:36864
    ds_read_b64_tr_b16 v[98:99], v132 offset:37376
    v_mul_f32 v63, v63, v4
    v_cvt_pk_bf16_f32 v142, v60, v61
    v_cvt_pk_bf16_f32 v143, v62, v63
    s_waitcnt lgkmcnt(2)
    v_mfma_f32_16x16x32_bf16 v[88:91], v[112:115], v[240:243], v[88:91]
    v_mfma_f32_16x16x32_bf16 v[92:95], v[112:115], v[244:247], v[92:95]
    ds_read_b64_tr_b16 v[100:101], v133 offset:36864
    ds_read_b64_tr_b16 v[102:103], v133 offset:37376
    s_add_u32 s59, s63, 1024
    v_permlane16_swap_b32 v140, v142
    v_permlane16_swap_b32 v141, v143
    buffer_store_dwordx4 v[140:143], v134, s[28:31], s59 offen sc1
    s_add_u32 m0, s80, 10240
    s_add_u32 s0, s82, 71680
    buffer_load_dwordx4 v9, s[72:75], s0 offen lds
    buffer_load_dwordx4 v10, s[72:75], s0 offen offset:1024 lds
    s_waitcnt lgkmcnt(2)
    v_mfma_f32_16x16x32_bf16 v[64:67], v[96:99], v[248:251], v[64:67]
    v_mfma_f32_16x16x32_bf16 v[68:71], v[96:99], v[252:255], v[68:71]
    ds_read_b64_tr_b16 v[108:109], v132 offset:45056
    ds_read_b64_tr_b16 v[110:111], v132 offset:45568
    s_waitcnt lgkmcnt(2)
    v_mfma_f32_16x16x32_bf16 v[80:83], v[100:103], v[248:251], v[80:83]
    v_mfma_f32_16x16x32_bf16 v[84:87], v[100:103], v[252:255], v[84:87]
    ds_read_b64_tr_b16 v[112:113], v133 offset:45056
    ds_read_b64_tr_b16 v[114:115], v133 offset:45568
    s_waitcnt lgkmcnt(0)
    v_mfma_f32_16x16x32_bf16 v[72:75], v[108:111], v[248:251], v[72:75]
    v_mfma_f32_16x16x32_bf16 v[76:79], v[108:111], v[252:255], v[76:79]
    s_barrier
    v_mfma_f32_16x16x32_bf16 v[88:91], v[112:115], v[248:251], v[88:91]
    v_mfma_f32_16x16x32_bf16 v[92:95], v[112:115], v[252:255], v[92:95]
    s_branch gated_mix__mha_block__glu_gated_geglu__prompt_kernel_g_e2
gated_mix__mha_block__glu_gated_geglu__prompt_kernel_q:
    s_bfe_u32 s52, s2, 0x30003
    s_bitcmp1_b32 s2, 0
    s_cselect_b32 s59, 8, 0
    s_or_b32 s52, s52, s59
    v_lshrrev_b32 v2, 3, v0
    v_and_b32 v3, 7, v0
    v_lshrrev_b32 v5, 4, v0
    s_lshl_b32 s59, s52, 3
    v_mul_u32_u24 v6, 896, v2
    s_add_u32 s59, s59, s26
    v_xor_b32 v7, v3, v5
    s_mul_i32 s54, s59, 14336
    v_lshl_add_u32 v120, v7, 4, v6
    s_lshl_b32 s58, s26, 11
    v_xor_b32 v121, 64, v120
    v_add_u32 v121, 6144, v121
    v_and_b32 v4, 1, v5
    s_lshl_b32 s59, s26, 3
    v_add_u32 v6, s59, v2
    s_lshl_b32 s57, s26, 10
    v_mul_u32_u24 v8, 2688, v6
    s_lshr_b32 s59, s59, 1
    s_and_b32 s59, s59, 4
    v_lshl_or_b32 v7, v4, 1, s59
    v_xor_b32 v7, v3, v7
    v_lshl_add_u32 v122, v7, 4, v8
    s_and_b32 s55, s53, 1
    s_lshl_b32 s55, s55, 9
    s_mov_b32 s56, 384
    s_mov_b32 s34, 1835008
    s_mov_b32 s35, 0x00020000
    s_mov_b32 s38, 1204224
    s_mov_b32 s39, 0x00020000
    s_add_u32 m0, s58, 0
    s_waitcnt lgkmcnt(0)
    buffer_load_dwordx4 v120, s[32:35], s54 offen lds
    buffer_load_dwordx4 v121, s[32:35], s54 offen offset:1024 lds
    s_add_u32 m0, s57, 65536
    s_nop 0
    buffer_load_dwordx4 v122, s[36:39], s55 offen lds
    s_add_u32 m0, s57, 98304
    s_add_u32 s64, s55, 128
    buffer_load_dwordx4 v122, s[36:39], s64 offen lds
    s_load_dwordx2 s[8:9], s[0:1], 16
    s_load_dwordx2 s[16:17], s[0:1], 48
    s_load_dwordx4 s[20:23], s[0:1], 64
    s_mov_b32 s50, 896
    s_mov_b32 s51, 0x00020000
    s_mov_b32 s30, 16777216
    s_mov_b32 s31, 0x00020000
    v_lshlrev_b32 v134, 4, v0
    s_and_b32 s60, s26, 3
    s_lshr_b32 s61, s26, 2
    s_cselect_b32 s71, 1, 0
    s_waitcnt lgkmcnt(0)
    s_cmp_lg_u32 s26, 7
    s_cbranch_scc1 gated_mix__mha_block__glu_gated_geglu__prompt_kernel_skip19
    v_lshlrev_b32 v10, 7, v0
    s_mov_b64 exec, 0x7f
    buffer_load_dword v11, v10, s[48:51], 0 offen
    s_mov_b64 exec, -1
gated_mix__mha_block__glu_gated_geglu__prompt_kernel_skip19:
    s_lshl_b32 s27, s52, 4
    s_add_u32 s27, s27, s53
    s_lshl_b32 s27, s27, 7
    s_add_u32 s27, s27, 15728640
    s_cmp_lg_u32 s26, 0
    s_cbranch_scc1 gated_mix__mha_block__glu_gated_geglu__prompt_kernel_skip20
    s_and_b32 s59, s2, 7
    s_lshl_b32 s59, s59, 1
    s_lshr_b32 s64, s2, 7
    s_add_u32 s59, s59, s64
    s_bfe_u32 s64, s2, 0x40003
    s_lshl_b32 s64, s64, 6
    s_add_u32 s59, s59, s64
    s_lshl_b32 s59, s59, 7
    s_add_u32 s59, s59, 15761408
    v_mov_b32 v10, 0
    v_lshlrev_b32 v9, 11, v0
    s_mov_b64 exec, 15
    buffer_store_dword v10, v9, s[28:31], s59 offen sc1
    s_mov_b64 exec, 1
    buffer_store_dword v10, off, s[28:31], s27 sc1
    s_mov_b64 exec, -1
gated_mix__mha_block__glu_gated_geglu__prompt_kernel_skip20:
    s_barrier
    s_add_u32 m0, s58, 16384
    s_add_u32 s64, s54, 128
    buffer_load_dwordx4 v120, s[32:35], s64 offen lds
    buffer_load_dwordx4 v121, s[32:35], s64 offen offset:1024 lds
    s_add_u32 m0, s57, 73728
    s_add_u32 s64, s55, 172032
    buffer_load_dwordx4 v122, s[36:39], s64 offen lds
    s_add_u32 m0, s57, 114688
    s_add_u32 s64, s55, 172160
    buffer_load_dwordx4 v122, s[36:39], s64 offen lds
    s_lshl_b32 s18, s2, 3
    s_add_u32 s18, s18, s26
    s_lshl_b32 s19, s18, 7
    v_lshl_add_u32 v13, v0, 18, s19
    s_mov_b32 s42, 1605632
    s_mov_b32 s43, 0x00020000
    s_mov_b32 s46, 1605632
    s_mov_b32 s47, 0x00020000
    s_mul_i32 s18, s18, 896
    v_lshl_add_u32 v14, v0, 7, s18
    s_mov_b32 s18, 688128
    s_mov_b32 s19, 516096
    s_mov_b64 exec, 15
    buffer_load_dword v11, v14, s[32:35], 0 offen offset:384
    buffer_load_dword v11, v13, s[36:39], s19 offen
    s_mov_b64 exec, 0x7f
    buffer_load_dword v11, v13, s[40:43], s18 offen
    buffer_load_dword v11, v13, s[44:47], s18 offen
    s_mov_b64 exec, -1
    s_lshl_b32 s10, s52, 7
    s_lshl_b32 s11, s53, 3
    s_add_u32 s10, s10, s11
    s_add_u32 s3, s10, s26
    s_mul_i32 s10, s3, 896
    v_mov_b64 v[136:137], 0
    v_mov_b64 v[138:139], 0
    v_mov_b64 v[140:141], 0
    v_mov_b64 v[142:143], 0
    s_mov_b32 exec_hi, 0x00ffffff
    buffer_load_dwordx4 v[136:139], v134, s[32:35], s10 offen
    buffer_load_dwordx4 v[140:143], v134, s[48:51], 0 offen
    s_mov_b64 exec, -1
    v_and_b32 v2, 15, v0
    v_lshrrev_b32 v3, 4, v0
    s_lshl_b32 s59, s60, 12
    v_lshl_add_u32 v4, v2, 7, s59
    v_lshrrev_b32 v5, 1, v2
    v_xor_b32 v5, v5, v3
    v_lshl_add_u32 v125, v5, 4, v4
    v_xor_b32 v126, 64, v125
    v_and_b32 v2, 3, v0
    v_bfe_u32 v4, v0, 2, 2
    v_lshl_add_u32 v5, v3, 3, v4
    v_bfe_u32 v6, v0, 3, 2
    s_lshl_b32 s59, s61, 1
    v_xor_b32 v6, s59, v6
    v_lshlrev_b32 v6, 5, v6
    v_lshl_add_u32 v5, v5, 7, v6
    v_lshl_add_u32 v6, v2, 3, v5
    v_add_u32 v129, 65536, v6
    v_xor_b32 v127, 32, v129
    v_add_u32 v130, 98304, v6
    v_xor_b32 v131, 32, v130
    v_mov_b32 v132, v6
    v_xor_b32 v133, 32, v6
    v_mov_b32 v15, 0xc0135761
    s_waitcnt vmcnt(10)
    s_barrier
    ds_read_b128 v[144:147], v125 offset:0
    ds_read_b128 v[148:151], v125 offset:2048
    ds_read_b64_tr_b16 v[108:109], v129 offset:0
    ds_read_b64_tr_b16 v[110:111], v129 offset:512
    ds_read_b64_tr_b16 v[112:113], v130 offset:0
    ds_read_b64_tr_b16 v[114:115], v130 offset:512
    ds_read_b64_tr_b16 v[64:65], v127 offset:0
    ds_read_b64_tr_b16 v[66:67], v127 offset:512
    ds_read_b64_tr_b16 v[68:69], v131 offset:0
    ds_read_b64_tr_b16 v[70:71], v131 offset:512
    s_cmp_eq_u32 s71, 0
    s_cbranch_scc0 gated_mix__mha_block__glu_gated_geglu__prompt_kernel_Q1_22
    s_waitcnt lgkmcnt(6)
    v_mfma_f32_16x16x32_bf16 v[16:19], v[108:111], v[144:147], 0
    v_mfma_f32_16x16x32_bf16 v[20:23], v[108:111], v[148:151], 0
    ds_read_b128 v[152:155], v126 offset:0
    ds_read_b128 v[156:159], v126 offset:2048
    ds_read_b64_tr_b16 v[96:97], v129 offset:4096
    ds_read_b64_tr_b16 v[98:99], v129 offset:4608
    s_waitcnt lgkmcnt(8)
    v_mfma_f32_16x16x32_bf16 v[32:35], v[112:115], v[144:147], 0
    v_mfma_f32_16x16x32_bf16 v[36:39], v[112:115], v[148:151], 0
    ds_read_b64_tr_b16 v[100:101], v130 offset:4096
    ds_read_b64_tr_b16 v[102:103], v130 offset:4608
    s_add_u32 m0, s58, 32768
    s_add_u32 s64, s54, 256
    buffer_load_dwordx4 v120, s[32:35], s64 offen lds
    buffer_load_dwordx4 v121, s[32:35], s64 offen offset:1024 lds
    s_add_u32 m0, s57, 81920
    s_add_u32 s64, s55, 344064
    buffer_load_dwordx4 v122, s[36:39], s64 offen lds
    s_waitcnt lgkmcnt(8)
    v_mfma_f32_16x16x32_bf16 v[24:27], v[64:67], v[144:147], 0
    v_mfma_f32_16x16x32_bf16 v[28:31], v[64:67], v[148:151], 0
    ds_read_b64_tr_b16 v[108:109], v127 offset:4096
    ds_read_b64_tr_b16 v[110:111], v127 offset:4608
    s_waitcnt lgkmcnt(8)
    v_mfma_f32_16x16x32_bf16 v[40:43], v[68:71], v[144:147], 0
    v_mfma_f32_16x16x32_bf16 v[44:47], v[68:71], v[148:151], 0
    ds_read_b64_tr_b16 v[112:113], v131 offset:4096
    ds_read_b64_tr_b16 v[114:115], v131 offset:4608
    s_add_u32 m0, s57, 131072
    s_add_u32 s64, s55, 344192
    buffer_load_dwordx4 v122, s[36:39], s64 offen lds
    s_waitcnt lgkmcnt(0)
    v_mfma_f32_16x16x32_bf16 v[16:19], v[96:99], v[152:155], v[16:19]
    v_mfma_f32_16x16x32_bf16 v[20:23], v[96:99], v[156:159], v[20:23]
    s_waitcnt vmcnt(10)
    s_barrier
    ds_read_b128 v[160:163], v125 offset:16384
    ds_read_b128 v[164:167], v125 offset:18432
    ds_read_b64_tr_b16 v[64:65], v129 offset:8192
    ds_read_b64_tr_b16 v[66:67], v129 offset:8704
    v_mfma_f32_16x16x32_bf16 v[32:35], v[100:103], v[152:155], v[32:35]
    v_mfma_f32_16x16x32_bf16 v[36:39], v[100:103], v[156:159], v[36:39]
    ds_read_b64_tr_b16 v[68:69], v130 offset:16384
    ds_read_b64_tr_b16 v[70:71], v130 offset:16896
    s_add_u32 m0, s58, 49152
    s_add_u32 s64, s54, 384
    buffer_load_dwordx4 v120, s[32:35], s64 offen lds
    buffer_load_dwordx4 v121, s[32:35], s64 offen offset:1024 lds
    v_mfma_f32_16x16x32_bf16 v[24:27], v[108:111], v[152:155], v[24:27]
    v_mfma_f32_16x16x32_bf16 v[28:31], v[108:111], v[156:159], v[28:31]
    ds_read_b64_tr_b16 v[96:97], v127 offset:8192
    ds_read_b64_tr_b16 v[98:99], v127 offset:8704
    v_mfma_f32_16x16x32_bf16 v[40:43], v[112:115], v[152:155], v[40:43]
    v_mfma_f32_16x16x32_bf16 v[44:47], v[112:115], v[156:159], v[44:47]
    ds_read_b64_tr_b16 v[100:101], v131 offset:16384
    ds_read_b64_tr_b16 v[102:103], v131 offset:16896
    s_add_u32 m0, s57, 90112
    s_add_u32 s64, s55, 516096
    buffer_load_dwordx4 v122, s[36:39], s64 offen lds
    s_waitcnt lgkmcnt(4)
    v_mfma_f32_16x16x32_bf16 v[16:19], v[64:67], v[160:163], v[16:19]
    v_mfma_f32_16x16x32_bf16 v[20:23], v[64:67], v[164:167], v[20:23]
    ds_read_b128 v[168:171], v126 offset:16384
    ds_read_b128 v[172:175], v126 offset:18432
    ds_read_b64_tr_b16 v[108:109], v129 offset:12288
    ds_read_b64_tr_b16 v[110:111], v129 offset:12800
    v_mfma_f32_16x16x32_bf16 v[32:35], v[68:71], v[160:163], v[32:35]
    v_mfma_f32_16x16x32_bf16 v[36:39], v[68:71], v[164:167], v[36:39]
    ds_read_b64_tr_b16 v[112:113], v130 offset:20480
    ds_read_b64_tr_b16 v[114:115], v130 offset:20992
    s_add_u32 m0, s57, 147456
    s_add_u32 s64, s55, 516224
    buffer_load_dwordx4 v122, s[36:39], s64 offen lds
    s_waitcnt lgkmcnt(6)
    v_mfma_f32_16x16x32_bf16 v[24:27], v[96:99], v[160:163], v[24:27]
    v_mfma_f32_16x16x32_bf16 v[28:31], v[96:99], v[164:167], v[28:31]
    ds_read_b64_tr_b16 v[64:65], v127 offset:12288
    ds_read_b64_tr_b16 v[66:67], v127 offset:12800
    v_mfma_f32_16x16x32_bf16 v[40:43], v[100:103], v[160:163], v[40:43]
    v_mfma_f32_16x16x32_bf16 v[44:47], v[100:103], v[164:167], v[44:47]
    ds_read_b64_tr_b16 v[68:69], v131 offset:20480
    ds_read_b64_tr_b16 v[70:71], v131 offset:20992
    s_waitcnt lgkmcnt(0)
    v_mfma_f32_16x16x32_bf16 v[16:19], v[108:111], v[168:171], v[16:19]
    v_mfma_f32_16x16x32_bf16 v[20:23], v[108:111], v[172:175], v[20:23]
    s_waitcnt vmcnt(4)
    s_barrier
    ds_read_b128 v[176:179], v125 offset:32768
    ds_read_b128 v[180:183], v125 offset:34816
    ds_read_b64_tr_b16 v[96:97], v129 offset:16384
    ds_read_b64_tr_b16 v[98:99], v129 offset:16896
    v_mfma_f32_16x16x32_bf16 v[32:35], v[112:115], v[168:171], v[32:35]
    v_mfma_f32_16x16x32_bf16 v[36:39], v[112:115], v[172:175], v[36:39]
    ds_read_b64_tr_b16 v[100:101], v130 offset:32768
    ds_read_b64_tr_b16 v[102:103], v130 offset:33280
    s_add_u32 m0, s58, 0
    s_add_u32 s64, s54, 512
    buffer_load_dwordx4 v120, s[32:35], s64 offen lds
    buffer_load_dwordx4 v121, s[32:35], s64 offen offset:1024 lds
    v_mfma_f32_16x16x32_bf16 v[24:27], v[64:67], v[168:171], v[24:27]
    v_mfma_f32_16x16x32_bf16 v[28:31], v[64:67], v[172:175], v[28:31]
    ds_read_b64_tr_b16 v[108:109], v127 offset:16384
    ds_read_b64_tr_b16 v[110:111], v127 offset:16896
    v_mfma_f32_16x16x32_bf16 v[40:43], v[68:71], v[168:171], v[40:43]
    v_mfma_f32_16x16x32_bf16 v[44:47], v[68:71], v[172:175], v[44:47]
    ds_read_b64_tr_b16 v[112:113], v131 offset:32768
    ds_read_b64_tr_b16 v[114:115], v131 offset:33280
    s_add_u32 m0, s57, 65536
    s_add_u32 s64, s55, 688128
    buffer_load_dwordx4 v122, s[36:39], s64 offen lds
    s_waitcnt lgkmcnt(4)
    v_mfma_f32_16x16x32_bf16 v[16:19], v[96:99], v[176:179], v[16:19]
    v_mfma_f32_16x16x32_bf16 v[20:23], v[96:99], v[180:183], v[20:23]
    ds_read_b128 v[184:187], v126 offset:32768
    ds_read_b128 v[188:191], v126 offset:34816
    ds_read_b64_tr_b16 v[64:65], v129 offset:20480
    ds_read_b64_tr_b16 v[66:67], v129 offset:20992
    v_mfma_f32_16x16x32_bf16 v[32:35], v[100:103], v[176:179], v[32:35]
    v_mfma_f32_16x16x32_bf16 v[36:39], v[100:103], v[180:183], v[36:39]
    ds_read_b64_tr_b16 v[68:69], v130 offset:36864
    ds_read_b64_tr_b16 v[70:71], v130 offset:37376
    s_add_u32 m0, s57, 98304
    s_add_u32 s64, s55, 688256
    buffer_load_dwordx4 v122, s[36:39], s64 offen lds
    s_waitcnt lgkmcnt(6)
    v_mfma_f32_16x16x32_bf16 v[24:27], v[108:111], v[176:179], v[24:27]
    v_mfma_f32_16x16x32_bf16 v[28:31], v[108:111], v[180:183], v[28:31]
    ds_read_b64_tr_b16 v[96:97], v127 offset:20480
    ds_read_b64_tr_b16 v[98:99], v127 offset:20992
    v_mov_b32 v1, 0
    v_mfma_f32_16x16x32_bf16 v[40:43], v[112:115], v[176:179], v[40:43]
    v_mfma_f32_16x16x32_bf16 v[44:47], v[112:115], v[180:183], v[44:47]
    ds_read_b64_tr_b16 v[100:101], v131 offset:36864
    ds_read_b64_tr_b16 v[102:103], v131 offset:37376
    v_dot2_f32_bf16 v1, v136, v140, v1
    v_dot2_f32_bf16 v1, v137, v141, v1
    s_waitcnt lgkmcnt(0)
    v_mfma_f32_16x16x32_bf16 v[16:19], v[64:67], v[184:187], v[16:19]
    v_mfma_f32_16x16x32_bf16 v[20:23], v[64:67], v[188:191], v[20:23]
    s_waitcnt vmcnt(4)
    s_barrier
    ds_read_b128 v[192:195], v125 offset:49152
    ds_read_b128 v[196:199], v125 offset:51200
    ds_read_b64_tr_b16 v[108:109], v129 offset:24576
    ds_read_b64_tr_b16 v[110:111], v129 offset:25088
    v_dot2_f32_bf16 v1, v138, v142, v1
    v_mfma_f32_16x16x32_bf16 v[32:35], v[68:71], v[184:187], v[32:35]
    v_mfma_f32_16x16x32_bf16 v[36:39], v[68:71], v[188:191], v[36:39]
    ds_read_b64_tr_b16 v[112:113], v130 offset:49152
    ds_read_b64_tr_b16 v[114:115], v130 offset:49664
    s_add_u32 m0, s58, 16384
    s_add_u32 s64, s54, 640
    buffer_load_dwordx4 v120, s[32:35], s64 offen lds
    buffer_load_dwordx4 v121, s[32:35], s64 offen offset:1024 lds
    v_dot2_f32_bf16 v1, v139, v143, v1
    s_nop 2
    v_add_f32_dpp v1, v1, v1 row_shr:1 row_mask:0xf bank_mask:0xf
    s_nop 1
    v_add_f32_dpp v1, v1, v1 row_shr:2 row_mask:0xf bank_mask:0xf
    v_mfma_f32_16x16x32_bf16 v[24:27], v[96:99], v[184:187], v[24:27]
    v_mfma_f32_16x16x32_bf16 v[28:31], v[96:99], v[188:191], v[28:31]
    ds_read_b64_tr_b16 v[64:65], v127 offset:24576
    ds_read_b64_tr_b16 v[66:67], v127 offset:25088
    v_add_f32_dpp v1, v1, v1 row_shr:4 row_mask:0xf bank_mask:0xf
    v_mfma_f32_16x16x32_bf16 v[40:43], v[100:103], v[184:187], v[40:43]
    v_mfma_f32_16x16x32_bf16 v[44:47], v[100:103], v[188:191], v[44:47]
    ds_read_b64_tr_b16 v[68:69], v131 offset:49152
    ds_read_b64_tr_b16 v[70:71], v131 offset:49664
    s_add_u32 m0, s57, 73728
    s_add_u32 s64, s55, 860160
    buffer_load_dwordx4 v122, s[36:39], s64 offen lds
    v_add_f32_dpp v1, v1, v1 row_shr:8 row_mask:0xf bank_mask:0xf
    s_nop 1
    v_add_f32_dpp v1, v1, v1 row_bcast:15 row_mask:0xa bank_mask:0xf
    s_waitcnt lgkmcnt(4)
    v_mfma_f32_16x16x32_bf16 v[16:19], v[108:111], v[192:195], v[16:19]
    v_mfma_f32_16x16x32_bf16 v[20:23], v[108:111], v[196:199], v[20:23]
    ds_read_b128 v[200:203], v126 offset:49152
    ds_read_b128 v[204:207], v126 offset:51200
    ds_read_b64_tr_b16 v[96:97], v129 offset:28672
    ds_read_b64_tr_b16 v[98:99], v129 offset:29184
    v_add_f32_dpp v1, v1, v1 row_bcast:31 row_mask:0xc bank_mask:0xf
    v_mul_f32 v1, 0xbfb8aa3b, v1
    v_mfma_f32_16x16x32_bf16 v[32:35], v[112:115], v[192:195], v[32:35]
    v_mfma_f32_16x16x32_bf16 v[36:39], v[112:115], v[196:199], v[36:39]
    ds_read_b64_tr_b16 v[100:101], v130 offset:53248
    ds_read_b64_tr_b16 v[102:103], v130 offset:53760
    s_add_u32 m0, s57, 114688
    s_add_u32 s64, s55, 860288
    buffer_load_dwordx4 v122, s[36:39], s64 offen lds
    v_exp_f32 v1, v1
    s_lshl_b32 s3, s3, 2
    s_waitcnt lgkmcnt(6)
    v_mfma_f32_16x16x32_bf16 v[24:27], v[64:67], v[192:195], v[24:27]
    v_mfma_f32_16x16x32_bf16 v[28:31], v[64:67], v[196:199], v[28:31]
    ds_read_b64_tr_b16 v[108:109], v127 offset:28672
    ds_read_b64_tr_b16 v[110:111], v127 offset:29184
    v_add_f32 v1, 1.0, v1
    v_mfma_f32_16x16x32_bf16 v[40:43], v[68:71], v[192:195], v[40:43]
    v_mfma_f32_16x16x32_bf16 v[44:47], v[68:71], v[196:199], v[44:47]
    ds_read_b64_tr_b16 v[112:113], v131 offset:53248
    ds_read_b64_tr_b16 v[114:115], v131 offset:53760
    v_rcp_f32 v1, v1
    s_add_u32 s3, s3, 14942208
    s_mov_b32 exec_lo, 0
    s_mov_b32 exec_hi, 0x80000000
    buffer_store_dword v1, off, s[28:31], s3 sc1
    s_mov_b64 exec, -1
    s_waitcnt lgkmcnt(0)
    v_mfma_f32_16x16x32_bf16 v[16:19], v[96:99], v[200:203], v[16:19]
    v_mfma_f32_16x16x32_bf16 v[20:23], v[96:99], v[204:207], v[20:23]
    s_waitcnt vmcnt(5)
    s_barrier
    ds_read_b128 v[208:211], v125 offset:0
    ds_read_b128 v[212:215], v125 offset:2048
    ds_read_b64_tr_b16 v[64:65], v129 offset:0
    ds_read_b64_tr_b16 v[66:67], v129 offset:512
    s_lshl_b32 s0, s52, 2
    s_add_u32 s0, s0, s60
    v_mfma_f32_16x16x32_bf16 v[32:35], v[100:103], v[200:203], v[32:35]
    v_mfma_f32_16x16x32_bf16 v[36:39], v[100:103], v[204:207], v[36:39]
    ds_read_b64_tr_b16 v[68:69], v130 offset:0
    ds_read_b64_tr_b16 v[70:71], v130 offset:512
    s_add_u32 m0, s58, 32768
    s_add_u32 s64, s54, 768
    buffer_load_dwordx4 v120, s[32:35], s64 offen lds
    buffer_load_dwordx4 v121, s[32:35], s64 offen offset:1024 lds
    s_mul_i32 s62, s0, 28672
    s_add_u32 s63, s62, 0
    s_lshl_b32 s0, s55, 5
    s_add_u32 s62, s63, s0
    s_mov_b32 s65, 0x3e8b97f6
    s_and_b32 s0, s2, 7
    v_mfma_f32_16x16x32_bf16 v[24:27], v[108:111], v[200:203], v[24:27]
    v_mfma_f32_16x16x32_bf16 v[28:31], v[108:111], v[204:207], v[28:31]
    ds_read_b64_tr_b16 v[96:97], v127 offset:0
    ds_read_b64_tr_b16 v[98:99], v127 offset:512
    s_lshr_b32 s1, s2, 3
    s_lshl_b32 s66, s0, 1
    s_lshr_b32 s67, s2, 7
    v_mfma_f32_16x16x32_bf16 v[40:43], v[112:115], v[200:203], v[40:43]
    v_mfma_f32_16x16x32_bf16 v[44:47], v[112:115], v[204:207], v[44:47]
    ds_read_b64_tr_b16 v[100:101], v131 offset:0
    ds_read_b64_tr_b16 v[102:103], v131 offset:512
    s_add_u32 m0, s57, 81920
    s_add_u32 s64, s55, 1032192
    buffer_load_dwordx4 v122, s[36:39], s64 offen lds
    s_add_u32 s66, s66, s67
    s_and_b32 s67, s1, 15
    s_and_b32 s70, s26, 3
    s_lshl_b32 s0, s26, 8
    s_add_u32 s0, s0, 155648
    s_waitcnt lgkmcnt(4)
    v_mfma_f32_16x16x32_bf16 v[16:19], v[64:67], v[208:211], v[16:19]
    v_mfma_f32_16x16x32_bf16 v[20:23], v[64:67], v[212:215], v[20:23]
    ds_read_b128 v[216:219], v126 offset:0
    ds_read_b128 v[220:223], v126 offset:2048
    ds_read_b64_tr_b16 v[108:109], v129 offset:4096
    ds_read_b64_tr_b16 v[110:111], v129 offset:4608
    v_lshl_add_u32 v14, v0, 2, s0
    s_lshr_b32 s0, s2, 3
    s_bitcmp1_b32 s2, 0
    s_cselect_b32 s1, 32, 0
    s_cselect_b32 s69, 24, 32
    v_mfma_f32_16x16x32_bf16 v[32:35], v[68:71], v[208:211], v[32:35]
    v_mfma_f32_16x16x32_bf16 v[36:39], v[68:71], v[212:215], v[36:39]
    ds_read_b64_tr_b16 v[112:113], v130 offset:4096
    ds_read_b64_tr_b16 v[114:115], v130 offset:4608
    s_add_u32 m0, s57, 131072
    s_add_u32 s64, s55, 1032320
    buffer_load_dwordx4 v122, s[36:39], s64 offen lds
    s_cmp_ge_u32 s0, s69
    s_cselect_b32 s69, 7, 0
    s_add_u32 s0, s0, s1
    s_mul_i32 s68, s0, 9363
    s_lshr_b32 s68, s68, 16
    s_mul_i32 s1, s68, 7
    s_sub_u32 s0, s0, s1
    s_waitcnt lgkmcnt(6)
    v_mfma_f32_16x16x32_bf16 v[24:27], v[96:99], v[208:211], v[24:27]
    v_mfma_f32_16x16x32_bf16 v[28:31], v[96:99], v[212:215], v[28:31]
    ds_read_b64_tr_b16 v[64:65], v127 offset:4096
    ds_read_b64_tr_b16 v[66:67], v127 offset:4608
    s_or_b32 s69, s69, s0
    s_min_u32 s68, s68, 7
    s_bfe_u32 s0, s2, 0x20001
    v_mfma_f32_16x16x32_bf16 v[40:43], v[100:103], v[208:211], v[40:43]
    v_mfma_f32_16x16x32_bf16 v[44:47], v[100:103], v[212:215], v[44:47]
    ds_read_b64_tr_b16 v[68:69], v131 offset:4096
    ds_read_b64_tr_b16 v[70:71], v131 offset:4608
    s_lshl_b32 s0, s0, 3
    s_add_u32 s68, s68, s0
    s_mul_i32 s0, s66, 28
    s_add_u32 s1, s0, 27
    s_lshr_b32 s80, s0, 6
    s_waitcnt lgkmcnt(0)
    v_mfma_f32_16x16x32_bf16 v[16:19], v[108:111], v[216:219], v[16:19]
    v_mfma_f32_16x16x32_bf16 v[20:23], v[108:111], v[220:223], v[20:23]
    s_waitcnt vmcnt(5)
    s_barrier
    ds_read_b128 v[224:227], v125 offset:16384
    ds_read_b128 v[228:231], v125 offset:18432
    ds_read_b64_tr_b16 v[96:97], v129 offset:8192
    ds_read_b64_tr_b16 v[98:99], v129 offset:8704
    s_lshr_b32 s81, s1, 6
    s_sub_u32 s81, s81, s80
    v_and_b32 v5, 1, v0
    v_mfma_f32_16x16x32_bf16 v[32:35], v[112:115], v[216:219], v[32:35]
    v_mfma_f32_16x16x32_bf16 v[36:39], v[112:115], v[220:223], v[36:39]
    ds_read_b64_tr_b16 v[100:101], v130 offset:16384
    ds_read_b64_tr_b16 v[102:103], v130 offset:16896
    s_add_u32 m0, s57, 49152
    s_add_u32 s64, s55, 256
    buffer_load_dwordx4 v122, s[36:39], s64 offen lds
    v_mul_u32_u24 v5, s81, v5
    v_bfe_u32 v6, v0, 1, 1
    v_mad_u32_u24 v5, v6, 7, v5
    v_bfe_u32 v6, v0, 2, 2
    v_lshl_add_u32 v5, v6, 4, v5
    s_lshl_b32 s81, s70, 6
    v_mfma_f32_16x16x32_bf16 v[24:27], v[64:67], v[216:219], v[24:27]
    v_mfma_f32_16x16x32_bf16 v[28:31], v[64:67], v[220:223], v[28:31]
    ds_read_b64_tr_b16 v[108:109], v127 offset:8192
    ds_read_b64_tr_b16 v[110:111], v127 offset:8704
    s_add_u32 s81, s81, s80
    v_add_u32 v5, s81, v5
    v_mfma_f32_16x16x32_bf16 v[40:43], v[68:71], v[216:219], v[40:43]
    v_mfma_f32_16x16x32_bf16 v[44:47], v[68:71], v[220:223], v[44:47]
    ds_read_b64_tr_b16 v[112:113], v131 offset:16384
    ds_read_b64_tr_b16 v[114:115], v131 offset:16896
    s_add_u32 m0, s57, 57344
    s_nop 0
    buffer_load_dwordx4 v122, s[36:39], s56 offen lds
    s_lshl_b32 s81, s67, 4
    s_lshr_b32 s0, s66, 3
    s_add_u32 s0, s0, s81
    s_add_u32 s0, s0, 14
    v_writelane_b32 v5, s0, 16
    v_lshlrev_b32 v5, 7, v5
    s_waitcnt lgkmcnt(4)
    v_mfma_f32_16x16x32_bf16 v[16:19], v[96:99], v[224:227], v[16:19]
    v_mfma_f32_16x16x32_bf16 v[20:23], v[96:99], v[228:231], v[20:23]
    ds_read_b128 v[232:235], v126 offset:16384
    ds_read_b128 v[236:239], v126 offset:18432
    ds_read_b64_tr_b16 v[64:65], v129 offset:12288
    ds_read_b64_tr_b16 v[66:67], v129 offset:12800
    v_add_u32 v12, 15728640, v5
    v_lshrrev_b32 v5, 5, v0
    v_mul_u32_u24 v5, 6656, v5
    v_mfma_f32_16x16x32_bf16 v[32:35], v[100:103], v[224:227], v[32:35]
    v_mfma_f32_16x16x32_bf16 v[36:39], v[100:103], v[228:231], v[36:39]
    ds_read_b64_tr_b16 v[68:69], v130 offset:20480
    ds_read_b64_tr_b16 v[70:71], v130 offset:20992
    s_add_u32 m0, s57, 147456
    s_add_u32 s64, s55, 172288
    buffer_load_dwordx4 v122, s[36:39], s64 offen lds
    v_add_u32 v10, v5, v134
    s_mul_i32 s86, s66, 7
    s_lshr_b32 s86, s86, 1
    s_lshl_b32 s86, s86, 9
    s_mul_i32 s1, s70, 458752
    s_waitcnt lgkmcnt(6)
    v_mfma_f32_16x16x32_bf16 v[24:27], v[108:111], v[224:227], v[24:27]
    v_mfma_f32_16x16x32_bf16 v[28:31], v[108:111], v[228:231], v[28:31]
    ds_read_b64_tr_b16 v[96:97], v127 offset:12288
    ds_read_b64_tr_b16 v[98:99], v127 offset:12800
    s_add_u32 s0, s1, s86
    s_add_u32 s0, s0, 1835008
    s_add_u32 s72, s28, s0
    s_addc_u32 s73, s29, 0
    v_mfma_f32_16x16x32_bf16 v[40:43], v[112:115], v[224:227], v[40:43]
    v_mfma_f32_16x16x32_bf16 v[44:47], v[112:115], v[228:231], v[44:47]
    ds_read_b64_tr_b16 v[100:101], v131 offset:20480
    ds_read_b64_tr_b16 v[102:103], v131 offset:20992
    s_add_u32 m0, s57, 155648
    s_add_u32 s64, s56, 172032
    buffer_load_dwordx4 v122, s[36:39], s64 offen lds
    s_mov_b32 s74, 458752
    s_mov_b32 s75, 0x00020000
    s_mul_i32 s0, s66, 448
    s_add_u32 s0, s0, s1
    s_add_u32 s0, s0, 3670016
    s_add_u32 s76, s28, s0
    s_addc_u32 s77, s29, 0
    s_lshl_b32 s18, s2, 3
    s_add_u32 s18, s18, s26
    s_lshl_b32 s19, s18, 7
    v_lshl_add_u32 v13, v0, 18, s19
    s_mov_b32 s4, s16
    s_mov_b32 s5, s17
    s_mov_b32 s6, 1605632
    s_mov_b32 s7, 0x00020000
    s_mov_b32 s12, s8
    s_mov_b32 s13, s9
    s_mov_b32 s14, 401408
    s_mov_b32 s15, 0x00020000
    s_mov_b64 exec, 0x7f
    buffer_load_dword v11, v13, s[4:7], 0 offen
    buffer_load_dword v11, v13, s[12:15], 0 offen
    s_mov_b64 exec, -1
    s_waitcnt lgkmcnt(0)
    v_mfma_f32_16x16x32_bf16 v[16:19], v[64:67], v[232:235], v[16:19]
    v_mfma_f32_16x16x32_bf16 v[20:23], v[64:67], v[236:239], v[20:23]
    s_waitcnt vmcnt(6)
    s_barrier
    s_mov_b32 s48, s22
    s_mov_b32 s49, s23
    s_mov_b32 s50, 256
    s_mov_b32 s51, 0x00020000
    s_cmp_lg_u32 s26, 0
    s_cbranch_scc1 gated_mix__mha_block__glu_gated_geglu__prompt_kernel_skip23
    s_and_b32 s3, s2, 3
    s_lshl_b32 s3, s3, 6
    v_mov_b32 v13, 1
    s_mov_b64 exec, 1
    buffer_atomic_add v13, off, s[48:51], s3 sc1
    s_mov_b64 exec, -1
gated_mix__mha_block__glu_gated_geglu__prompt_kernel_skip23:
    ds_read_b128 v[240:243], v125 offset:32768
    ds_read_b128 v[244:247], v125 offset:34816
    ds_read_b64_tr_b16 v[108:109], v129 offset:16384
    ds_read_b64_tr_b16 v[110:111], v129 offset:16896
    s_mov_b32 s78, 458752
    s_mov_b32 s79, 0x00020000
    s_lshl_b32 s1, s67, 2
    v_mfma_f32_16x16x32_bf16 v[32:35], v[68:71], v[232:235], v[32:35]
    v_mfma_f32_16x16x32_bf16 v[36:39], v[68:71], v[236:239], v[36:39]
    ds_read_b64_tr_b16 v[112:113], v130 offset:32768
    ds_read_b64_tr_b16 v[114:115], v130 offset:33280
    s_add_u32 m0, s57, 0
    s_add_u32 s64, s55, 344320
    buffer_load_dwordx4 v122, s[36:39], s64 offen lds
    s_add_u32 s0, s70, 1
    s_and_b32 s0, s0, 3
    s_add_u32 m0, s57, 8192
    s_add_u32 s64, s56, 344064
    buffer_load_dwordx4 v122, s[36:39], s64 offen lds
    s_add_u32 s0, s0, s1
    s_mul_i32 s0, s0, 28672
    s_add_u32 s80, s0, s86
    v_mfma_f32_16x16x32_bf16 v[24:27], v[96:99], v[232:235], v[24:27]
    v_mfma_f32_16x16x32_bf16 v[28:31], v[96:99], v[236:239], v[28:31]
    ds_read_b64_tr_b16 v[64:65], v127 offset:16384
    ds_read_b64_tr_b16 v[66:67], v127 offset:16896
    s_add_u32 s0, s70, 2
    s_and_b32 s0, s0, 3
    s_add_u32 s0, s0, s1
    v_mfma_f32_16x16x32_bf16 v[40:43], v[100:103], v[232:235], v[40:43]
    v_mfma_f32_16x16x32_bf16 v[44:47], v[100:103], v[236:239], v[44:47]
    ds_read_b64_tr_b16 v[68:69], v131 offset:32768
    ds_read_b64_tr_b16 v[70:71], v131 offset:33280
    s_add_u32 m0, s57, 98304
    s_add_u32 s64, s55, 516352
    buffer_load_dwordx4 v122, s[36:39], s64 offen lds
    s_mul_i32 s0, s0, 28672
    s_add_u32 s81, s0, s86
    s_add_u32 s0, s70, 3
    s_add_u32 m0, s57, 106496
    s_add_u32 s64, s56, 516096
    buffer_load_dwordx4 v122, s[36:39], s64 offen lds
    s_and_b32 s0, s0, 3
    s_add_u32 s0, s0, s1
    s_mul_i32 s0, s0, 28672
    s_waitcnt lgkmcnt(4)
    v_mfma_f32_16x16x32_bf16 v[16:19], v[108:111], v[240:243], v[16:19]
    v_mfma_f32_16x16x32_bf16 v[20:23], v[108:111], v[244:247], v[20:23]
    ds_read_b128 v[248:251], v126 offset:32768
    ds_read_b128 v[252:255], v126 offset:34816
    ds_read_b64_tr_b16 v[96:97], v129 offset:20480
    ds_read_b64_tr_b16 v[98:99], v129 offset:20992
    s_add_u32 s82, s0, s86
    s_add_u32 s0, s70, 4
    v_mfma_f32_16x16x32_bf16 v[32:35], v[112:115], v[240:243], v[32:35]
    v_mfma_f32_16x16x32_bf16 v[36:39], v[112:115], v[244:247], v[36:39]
    ds_read_b64_tr_b16 v[100:101], v130 offset:36864
    ds_read_b64_tr_b16 v[102:103], v130 offset:37376
    s_add_u32 m0, s57, 16384
    s_add_u32 s64, s55, 688384
    buffer_load_dwordx4 v122, s[36:39], s64 offen lds
    s_and_b32 s0, s0, 3
    s_add_u32 s0, s0, s1
    s_mul_i32 s0, s0, 28672
    s_add_u32 m0, s57, 24576
    s_add_u32 s64, s56, 688128
    buffer_load_dwordx4 v122, s[36:39], s64 offen lds
    s_add_u32 s83, s0, s86
    s_add_u32 s0, s1, s70
    s_lshl_b32 s60, s0, 7
    s_waitcnt lgkmcnt(6)
    v_mfma_f32_16x16x32_bf16 v[24:27], v[64:67], v[240:243], v[24:27]
    v_mfma_f32_16x16x32_bf16 v[28:31], v[64:67], v[244:247], v[28:31]
    ds_read_b64_tr_b16 v[108:109], v127 offset:20480
    ds_read_b64_tr_b16 v[110:111], v127 offset:20992
    s_add_u32 s61, s60, 14942208
    s_lshl_b32 s0, s0, 4
    s_add_u32 s0, s0, s66
    v_mfma_f32_16x16x32_bf16 v[40:43], v[68:71], v[240:243], v[40:43]
    v_mfma_f32_16x16x32_bf16 v[44:47], v[68:71], v[244:247], v[44:47]
    ds_read_b64_tr_b16 v[112:113], v131 offset:36864
    ds_read_b64_tr_b16 v[114:115], v131 offset:37376
    s_add_u32 m0, s57, 114688
    s_add_u32 s64, s55, 860416
    buffer_load_dwordx4 v122, s[36:39], s64 offen lds
    s_lshl_b32 s86, s0, 11
    s_add_u32 s86, s86, 12845056
    s_lshl_b32 s87, s0, 7
    s_add_u32 m0, s57, 122880
    s_add_u32 s64, s56, 860160
    buffer_load_dwordx4 v122, s[36:39], s64 offen lds
    s_add_u32 s87, s87, 15761408
    s_mov_b32 s84, 0x0fffffff
    s_mov_b32 s85, 0x0fffffff
    s_waitcnt lgkmcnt(4)
    v_mfma_f32_16x16x32_bf16 v[16:19], v[96:99], v[248:251], v[16:19]
    v_mfma_f32_16x16x32_bf16 v[20:23], v[96:99], v[252:255], v[20:23]
    v_mfma_f32_16x16x32_bf16 v[32:35], v[100:103], v[248:251], v[32:35]
    v_mfma_f32_16x16x32_bf16 v[36:39], v[100:103], v[252:255], v[36:39]
    s_waitcnt lgkmcnt(0)
    v_mfma_f32_16x16x32_bf16 v[24:27], v[108:111], v[248:251], v[24:27]
    v_mfma_f32_16x16x32_bf16 v[28:31], v[108:111], v[252:255], v[28:31]
    s_waitcnt vmcnt(10)
    s_barrier
    ds_read_b64_tr_b16 v[96:97], v132 offset:49152
    ds_read_b64_tr_b16 v[98:99], v132 offset:49664
    v_mfma_f32_16x16x32_bf16 v[40:43], v[112:115], v[248:251], v[40:43]
    v_mfma_f32_16x16x32_bf16 v[44:47], v[112:115], v[252:255], v[44:47]
    ds_read_b64_tr_b16 v[100:101], v133 offset:49152
    ds_read_b64_tr_b16 v[102:103], v133 offset:49664
    s_add_u32 m0, s57, 32768
    s_add_u32 s64, s55, 1032448
    buffer_load_dwordx4 v122, s[36:39], s64 offen lds
    ds_read_b64_tr_b16 v[104:105], v132 offset:53248
    ds_read_b64_tr_b16 v[106:107], v132 offset:53760
    s_add_u32 m0, s57, 40960
    s_add_u32 s64, s56, 1032192
    buffer_load_dwordx4 v122, s[36:39], s64 offen lds
    s_waitcnt lgkmcnt(4)
    v_mfma_f32_16x16x32_bf16 v[64:67], v[96:99], v[144:147], 0
    v_mfma_f32_16x16x32_bf16 v[68:71], v[96:99], v[148:151], 0
    ds_read_b64_tr_b16 v[108:109], v133 offset:53248
    ds_read_b64_tr_b16 v[110:111], v133 offset:53760
    v_mul_f32 v16, s65, v16
    v_mul_f32 v17, s65, v17
    v_mul_f32 v18, s65, v18
    v_mul_f32 v19, s65, v19
    v_mul_f32 v20, s65, v20
    v_mul_f32 v21, s65, v21
    v_mul_f32 v22, s65, v22
    v_mul_f32 v23, s65, v23
    s_waitcnt lgkmcnt(4)
    v_mfma_f32_16x16x32_bf16 v[72:75], v[100:103], v[144:147], 0
    v_mfma_f32_16x16x32_bf16 v[76:79], v[100:103], v[148:151], 0
    ds_read_b64_tr_b16 v[112:113], v130 offset:49152
    ds_read_b64_tr_b16 v[114:115], v130 offset:49664
    v_mul_f32 v24, s65, v24
    v_mul_f32 v25, s65, v25
    v_mul_f32 v26, s65, v26
    v_mul_f32 v27, s65, v27
    v_mul_f32 v28, s65, v28
    v_mul_f32 v29, s65, v29
    v_mul_f32 v30, s65, v30
    v_mul_f32 v31, s65, v31
    s_waitcnt lgkmcnt(4)
    v_mfma_f32_16x16x32_bf16 v[64:67], v[104:107], v[152:155], v[64:67]
    v_mfma_f32_16x16x32_bf16 v[68:71], v[104:107], v[156:159], v[68:71]
    ds_read_b64_tr_b16 v[116:117], v131 offset:49152
    ds_read_b64_tr_b16 v[118:119], v131 offset:49664
    v_cvt_pk_bf16_f32 v136, v16, v17
    v_cvt_pk_bf16_f32 v137, v18, v19
    v_cvt_pk_bf16_f32 v138, v20, v21
    v_cvt_pk_bf16_f32 v139, v22, v23
    v_cvt_pk_bf16_f32 v140, v24, v25
    v_cvt_pk_bf16_f32 v141, v26, v27
    v_cvt_pk_bf16_f32 v142, v28, v29
    v_cvt_pk_bf16_f32 v143, v30, v31
    s_waitcnt lgkmcnt(4)
    v_mfma_f32_16x16x32_bf16 v[72:75], v[108:111], v[152:155], v[72:75]
    v_mfma_f32_16x16x32_bf16 v[76:79], v[108:111], v[156:159], v[76:79]
    ds_read_b64_tr_b16 v[96:97], v130 offset:53248
    ds_read_b64_tr_b16 v[98:99], v130 offset:53760
    s_add_u32 s59, s62, 0
    v_permlane16_swap_b32 v136, v138
    v_permlane16_swap_b32 v137, v139
    v_permlane16_swap_b32 v140, v142
    v_permlane16_swap_b32 v141, v143
    buffer_store_dwordx4 v[136:139], v134, s[28:31], s59 offen offset:0 sc1
    buffer_store_dwordx4 v[140:143], v134, s[28:31], s59 offen offset:1024 sc1
    v_mul_f32 v32, s65, v32
    s_waitcnt lgkmcnt(4)
    v_mfma_f32_16x16x32_bf16 v[64:67], v[112:115], v[160:163], v[64:67]
    v_mfma_f32_16x16x32_bf16 v[68:71], v[112:115], v[164:167], v[68:71]
    ds_read_b64_tr_b16 v[100:101], v131 offset:53248
    ds_read_b64_tr_b16 v[102:103], v131 offset:53760
    v_mul_f32 v33, s65, v33
    v_mul_f32 v34, s65, v34
    v_mul_f32 v35, s65, v35
    v_mul_f32 v36, s65, v36
    v_mul_f32 v37, s65, v37
    v_mul_f32 v38, s65, v38
    v_mul_f32 v39, s65, v39
    v_mul_f32 v40, s65, v40
    s_waitcnt lgkmcnt(4)
    v_mfma_f32_16x16x32_bf16 v[72:75], v[116:119], v[160:163], v[72:75]
    v_mfma_f32_16x16x32_bf16 v[76:79], v[116:119], v[164:167], v[76:79]
    s_waitcnt vmcnt(8)
    s_barrier
    ds_read_b64_tr_b16 v[104:105], v132 offset:0
    ds_read_b64_tr_b16 v[106:107], v132 offset:512
    v_mul_f32 v41, s65, v41
    v_mul_f32 v42, s65, v42
    v_mul_f32 v43, s65, v43
    v_mul_f32 v44, s65, v44
    v_mul_f32 v45, s65, v45
    v_mul_f32 v46, s65, v46
    v_mul_f32 v47, s65, v47
    v_cvt_pk_bf16_f32 v136, v32, v33
    s_waitcnt lgkmcnt(4)
    v_mfma_f32_16x16x32_bf16 v[64:67], v[96:99], v[168:171], v[64:67]
    v_mfma_f32_16x16x32_bf16 v[68:71], v[96:99], v[172:175], v[68:71]
    ds_read_b64_tr_b16 v[108:109], v133 offset:0
    ds_read_b64_tr_b16 v[110:111], v133 offset:512
    v_cvt_pk_bf16_f32 v137, v34, v35
    v_cvt_pk_bf16_f32 v138, v36, v37
    v_cvt_pk_bf16_f32 v139, v38, v39
    v_cvt_pk_bf16_f32 v140, v40, v41
    v_cvt_pk_bf16_f32 v141, v42, v43
    v_cvt_pk_bf16_f32 v142, v44, v45
    v_cvt_pk_bf16_f32 v143, v46, v47
    s_add_u32 s59, s62, 4096
    s_waitcnt lgkmcnt(4)
    v_mfma_f32_16x16x32_bf16 v[72:75], v[100:103], v[168:171], v[72:75]
    v_mfma_f32_16x16x32_bf16 v[76:79], v[100:103], v[172:175], v[76:79]
    ds_read_b64_tr_b16 v[112:113], v132 offset:4096
    ds_read_b64_tr_b16 v[114:115], v132 offset:4608
    v_permlane16_swap_b32 v136, v138
    v_permlane16_swap_b32 v137, v139
    v_permlane16_swap_b32 v140, v142
    v_permlane16_swap_b32 v141, v143
    buffer_store_dwordx4 v[136:139], v134, s[28:31], s59 offen offset:0 sc1
    buffer_store_dwordx4 v[140:143], v134, s[28:31], s59 offen offset:1024 sc1
    s_waitcnt lgkmcnt(4)
    v_mfma_f32_16x16x32_bf16 v[64:67], v[104:107], v[176:179], v[64:67]
    v_mfma_f32_16x16x32_bf16 v[68:71], v[104:107], v[180:183], v[68:71]
    ds_read_b64_tr_b16 v[116:117], v133 offset:4096
    ds_read_b64_tr_b16 v[118:119], v133 offset:4608
    s_waitcnt lgkmcnt(4)
    v_mfma_f32_16x16x32_bf16 v[72:75], v[108:111], v[176:179], v[72:75]
    v_mfma_f32_16x16x32_bf16 v[76:79], v[108:111], v[180:183], v[76:79]
    ds_read_b64_tr_b16 v[96:97], v130 offset:0
    ds_read_b64_tr_b16 v[98:99], v130 offset:512
    s_waitcnt lgkmcnt(4)
    v_mfma_f32_16x16x32_bf16 v[64:67], v[112:115], v[184:187], v[64:67]
    v_mfma_f32_16x16x32_bf16 v[68:71], v[112:115], v[188:191], v[68:71]
    ds_read_b64_tr_b16 v[100:101], v131 offset:0
    ds_read_b64_tr_b16 v[102:103], v131 offset:512
    s_waitcnt lgkmcnt(4)
    v_mfma_f32_16x16x32_bf16 v[72:75], v[116:119], v[184:187], v[72:75]
    v_mfma_f32_16x16x32_bf16 v[76:79], v[116:119], v[188:191], v[76:79]
    ds_read_b64_tr_b16 v[104:105], v130 offset:4096
    ds_read_b64_tr_b16 v[106:107], v130 offset:4608
    s_waitcnt lgkmcnt(4)
    v_mfma_f32_16x16x32_bf16 v[64:67], v[96:99], v[192:195], v[64:67]
    v_mfma_f32_16x16x32_bf16 v[68:71], v[96:99], v[196:199], v[68:71]
    ds_read_b64_tr_b16 v[108:109], v131 offset:4096
    ds_read_b64_tr_b16 v[110:111], v131 offset:4608
    s_waitcnt lgkmcnt(4)
    v_mfma_f32_16x16x32_bf16 v[72:75], v[100:103], v[192:195], v[72:75]
    v_mfma_f32_16x16x32_bf16 v[76:79], v[100:103], v[196:199], v[76:79]
    s_waitcnt vmcnt(4)
    s_barrier
    ds_read_b64_tr_b16 v[112:113], v132 offset:16384
    ds_read_b64_tr_b16 v[114:115], v132 offset:16896
    s_waitcnt lgkmcnt(4)
    v_mfma_f32_16x16x32_bf16 v[64:67], v[104:107], v[200:203], v[64:67]
    v_mfma_f32_16x16x32_bf16 v[68:71], v[104:107], v[204:207], v[68:71]
    ds_read_b64_tr_b16 v[116:117], v133 offset:16384
    ds_read_b64_tr_b16 v[118:119], v133 offset:16896
    s_waitcnt lgkmcnt(4)
    v_mfma_f32_16x16x32_bf16 v[72:75], v[108:111], v[200:203], v[72:75]
    v_mfma_f32_16x16x32_bf16 v[76:79], v[108:111], v[204:207], v[76:79]
    ds_read_b64_tr_b16 v[96:97], v132 offset:20480
    ds_read_b64_tr_b16 v[98:99], v132 offset:20992
    s_waitcnt lgkmcnt(4)
    v_mfma_f32_16x16x32_bf16 v[64:67], v[112:115], v[208:211], v[64:67]
    v_mfma_f32_16x16x32_bf16 v[68:71], v[112:115], v[212:215], v[68:71]
    ds_read_b64_tr_b16 v[100:101], v133 offset:20480
    ds_read_b64_tr_b16 v[102:103], v133 offset:20992
    s_waitcnt lgkmcnt(4)
    v_mfma_f32_16x16x32_bf16 v[72:75], v[116:119], v[208:211], v[72:75]
    v_mfma_f32_16x16x32_bf16 v[76:79], v[116:119], v[212:215], v[76:79]
    ds_read_b64_tr_b16 v[104:105], v130 offset:16384
    ds_read_b64_tr_b16 v[106:107], v130 offset:16896
    s_waitcnt lgkmcnt(4)
    v_mfma_f32_16x16x32_bf16 v[64:67], v[96:99], v[216:219], v[64:67]
    v_mfma_f32_16x16x32_bf16 v[68:71], v[96:99], v[220:223], v[68:71]
    ds_read_b64_tr_b16 v[108:109], v131 offset:16384
    ds_read_b64_tr_b16 v[110:111], v131 offset:16896
    s_waitcnt lgkmcnt(4)
    v_mfma_f32_16x16x32_bf16 v[72:75], v[100:103], v[216:219], v[72:75]
    v_mfma_f32_16x16x32_bf16 v[76:79], v[100:103], v[220:223], v[76:79]
    ds_read_b64_tr_b16 v[112:113], v130 offset:20480
    ds_read_b64_tr_b16 v[114:115], v130 offset:20992
    s_waitcnt lgkmcnt(4)
    v_mfma_f32_16x16x32_bf16 v[64:67], v[104:107], v[224:227], v[64:67]
    v_mfma_f32_16x16x32_bf16 v[68:71], v[104:107], v[228:231], v[68:71]
    ds_read_b64_tr_b16 v[116:117], v131 offset:20480
    ds_read_b64_tr_b16 v[118:119], v131 offset:20992
    s_waitcnt lgkmcnt(4)
    v_mfma_f32_16x16x32_bf16 v[72:75], v[108:111], v[224:227], v[72:75]
    v_mfma_f32_16x16x32_bf16 v[76:79], v[108:111], v[228:231], v[76:79]
    ds_read_b64_tr_b16 v[96:97], v132 offset:32768
    ds_read_b64_tr_b16 v[98:99], v132 offset:33280
    s_waitcnt lgkmcnt(4)
    v_mfma_f32_16x16x32_bf16 v[64:67], v[112:115], v[232:235], v[64:67]
    v_mfma_f32_16x16x32_bf16 v[68:71], v[112:115], v[236:239], v[68:71]
    ds_read_b64_tr_b16 v[100:101], v133 offset:32768
    ds_read_b64_tr_b16 v[102:103], v133 offset:33280
    s_waitcnt lgkmcnt(4)
    v_mfma_f32_16x16x32_bf16 v[72:75], v[116:119], v[232:235], v[72:75]
    v_mfma_f32_16x16x32_bf16 v[76:79], v[116:119], v[236:239], v[76:79]
    ds_read_b64_tr_b16 v[104:105], v132 offset:36864
    ds_read_b64_tr_b16 v[106:107], v132 offset:37376
    s_waitcnt lgkmcnt(4)
    v_mfma_f32_16x16x32_bf16 v[64:67], v[96:99], v[240:243], v[64:67]
    v_mfma_f32_16x16x32_bf16 v[68:71], v[96:99], v[244:247], v[68:71]
    ds_read_b64_tr_b16 v[108:109], v133 offset:36864
    ds_read_b64_tr_b16 v[110:111], v133 offset:37376
    s_waitcnt lgkmcnt(4)
    v_mfma_f32_16x16x32_bf16 v[72:75], v[100:103], v[240:243], v[72:75]
    v_mfma_f32_16x16x32_bf16 v[76:79], v[100:103], v[244:247], v[76:79]
    ds_read_b64_tr_b16 v[112:113], v132 offset:57344
    ds_read_b64_tr_b16 v[114:115], v132 offset:57856
    s_waitcnt lgkmcnt(4)
    v_mfma_f32_16x16x32_bf16 v[64:67], v[104:107], v[248:251], v[64:67]
    v_mfma_f32_16x16x32_bf16 v[68:71], v[104:107], v[252:255], v[68:71]
    ds_read_b64_tr_b16 v[116:117], v133 offset:57344
    ds_read_b64_tr_b16 v[118:119], v133 offset:57856
    s_waitcnt lgkmcnt(4)
    v_mfma_f32_16x16x32_bf16 v[72:75], v[108:111], v[248:251], v[72:75]
    v_mfma_f32_16x16x32_bf16 v[76:79], v[108:111], v[252:255], v[76:79]
    ds_read_b64_tr_b16 v[96:97], v132 offset:61440
    ds_read_b64_tr_b16 v[98:99], v132 offset:61952
    s_bitcmp1_b32 s53, 0
    s_cbranch_scc1 gated_mix__mha_block__glu_gated_geglu__prompt_kernel_idle24
    s_waitcnt lgkmcnt(4)
    v_mfma_f32_16x16x32_bf16 v[16:19], v[112:115], v[144:147], 0
    v_mfma_f32_16x16x32_bf16 v[20:23], v[112:115], v[148:151], 0
    ds_read_b64_tr_b16 v[100:101], v133 offset:61440
    ds_read_b64_tr_b16 v[102:103], v133 offset:61952
    s_waitcnt lgkmcnt(4)
    v_mfma_f32_16x16x32_bf16 v[24:27], v[116:119], v[144:147], 0
    v_mfma_f32_16x16x32_bf16 v[28:31], v[116:119], v[148:151], 0
    ds_read_b64_tr_b16 v[104:105], v130 offset:57344
    ds_read_b64_tr_b16 v[106:107], v130 offset:57856
    v_mul_f32 v64, s65, v64
    v_mul_f32 v65, s65, v65
    v_mul_f32 v66, s65, v66
    v_mul_f32 v67, s65, v67
    v_mul_f32 v68, s65, v68
    v_mul_f32 v69, s65, v69
    s_waitcnt lgkmcnt(4)
    v_mfma_f32_16x16x32_bf16 v[16:19], v[96:99], v[152:155], v[16:19]
    v_mfma_f32_16x16x32_bf16 v[20:23], v[96:99], v[156:159], v[20:23]
    ds_read_b64_tr_b16 v[108:109], v131 offset:57344
    ds_read_b64_tr_b16 v[110:111], v131 offset:57856
    v_mul_f32 v70, s65, v70
    v_mul_f32 v71, s65, v71
    v_mul_f32 v72, s65, v72
    v_mul_f32 v73, s65, v73
    v_mul_f32 v74, s65, v74
    v_mul_f32 v75, s65, v75
    s_waitcnt lgkmcnt(4)
    v_mfma_f32_16x16x32_bf16 v[24:27], v[100:103], v[152:155], v[24:27]
    v_mfma_f32_16x16x32_bf16 v[28:31], v[100:103], v[156:159], v[28:31]
    ds_read_b64_tr_b16 v[112:113], v130 offset:61440
    ds_read_b64_tr_b16 v[114:115], v130 offset:61952
    v_mul_f32 v76, s65, v76
    v_mul_f32 v77, s65, v77
    v_mul_f32 v78, s65, v78
    v_mul_f32 v79, s65, v79
    v_cvt_pk_bf16_f32 v136, v64, v65
    v_cvt_pk_bf16_f32 v137, v66, v67
    s_waitcnt lgkmcnt(4)
    v_mfma_f32_16x16x32_bf16 v[16:19], v[104:107], v[160:163], v[16:19]
    v_mfma_f32_16x16x32_bf16 v[20:23], v[104:107], v[164:167], v[20:23]
    ds_read_b64_tr_b16 v[116:117], v131 offset:61440
    ds_read_b64_tr_b16 v[118:119], v131 offset:61952
    v_cvt_pk_bf16_f32 v138, v68, v69
    v_cvt_pk_bf16_f32 v139, v70, v71
    v_cvt_pk_bf16_f32 v140, v72, v73
    v_cvt_pk_bf16_f32 v141, v74, v75
    v_cvt_pk_bf16_f32 v142, v76, v77
    v_cvt_pk_bf16_f32 v143, v78, v79
    s_waitcnt lgkmcnt(4)
    v_mfma_f32_16x16x32_bf16 v[24:27], v[108:111], v[160:163], v[24:27]
    v_mfma_f32_16x16x32_bf16 v[28:31], v[108:111], v[164:167], v[28:31]
    ds_read_b64_tr_b16 v[96:97], v132 offset:8192
    ds_read_b64_tr_b16 v[98:99], v132 offset:8704
    s_add_u32 s59, s62, 8192
    v_permlane16_swap_b32 v136, v138
    v_permlane16_swap_b32 v137, v139
    v_permlane16_swap_b32 v140, v142
    v_permlane16_swap_b32 v141, v143
    buffer_store_dwordx4 v[136:139], v134, s[28:31], s59 offen offset:0 sc1
    s_waitcnt lgkmcnt(4)
    v_mfma_f32_16x16x32_bf16 v[16:19], v[112:115], v[168:171], v[16:19]
    v_mfma_f32_16x16x32_bf16 v[20:23], v[112:115], v[172:175], v[20:23]
    ds_read_b64_tr_b16 v[100:101], v133 offset:8192
    ds_read_b64_tr_b16 v[102:103], v133 offset:8704
    buffer_store_dwordx4 v[140:143], v134, s[28:31], s59 offen offset:1024 sc1
    s_waitcnt lgkmcnt(4)
    v_mfma_f32_16x16x32_bf16 v[24:27], v[116:119], v[168:171], v[24:27]
    v_mfma_f32_16x16x32_bf16 v[28:31], v[116:119], v[172:175], v[28:31]
    ds_read_b64_tr_b16 v[104:105], v132 offset:12288
    ds_read_b64_tr_b16 v[106:107], v132 offset:12800
    s_waitcnt lgkmcnt(4)
    v_mfma_f32_16x16x32_bf16 v[16:19], v[96:99], v[176:179], v[16:19]
    v_mfma_f32_16x16x32_bf16 v[20:23], v[96:99], v[180:183], v[20:23]
    ds_read_b64_tr_b16 v[108:109], v133 offset:12288
    ds_read_b64_tr_b16 v[110:111], v133 offset:12800
    s_waitcnt lgkmcnt(4)
    v_mfma_f32_16x16x32_bf16 v[24:27], v[100:103], v[176:179], v[24:27]
    v_mfma_f32_16x16x32_bf16 v[28:31], v[100:103], v[180:183], v[28:31]
    ds_read_b64_tr_b16 v[112:113], v130 offset:8192
    ds_read_b64_tr_b16 v[114:115], v130 offset:8704
    s_waitcnt lgkmcnt(4)
    v_mfma_f32_16x16x32_bf16 v[16:19], v[104:107], v[184:187], v[16:19]
    v_mfma_f32_16x16x32_bf16 v[20:23], v[104:107], v[188:191], v[20:23]
    ds_read_b64_tr_b16 v[116:117], v131 offset:8192
    ds_read_b64_tr_b16 v[118:119], v131 offset:8704
    s_waitcnt lgkmcnt(4)
    v_mfma_f32_16x16x32_bf16 v[24:27], v[108:111], v[184:187], v[24:27]
    v_mfma_f32_16x16x32_bf16 v[28:31], v[108:111], v[188:191], v[28:31]
    ds_read_b64_tr_b16 v[96:97], v130 offset:12288
    ds_read_b64_tr_b16 v[98:99], v130 offset:12800
    s_waitcnt lgkmcnt(4)
    v_mfma_f32_16x16x32_bf16 v[16:19], v[112:115], v[192:195], v[16:19]
    v_mfma_f32_16x16x32_bf16 v[20:23], v[112:115], v[196:199], v[20:23]
    ds_read_b64_tr_b16 v[100:101], v131 offset:12288
    ds_read_b64_tr_b16 v[102:103], v131 offset:12800
    s_waitcnt lgkmcnt(4)
    v_mfma_f32_16x16x32_bf16 v[24:27], v[116:119], v[192:195], v[24:27]
    v_mfma_f32_16x16x32_bf16 v[28:31], v[116:119], v[196:199], v[28:31]
    ds_read_b64_tr_b16 v[104:105], v132 offset:24576
    ds_read_b64_tr_b16 v[106:107], v132 offset:25088
    s_waitcnt lgkmcnt(4)
    v_mfma_f32_16x16x32_bf16 v[16:19], v[96:99], v[200:203], v[16:19]
    v_mfma_f32_16x16x32_bf16 v[20:23], v[96:99], v[204:207], v[20:23]
    ds_read_b64_tr_b16 v[108:109], v133 offset:24576
    ds_read_b64_tr_b16 v[110:111], v133 offset:25088
    s_waitcnt lgkmcnt(4)
    v_mfma_f32_16x16x32_bf16 v[24:27], v[100:103], v[200:203], v[24:27]
    v_mfma_f32_16x16x32_bf16 v[28:31], v[100:103], v[204:207], v[28:31]
    ds_read_b64_tr_b16 v[112:113], v132 offset:28672
    ds_read_b64_tr_b16 v[114:115], v132 offset:29184
    s_waitcnt lgkmcnt(4)
    v_mfma_f32_16x16x32_bf16 v[16:19], v[104:107], v[208:211], v[16:19]
    v_mfma_f32_16x16x32_bf16 v[20:23], v[104:107], v[212:215], v[20:23]
    ds_read_b64_tr_b16 v[116:117], v133 offset:28672
    ds_read_b64_tr_b16 v[118:119], v133 offset:29184
    s_waitcnt lgkmcnt(4)
    v_mfma_f32_16x16x32_bf16 v[24:27], v[108:111], v[208:211], v[24:27]
    v_mfma_f32_16x16x32_bf16 v[28:31], v[108:111], v[212:215], v[28:31]
    ds_read_b64_tr_b16 v[96:97], v130 offset:24576
    ds_read_b64_tr_b16 v[98:99], v130 offset:25088
    s_waitcnt lgkmcnt(4)
    v_mfma_f32_16x16x32_bf16 v[16:19], v[112:115], v[216:219], v[16:19]
    v_mfma_f32_16x16x32_bf16 v[20:23], v[112:115], v[220:223], v[20:23]
    ds_read_b64_tr_b16 v[100:101], v131 offset:24576
    ds_read_b64_tr_b16 v[102:103], v131 offset:25088
    s_waitcnt lgkmcnt(4)
    v_mfma_f32_16x16x32_bf16 v[24:27], v[116:119], v[216:219], v[24:27]
    v_mfma_f32_16x16x32_bf16 v[28:31], v[116:119], v[220:223], v[28:31]
    ds_read_b64_tr_b16 v[104:105], v130 offset:28672
    ds_read_b64_tr_b16 v[106:107], v130 offset:29184
    s_waitcnt lgkmcnt(4)
    v_mfma_f32_16x16x32_bf16 v[16:19], v[96:99], v[224:227], v[16:19]
    v_mfma_f32_16x16x32_bf16 v[20:23], v[96:99], v[228:231], v[20:23]
    ds_read_b64_tr_b16 v[108:109], v131 offset:28672
    ds_read_b64_tr_b16 v[110:111], v131 offset:29184
    s_waitcnt lgkmcnt(4)
    v_mfma_f32_16x16x32_bf16 v[24:27], v[100:103], v[224:227], v[24:27]
    v_mfma_f32_16x16x32_bf16 v[28:31], v[100:103], v[228:231], v[28:31]
    ds_read_b64_tr_b16 v[112:113], v132 offset:40960
    ds_read_b64_tr_b16 v[114:115], v132 offset:41472
    s_waitcnt lgkmcnt(4)
    v_mfma_f32_16x16x32_bf16 v[16:19], v[104:107], v[232:235], v[16:19]
    v_mfma_f32_16x16x32_bf16 v[20:23], v[104:107], v[236:239], v[20:23]
    ds_read_b64_tr_b16 v[116:117], v133 offset:40960
    ds_read_b64_tr_b16 v[118:119], v133 offset:41472
    s_waitcnt lgkmcnt(4)
    v_mfma_f32_16x16x32_bf16 v[24:27], v[108:111], v[232:235], v[24:27]
    v_mfma_f32_16x16x32_bf16 v[28:31], v[108:111], v[236:239], v[28:31]
    ds_read_b64_tr_b16 v[96:97], v132 offset:45056
    ds_read_b64_tr_b16 v[98:99], v132 offset:45568
    s_waitcnt lgkmcnt(4)
    v_mfma_f32_16x16x32_bf16 v[16:19], v[112:115], v[240:243], v[16:19]
    v_mfma_f32_16x16x32_bf16 v[20:23], v[112:115], v[244:247], v[20:23]
    ds_read_b64_tr_b16 v[100:101], v133 offset:45056
    ds_read_b64_tr_b16 v[102:103], v133 offset:45568
    s_waitcnt lgkmcnt(4)
    v_mfma_f32_16x16x32_bf16 v[24:27], v[116:119], v[240:243], v[24:27]
    v_mfma_f32_16x16x32_bf16 v[28:31], v[116:119], v[244:247], v[28:31]
    s_waitcnt lgkmcnt(2)
    v_mfma_f32_16x16x32_bf16 v[16:19], v[96:99], v[248:251], v[16:19]
    v_mfma_f32_16x16x32_bf16 v[20:23], v[96:99], v[252:255], v[20:23]
    s_waitcnt lgkmcnt(0)
    v_mfma_f32_16x16x32_bf16 v[24:27], v[100:103], v[248:251], v[24:27]
    v_mfma_f32_16x16x32_bf16 v[28:31], v[100:103], v[252:255], v[28:31]
    s_nop 3
    v_mul_f32 v16, s65, v16
    v_mul_f32 v17, s65, v17
    v_mul_f32 v18, s65, v18
    v_mul_f32 v19, s65, v19
    v_mul_f32 v20, s65, v20
    v_mul_f32 v21, s65, v21
    v_mul_f32 v22, s65, v22
    v_mul_f32 v23, s65, v23
    v_mul_f32 v24, s65, v24
    v_mul_f32 v25, s65, v25
    v_mul_f32 v26, s65, v26
    v_mul_f32 v27, s65, v27
    v_mul_f32 v28, s65, v28
    v_mul_f32 v29, s65, v29
    v_mul_f32 v30, s65, v30
    v_mul_f32 v31, s65, v31
    v_cvt_pk_bf16_f32 v136, v16, v17
    v_cvt_pk_bf16_f32 v137, v18, v19
    v_cvt_pk_bf16_f32 v138, v20, v21
    v_cvt_pk_bf16_f32 v139, v22, v23
    v_cvt_pk_bf16_f32 v140, v24, v25
    v_cvt_pk_bf16_f32 v141, v26, v27
    v_cvt_pk_bf16_f32 v142, v28, v29
    v_cvt_pk_bf16_f32 v143, v30, v31
    s_add_u32 s59, s63, 12288
    v_permlane16_swap_b32 v136, v138
    v_permlane16_swap_b32 v137, v139
    v_permlane16_swap_b32 v140, v142
    v_permlane16_swap_b32 v141, v143
    buffer_store_dwordx4 v[136:139], v134, s[28:31], s59 offen offset:0 sc1
    buffer_store_dwordx4 v[140:143], v134, s[28:31], s59 offen offset:1024 sc1
    s_branch gated_mix__mha_block__glu_gated_geglu__prompt_kernel_fin25
gated_mix__mha_block__glu_gated_geglu__prompt_kernel_idle24:
    v_mul_f32 v64, s65, v64
    v_mul_f32 v65, s65, v65
    v_mul_f32 v66, s65, v66
    v_mul_f32 v67, s65, v67
    v_mul_f32 v68, s65, v68
    v_mul_f32 v69, s65, v69
    v_mul_f32 v70, s65, v70
    v_mul_f32 v71, s65, v71
    v_mul_f32 v72, s65, v72
    v_mul_f32 v73, s65, v73
    v_mul_f32 v74, s65, v74
    v_mul_f32 v75, s65, v75
    v_mul_f32 v76, s65, v76
    v_mul_f32 v77, s65, v77
    v_mul_f32 v78, s65, v78
    v_mul_f32 v79, s65, v79
    v_cvt_pk_bf16_f32 v136, v64, v65
    v_cvt_pk_bf16_f32 v137, v66, v67
    v_cvt_pk_bf16_f32 v138, v68, v69
    v_cvt_pk_bf16_f32 v139, v70, v71
    v_cvt_pk_bf16_f32 v140, v72, v73
    v_cvt_pk_bf16_f32 v141, v74, v75
    v_cvt_pk_bf16_f32 v142, v76, v77
    v_cvt_pk_bf16_f32 v143, v78, v79
    s_add_u32 s59, s62, 8192
    v_permlane16_swap_b32 v136, v138
    v_permlane16_swap_b32 v137, v139
    v_permlane16_swap_b32 v140, v142
    v_permlane16_swap_b32 v141, v143
    buffer_store_dwordx4 v[136:139], v134, s[28:31], s59 offen offset:0 sc1
    buffer_store_dwordx4 v[140:143], v134, s[28:31], s59 offen offset:1024 sc1
gated_mix__mha_block__glu_gated_geglu__prompt_kernel_fin25:
    s_waitcnt vmcnt(0) lgkmcnt(0)
    s_barrier
    s_cmp_lg_u32 s26, 0
    s_cbranch_scc1 gated_mix__mha_block__glu_gated_geglu__prompt_kernel_skip26
    v_mov_b32 v5, 1
    s_mov_b64 exec, 1
    buffer_store_dword v5, off, s[28:31], s27 sc1
    s_mov_b64 exec, -1
gated_mix__mha_block__glu_gated_geglu__prompt_kernel_skip26:
    s_lshl_b32 s3, s26, 9
    s_add_u32 s3, s3, 155648
    v_lshl_add_u32 v8, v0, 3, s3
    v_mov_b64 v[6:7], 0
    ds_write_b64 v8, v[6:7]
    ds_write_b64 v8, v[6:7] offset:4096
    s_waitcnt lgkmcnt(0)
    s_barrier
    s_branch gated_mix__mha_block__glu_gated_geglu__prompt_kernel_a_plain
gated_mix__mha_block__glu_gated_geglu__prompt_kernel_Q1_22:
    s_waitcnt lgkmcnt(6)
    v_mfma_f32_16x16x32_bf16 v[16:19], v[108:111], v[144:147], 0
    v_mfma_f32_16x16x32_bf16 v[20:23], v[108:111], v[148:151], 0
    ds_read_b128 v[152:155], v126 offset:0
    ds_read_b128 v[156:159], v126 offset:2048
    ds_read_b64_tr_b16 v[96:97], v129 offset:4096
    ds_read_b64_tr_b16 v[98:99], v129 offset:4608
    s_waitcnt lgkmcnt(8)
    v_mfma_f32_16x16x32_bf16 v[32:35], v[112:115], v[144:147], 0
    v_mfma_f32_16x16x32_bf16 v[36:39], v[112:115], v[148:151], 0
    ds_read_b64_tr_b16 v[100:101], v130 offset:4096
    ds_read_b64_tr_b16 v[102:103], v130 offset:4608
    s_add_u32 m0, s58, 32768
    s_add_u32 s64, s54, 256
    buffer_load_dwordx4 v120, s[32:35], s64 offen lds
    buffer_load_dwordx4 v121, s[32:35], s64 offen offset:1024 lds
    s_add_u32 m0, s57, 81920
    s_add_u32 s64, s55, 344064
    buffer_load_dwordx4 v122, s[36:39], s64 offen lds
    s_waitcnt lgkmcnt(8)
    v_mfma_f32_16x16x32_bf16 v[24:27], v[64:67], v[144:147], 0
    v_mfma_f32_16x16x32_bf16 v[28:31], v[64:67], v[148:151], 0
    ds_read_b64_tr_b16 v[108:109], v127 offset:4096
    ds_read_b64_tr_b16 v[110:111], v127 offset:4608
    s_waitcnt lgkmcnt(8)
    v_mfma_f32_16x16x32_bf16 v[40:43], v[68:71], v[144:147], 0
    v_mfma_f32_16x16x32_bf16 v[44:47], v[68:71], v[148:151], 0
    ds_read_b64_tr_b16 v[112:113], v131 offset:4096
    ds_read_b64_tr_b16 v[114:115], v131 offset:4608
    s_add_u32 m0, s57, 131072
    s_add_u32 s64, s55, 344192
    buffer_load_dwordx4 v122, s[36:39], s64 offen lds
    s_waitcnt lgkmcnt(0)
    v_mfma_f32_16x16x32_bf16 v[16:19], v[96:99], v[152:155], v[16:19]
    v_mfma_f32_16x16x32_bf16 v[20:23], v[96:99], v[156:159], v[20:23]
    s_waitcnt vmcnt(10)
    s_barrier
    ds_read_b128 v[160:163], v125 offset:16384
    ds_read_b128 v[164:167], v125 offset:18432
    ds_read_b64_tr_b16 v[64:65], v129 offset:8192
    ds_read_b64_tr_b16 v[66:67], v129 offset:8704
    v_mfma_f32_16x16x32_bf16 v[32:35], v[100:103], v[152:155], v[32:35]
    v_mfma_f32_16x16x32_bf16 v[36:39], v[100:103], v[156:159], v[36:39]
    ds_read_b64_tr_b16 v[68:69], v130 offset:16384
    ds_read_b64_tr_b16 v[70:71], v130 offset:16896
    s_add_u32 m0, s58, 49152
    s_add_u32 s64, s54, 384
    buffer_load_dwordx4 v120, s[32:35], s64 offen lds
    buffer_load_dwordx4 v121, s[32:35], s64 offen offset:1024 lds
    v_mfma_f32_16x16x32_bf16 v[24:27], v[108:111], v[152:155], v[24:27]
    v_mfma_f32_16x16x32_bf16 v[28:31], v[108:111], v[156:159], v[28:31]
    ds_read_b64_tr_b16 v[96:97], v127 offset:8192
    ds_read_b64_tr_b16 v[98:99], v127 offset:8704
    v_mfma_f32_16x16x32_bf16 v[40:43], v[112:115], v[152:155], v[40:43]
    v_mfma_f32_16x16x32_bf16 v[44:47], v[112:115], v[156:159], v[44:47]
    ds_read_b64_tr_b16 v[100:101], v131 offset:16384
    ds_read_b64_tr_b16 v[102:103], v131 offset:16896
    s_add_u32 m0, s57, 90112
    s_add_u32 s64, s55, 516096
    buffer_load_dwordx4 v122, s[36:39], s64 offen lds
    s_waitcnt lgkmcnt(4)
    v_mfma_f32_16x16x32_bf16 v[16:19], v[64:67], v[160:163], v[16:19]
    v_mfma_f32_16x16x32_bf16 v[20:23], v[64:67], v[164:167], v[20:23]
    ds_read_b128 v[168:171], v126 offset:16384
    ds_read_b128 v[172:175], v126 offset:18432
    ds_read_b64_tr_b16 v[108:109], v129 offset:12288
    ds_read_b64_tr_b16 v[110:111], v129 offset:12800
    v_mfma_f32_16x16x32_bf16 v[32:35], v[68:71], v[160:163], v[32:35]
    v_mfma_f32_16x16x32_bf16 v[36:39], v[68:71], v[164:167], v[36:39]
    ds_read_b64_tr_b16 v[112:113], v130 offset:20480
    ds_read_b64_tr_b16 v[114:115], v130 offset:20992
    s_add_u32 m0, s57, 147456
    s_add_u32 s64, s55, 516224
    buffer_load_dwordx4 v122, s[36:39], s64 offen lds
    s_waitcnt lgkmcnt(6)
    v_mfma_f32_16x16x32_bf16 v[24:27], v[96:99], v[160:163], v[24:27]
    v_mfma_f32_16x16x32_bf16 v[28:31], v[96:99], v[164:167], v[28:31]
    ds_read_b64_tr_b16 v[64:65], v127 offset:12288
    ds_read_b64_tr_b16 v[66:67], v127 offset:12800
    v_mfma_f32_16x16x32_bf16 v[40:43], v[100:103], v[160:163], v[40:43]
    v_mfma_f32_16x16x32_bf16 v[44:47], v[100:103], v[164:167], v[44:47]
    ds_read_b64_tr_b16 v[68:69], v131 offset:20480
    ds_read_b64_tr_b16 v[70:71], v131 offset:20992
    s_waitcnt lgkmcnt(0)
    v_mfma_f32_16x16x32_bf16 v[16:19], v[108:111], v[168:171], v[16:19]
    v_mfma_f32_16x16x32_bf16 v[20:23], v[108:111], v[172:175], v[20:23]
    s_waitcnt vmcnt(4)
    s_barrier
    ds_read_b128 v[176:179], v125 offset:32768
    ds_read_b128 v[180:183], v125 offset:34816
    ds_read_b64_tr_b16 v[96:97], v129 offset:16384
    ds_read_b64_tr_b16 v[98:99], v129 offset:16896
    v_mfma_f32_16x16x32_bf16 v[32:35], v[112:115], v[168:171], v[32:35]
    v_mfma_f32_16x16x32_bf16 v[36:39], v[112:115], v[172:175], v[36:39]
    ds_read_b64_tr_b16 v[100:101], v130 offset:32768
    ds_read_b64_tr_b16 v[102:103], v130 offset:33280
    s_add_u32 m0, s58, 0
    s_add_u32 s64, s54, 512
    buffer_load_dwordx4 v120, s[32:35], s64 offen lds
    buffer_load_dwordx4 v121, s[32:35], s64 offen offset:1024 lds
    v_mfma_f32_16x16x32_bf16 v[24:27], v[64:67], v[168:171], v[24:27]
    v_mfma_f32_16x16x32_bf16 v[28:31], v[64:67], v[172:175], v[28:31]
    ds_read_b64_tr_b16 v[108:109], v127 offset:16384
    ds_read_b64_tr_b16 v[110:111], v127 offset:16896
    v_mfma_f32_16x16x32_bf16 v[40:43], v[68:71], v[168:171], v[40:43]
    v_mfma_f32_16x16x32_bf16 v[44:47], v[68:71], v[172:175], v[44:47]
    ds_read_b64_tr_b16 v[112:113], v131 offset:32768
    ds_read_b64_tr_b16 v[114:115], v131 offset:33280
    s_add_u32 m0, s57, 65536
    s_add_u32 s64, s55, 688128
    buffer_load_dwordx4 v122, s[36:39], s64 offen lds
    s_waitcnt lgkmcnt(4)
    v_mfma_f32_16x16x32_bf16 v[16:19], v[96:99], v[176:179], v[16:19]
    v_mfma_f32_16x16x32_bf16 v[20:23], v[96:99], v[180:183], v[20:23]
    ds_read_b128 v[184:187], v126 offset:32768
    ds_read_b128 v[188:191], v126 offset:34816
    ds_read_b64_tr_b16 v[64:65], v129 offset:20480
    ds_read_b64_tr_b16 v[66:67], v129 offset:20992
    v_mfma_f32_16x16x32_bf16 v[32:35], v[100:103], v[176:179], v[32:35]
    v_mfma_f32_16x16x32_bf16 v[36:39], v[100:103], v[180:183], v[36:39]
    ds_read_b64_tr_b16 v[68:69], v130 offset:36864
    ds_read_b64_tr_b16 v[70:71], v130 offset:37376
    s_add_u32 m0, s57, 98304
    s_add_u32 s64, s55, 688256
    buffer_load_dwordx4 v122, s[36:39], s64 offen lds
    s_waitcnt lgkmcnt(6)
    v_mfma_f32_16x16x32_bf16 v[24:27], v[108:111], v[176:179], v[24:27]
    v_mfma_f32_16x16x32_bf16 v[28:31], v[108:111], v[180:183], v[28:31]
    ds_read_b64_tr_b16 v[96:97], v127 offset:20480
    ds_read_b64_tr_b16 v[98:99], v127 offset:20992
    v_mov_b32 v1, 0
    v_mfma_f32_16x16x32_bf16 v[40:43], v[112:115], v[176:179], v[40:43]
    v_mfma_f32_16x16x32_bf16 v[44:47], v[112:115], v[180:183], v[44:47]
    ds_read_b64_tr_b16 v[100:101], v131 offset:36864
    ds_read_b64_tr_b16 v[102:103], v131 offset:37376
    v_dot2_f32_bf16 v1, v136, v140, v1
    v_dot2_f32_bf16 v1, v137, v141, v1
    s_waitcnt lgkmcnt(0)
    v_mfma_f32_16x16x32_bf16 v[16:19], v[64:67], v[184:187], v[16:19]
    v_mfma_f32_16x16x32_bf16 v[20:23], v[64:67], v[188:191], v[20:23]
    s_waitcnt vmcnt(4)
    s_barrier
    ds_read_b128 v[192:195], v125 offset:49152
    ds_read_b128 v[196:199], v125 offset:51200
    ds_read_b64_tr_b16 v[108:109], v129 offset:24576
    ds_read_b64_tr_b16 v[110:111], v129 offset:25088
    v_dot2_f32_bf16 v1, v138, v142, v1
    v_mfma_f32_16x16x32_bf16 v[32:35], v[68:71], v[184:187], v[32:35]
    v_mfma_f32_16x16x32_bf16 v[36:39], v[68:71], v[188:191], v[36:39]
    ds_read_b64_tr_b16 v[112:113], v130 offset:49152
    ds_read_b64_tr_b16 v[114:115], v130 offset:49664
    s_add_u32 m0, s58, 16384
    s_add_u32 s64, s54, 640
    buffer_load_dwordx4 v120, s[32:35], s64 offen lds
    buffer_load_dwordx4 v121, s[32:35], s64 offen offset:1024 lds
    v_dot2_f32_bf16 v1, v139, v143, v1
    s_nop 2
    v_add_f32_dpp v1, v1, v1 row_shr:1 row_mask:0xf bank_mask:0xf
    s_nop 1
    v_add_f32_dpp v1, v1, v1 row_shr:2 row_mask:0xf bank_mask:0xf
    v_mfma_f32_16x16x32_bf16 v[24:27], v[96:99], v[184:187], v[24:27]
    v_mfma_f32_16x16x32_bf16 v[28:31], v[96:99], v[188:191], v[28:31]
    ds_read_b64_tr_b16 v[64:65], v127 offset:24576
    ds_read_b64_tr_b16 v[66:67], v127 offset:25088
    v_add_f32_dpp v1, v1, v1 row_shr:4 row_mask:0xf bank_mask:0xf
    v_mfma_f32_16x16x32_bf16 v[40:43], v[100:103], v[184:187], v[40:43]
    v_mfma_f32_16x16x32_bf16 v[44:47], v[100:103], v[188:191], v[44:47]
    ds_read_b64_tr_b16 v[68:69], v131 offset:49152
    ds_read_b64_tr_b16 v[70:71], v131 offset:49664
    s_add_u32 m0, s57, 73728
    s_add_u32 s64, s55, 860160
    buffer_load_dwordx4 v122, s[36:39], s64 offen lds
    v_add_f32_dpp v1, v1, v1 row_shr:8 row_mask:0xf bank_mask:0xf
    s_nop 1
    v_add_f32_dpp v1, v1, v1 row_bcast:15 row_mask:0xa bank_mask:0xf
    s_waitcnt lgkmcnt(4)
    v_mfma_f32_16x16x32_bf16 v[16:19], v[108:111], v[192:195], v[16:19]
    v_mfma_f32_16x16x32_bf16 v[20:23], v[108:111], v[196:199], v[20:23]
    ds_read_b128 v[200:203], v126 offset:49152
    ds_read_b128 v[204:207], v126 offset:51200
    ds_read_b64_tr_b16 v[96:97], v129 offset:28672
    ds_read_b64_tr_b16 v[98:99], v129 offset:29184
    v_add_f32_dpp v1, v1, v1 row_bcast:31 row_mask:0xc bank_mask:0xf
    v_mul_f32 v1, 0xbfb8aa3b, v1
    v_mfma_f32_16x16x32_bf16 v[32:35], v[112:115], v[192:195], v[32:35]
    v_mfma_f32_16x16x32_bf16 v[36:39], v[112:115], v[196:199], v[36:39]
    ds_read_b64_tr_b16 v[100:101], v130 offset:53248
    ds_read_b64_tr_b16 v[102:103], v130 offset:53760
    s_add_u32 m0, s57, 114688
    s_add_u32 s64, s55, 860288
    buffer_load_dwordx4 v122, s[36:39], s64 offen lds
    v_exp_f32 v1, v1
    s_lshl_b32 s3, s3, 2
    s_waitcnt lgkmcnt(6)
    v_mfma_f32_16x16x32_bf16 v[24:27], v[64:67], v[192:195], v[24:27]
    v_mfma_f32_16x16x32_bf16 v[28:31], v[64:67], v[196:199], v[28:31]
    ds_read_b64_tr_b16 v[108:109], v127 offset:28672
    ds_read_b64_tr_b16 v[110:111], v127 offset:29184
    v_add_f32 v1, 1.0, v1
    v_mfma_f32_16x16x32_bf16 v[40:43], v[68:71], v[192:195], v[40:43]
    v_mfma_f32_16x16x32_bf16 v[44:47], v[68:71], v[196:199], v[44:47]
    ds_read_b64_tr_b16 v[112:113], v131 offset:53248
    ds_read_b64_tr_b16 v[114:115], v131 offset:53760
    v_rcp_f32 v1, v1
    s_add_u32 s3, s3, 14942208
    s_mov_b32 exec_lo, 0
    s_mov_b32 exec_hi, 0x80000000
    buffer_store_dword v1, off, s[28:31], s3 sc1
    s_mov_b64 exec, -1
    s_waitcnt lgkmcnt(0)
    v_mfma_f32_16x16x32_bf16 v[16:19], v[96:99], v[200:203], v[16:19]
    v_mfma_f32_16x16x32_bf16 v[20:23], v[96:99], v[204:207], v[20:23]
    s_waitcnt vmcnt(5)
    s_barrier
    ds_read_b128 v[208:211], v125 offset:0
    ds_read_b128 v[212:215], v125 offset:2048
    ds_read_b64_tr_b16 v[64:65], v129 offset:0
    ds_read_b64_tr_b16 v[66:67], v129 offset:512
    s_lshl_b32 s0, s52, 2
    v_mfma_f32_16x16x32_bf16 v[32:35], v[100:103], v[200:203], v[32:35]
    v_mfma_f32_16x16x32_bf16 v[36:39], v[100:103], v[204:207], v[36:39]
    ds_read_b64_tr_b16 v[68:69], v130 offset:0
    ds_read_b64_tr_b16 v[70:71], v130 offset:512
    s_add_u32 m0, s58, 32768
    s_add_u32 s64, s54, 768
    buffer_load_dwordx4 v120, s[32:35], s64 offen lds
    buffer_load_dwordx4 v121, s[32:35], s64 offen offset:1024 lds
    s_add_u32 s0, s0, s60
    s_mul_i32 s62, s0, 28672
    v_mfma_f32_16x16x32_bf16 v[24:27], v[108:111], v[200:203], v[24:27]
    v_mfma_f32_16x16x32_bf16 v[28:31], v[108:111], v[204:207], v[28:31]
    ds_read_b64_tr_b16 v[96:97], v127 offset:0
    ds_read_b64_tr_b16 v[98:99], v127 offset:512
    s_add_u32 s63, s62, 2048
    v_mfma_f32_16x16x32_bf16 v[40:43], v[112:115], v[200:203], v[40:43]
    v_mfma_f32_16x16x32_bf16 v[44:47], v[112:115], v[204:207], v[44:47]
    ds_read_b64_tr_b16 v[100:101], v131 offset:0
    ds_read_b64_tr_b16 v[102:103], v131 offset:512
    s_add_u32 m0, s57, 81920
    s_add_u32 s64, s55, 1032192
    buffer_load_dwordx4 v122, s[36:39], s64 offen lds
    s_lshl_b32 s0, s55, 5
    s_add_u32 s62, s63, s0
    s_waitcnt lgkmcnt(4)
    v_mfma_f32_16x16x32_bf16 v[16:19], v[64:67], v[208:211], v[16:19]
    v_mfma_f32_16x16x32_bf16 v[20:23], v[64:67], v[212:215], v[20:23]
    ds_read_b128 v[216:219], v126 offset:0
    ds_read_b128 v[220:223], v126 offset:2048
    ds_read_b64_tr_b16 v[108:109], v129 offset:4096
    ds_read_b64_tr_b16 v[110:111], v129 offset:4608
    s_mov_b32 s65, 0x3e8b97f6
    v_mfma_f32_16x16x32_bf16 v[32:35], v[68:71], v[208:211], v[32:35]
    v_mfma_f32_16x16x32_bf16 v[36:39], v[68:71], v[212:215], v[36:39]
    ds_read_b64_tr_b16 v[112:113], v130 offset:4096
    ds_read_b64_tr_b16 v[114:115], v130 offset:4608
    s_add_u32 m0, s57, 131072
    s_add_u32 s64, s55, 1032320
    buffer_load_dwordx4 v122, s[36:39], s64 offen lds
    s_mov_b32 s72, s16
    s_mov_b32 s73, s17
    s_waitcnt lgkmcnt(6)
    v_mfma_f32_16x16x32_bf16 v[24:27], v[96:99], v[208:211], v[24:27]
    v_mfma_f32_16x16x32_bf16 v[28:31], v[96:99], v[212:215], v[28:31]
    ds_read_b64_tr_b16 v[64:65], v127 offset:4096
    ds_read_b64_tr_b16 v[66:67], v127 offset:4608
    s_mov_b32 s74, 1605632
    v_mfma_f32_16x16x32_bf16 v[40:43], v[100:103], v[208:211], v[40:43]
    v_mfma_f32_16x16x32_bf16 v[44:47], v[100:103], v[212:215], v[44:47]
    ds_read_b64_tr_b16 v[68:69], v131 offset:4096
    ds_read_b64_tr_b16 v[70:71], v131 offset:4608
    s_mov_b32 s75, 0x00020000
    v_lshrrev_b32 v5, 3, v0
    v_mul_u32_u24 v6, 896, v5
    s_waitcnt lgkmcnt(0)
    v_mfma_f32_16x16x32_bf16 v[16:19], v[108:111], v[216:219], v[16:19]
    v_mfma_f32_16x16x32_bf16 v[20:23], v[108:111], v[220:223], v[20:23]
    s_waitcnt vmcnt(5)
    s_barrier
    ds_read_b128 v[224:227], v125 offset:16384
    ds_read_b128 v[228:231], v125 offset:18432
    ds_read_b64_tr_b16 v[96:97], v129 offset:8192
    ds_read_b64_tr_b16 v[98:99], v129 offset:8704
    v_lshrrev_b32 v5, 2, v0
    v_mfma_f32_16x16x32_bf16 v[32:35], v[112:115], v[216:219], v[32:35]
    v_mfma_f32_16x16x32_bf16 v[36:39], v[112:115], v[220:223], v[36:39]
    ds_read_b64_tr_b16 v[100:101], v130 offset:16384
    ds_read_b64_tr_b16 v[102:103], v130 offset:16896
    s_add_u32 m0, s57, 49152
    s_add_u32 s64, s55, 256
    buffer_load_dwordx4 v122, s[36:39], s64 offen lds
    v_and_b32 v5, 4, v5
    v_and_b32 v7, 7, v0
    v_mfma_f32_16x16x32_bf16 v[24:27], v[64:67], v[216:219], v[24:27]
    v_mfma_f32_16x16x32_bf16 v[28:31], v[64:67], v[220:223], v[28:31]
    ds_read_b64_tr_b16 v[108:109], v127 offset:8192
    ds_read_b64_tr_b16 v[110:111], v127 offset:8704
    v_xor_b32 v5, v5, v7
    v_mfma_f32_16x16x32_bf16 v[40:43], v[68:71], v[216:219], v[40:43]
    v_mfma_f32_16x16x32_bf16 v[44:47], v[68:71], v[220:223], v[44:47]
    ds_read_b64_tr_b16 v[112:113], v131 offset:16384
    ds_read_b64_tr_b16 v[114:115], v131 offset:16896
    s_add_u32 m0, s57, 57344
    s_nop 0
    buffer_load_dwordx4 v122, s[36:39], s56 offen lds
    v_lshl_add_u32 v9, v5, 4, v6
    v_add_u32 v10, 6144, v9
    s_waitcnt lgkmcnt(4)
    v_mfma_f32_16x16x32_bf16 v[16:19], v[96:99], v[224:227], v[16:19]
    v_mfma_f32_16x16x32_bf16 v[20:23], v[96:99], v[228:231], v[20:23]
    ds_read_b128 v[232:235], v126 offset:16384
    ds_read_b128 v[236:239], v126 offset:18432
    ds_read_b64_tr_b16 v[64:65], v129 offset:12288
    ds_read_b64_tr_b16 v[66:67], v129 offset:12800
    s_and_b32 s70, s26, 3
    v_mfma_f32_16x16x32_bf16 v[32:35], v[100:103], v[224:227], v[32:35]
    v_mfma_f32_16x16x32_bf16 v[36:39], v[100:103], v[228:231], v[36:39]
    ds_read_b64_tr_b16 v[68:69], v130 offset:20480
    ds_read_b64_tr_b16 v[70:71], v130 offset:20992
    s_add_u32 m0, s57, 147456
    s_add_u32 s64, s55, 172288
    buffer_load_dwordx4 v122, s[36:39], s64 offen lds
    s_mul_i32 s81, s70, 14336
    s_mul_i32 s80, s70, 12288
    s_waitcnt lgkmcnt(6)
    v_mfma_f32_16x16x32_bf16 v[24:27], v[108:111], v[224:227], v[24:27]
    v_mfma_f32_16x16x32_bf16 v[28:31], v[108:111], v[228:231], v[28:31]
    ds_read_b64_tr_b16 v[96:97], v127 offset:12288
    ds_read_b64_tr_b16 v[98:99], v127 offset:12800
    s_add_u32 s80, s80, 57344
    v_mfma_f32_16x16x32_bf16 v[40:43], v[112:115], v[224:227], v[40:43]
    v_mfma_f32_16x16x32_bf16 v[44:47], v[112:115], v[228:231], v[44:47]
    ds_read_b64_tr_b16 v[100:101], v131 offset:20480
    ds_read_b64_tr_b16 v[102:103], v131 offset:20992
    s_add_u32 m0, s57, 155648
    s_add_u32 s64, s56, 172032
    buffer_load_dwordx4 v122, s[36:39], s64 offen lds
    s_lshr_b32 s0, s2, 3
    s_bitcmp1_b32 s2, 0
    s_cselect_b32 s1, 32, 0
    s_cselect_b32 s69, 24, 32
    s_cmp_ge_u32 s0, s69
    s_cselect_b32 s69, 7, 0
    s_lshl_b32 s18, s2, 3
    s_add_u32 s18, s18, s26
    s_lshl_b32 s19, s18, 7
    v_lshl_add_u32 v13, v0, 18, s19
    s_mov_b32 s4, s16
    s_mov_b32 s5, s17
    s_mov_b32 s6, 1605632
    s_mov_b32 s7, 0x00020000
    s_mov_b32 s12, s8
    s_mov_b32 s13, s9
    s_mov_b32 s14, 401408
    s_mov_b32 s15, 0x00020000
    s_mov_b64 exec, 0x7f
    buffer_load_dword v11, v13, s[4:7], 0 offen
    buffer_load_dword v11, v13, s[12:15], 0 offen
    s_mov_b64 exec, -1
    s_waitcnt lgkmcnt(0)
    v_mfma_f32_16x16x32_bf16 v[16:19], v[64:67], v[232:235], v[16:19]
    v_mfma_f32_16x16x32_bf16 v[20:23], v[64:67], v[236:239], v[20:23]
    s_waitcnt vmcnt(6)
    s_barrier
    s_mov_b32 s48, s22
    s_mov_b32 s49, s23
    s_mov_b32 s50, 256
    s_mov_b32 s51, 0x00020000
    ds_read_b128 v[240:243], v125 offset:32768
    ds_read_b128 v[244:247], v125 offset:34816
    ds_read_b64_tr_b16 v[108:109], v129 offset:16384
    ds_read_b64_tr_b16 v[110:111], v129 offset:16896
    s_add_u32 s0, s0, s1
    v_mfma_f32_16x16x32_bf16 v[32:35], v[68:71], v[232:235], v[32:35]
    v_mfma_f32_16x16x32_bf16 v[36:39], v[68:71], v[236:239], v[36:39]
    ds_read_b64_tr_b16 v[112:113], v130 offset:32768
    ds_read_b64_tr_b16 v[114:115], v130 offset:33280
    s_add_u32 m0, s57, 0
    s_add_u32 s64, s55, 344320
    buffer_load_dwordx4 v122, s[36:39], s64 offen lds
    s_mul_i32 s68, s0, 9363
    s_add_u32 m0, s57, 8192
    s_add_u32 s64, s56, 344064
    buffer_load_dwordx4 v122, s[36:39], s64 offen lds
    s_lshr_b32 s68, s68, 16
    v_mfma_f32_16x16x32_bf16 v[24:27], v[96:99], v[232:235], v[24:27]
    v_mfma_f32_16x16x32_bf16 v[28:31], v[96:99], v[236:239], v[28:31]
    ds_read_b64_tr_b16 v[64:65], v127 offset:16384
    ds_read_b64_tr_b16 v[66:67], v127 offset:16896
    s_mul_i32 s1, s68, 7
    v_mfma_f32_16x16x32_bf16 v[40:43], v[100:103], v[232:235], v[40:43]
    v_mfma_f32_16x16x32_bf16 v[44:47], v[100:103], v[236:239], v[44:47]
    ds_read_b64_tr_b16 v[68:69], v131 offset:32768
    ds_read_b64_tr_b16 v[70:71], v131 offset:33280
    s_add_u32 m0, s57, 98304
    s_add_u32 s64, s55, 516352
    buffer_load_dwordx4 v122, s[36:39], s64 offen lds
    s_sub_u32 s0, s0, s1
    s_add_u32 m0, s57, 106496
    s_add_u32 s64, s56, 516096
    buffer_load_dwordx4 v122, s[36:39], s64 offen lds
    s_or_b32 s69, s69, s0
    s_waitcnt lgkmcnt(4)
    v_mfma_f32_16x16x32_bf16 v[16:19], v[108:111], v[240:243], v[16:19]
    v_mfma_f32_16x16x32_bf16 v[20:23], v[108:111], v[244:247], v[20:23]
    ds_read_b128 v[248:251], v126 offset:32768
    ds_read_b128 v[252:255], v126 offset:34816
    ds_read_b64_tr_b16 v[96:97], v129 offset:20480
    ds_read_b64_tr_b16 v[98:99], v129 offset:20992
    s_min_u32 s68, s68, 7
    v_mfma_f32_16x16x32_bf16 v[32:35], v[112:115], v[240:243], v[32:35]
    v_mfma_f32_16x16x32_bf16 v[36:39], v[112:115], v[244:247], v[36:39]
    ds_read_b64_tr_b16 v[100:101], v130 offset:36864
    ds_read_b64_tr_b16 v[102:103], v130 offset:37376
    s_add_u32 m0, s57, 16384
    s_add_u32 s64, s55, 688384
    buffer_load_dwordx4 v122, s[36:39], s64 offen lds
    s_bfe_u32 s0, s2, 0x20001
    s_add_u32 m0, s57, 24576
    s_add_u32 s64, s56, 688128
    buffer_load_dwordx4 v122, s[36:39], s64 offen lds
    s_lshl_b32 s0, s0, 3
    s_waitcnt lgkmcnt(6)
    v_mfma_f32_16x16x32_bf16 v[24:27], v[64:67], v[240:243], v[24:27]
    v_mfma_f32_16x16x32_bf16 v[28:31], v[64:67], v[244:247], v[28:31]
    ds_read_b64_tr_b16 v[108:109], v127 offset:20480
    ds_read_b64_tr_b16 v[110:111], v127 offset:20992
    s_add_u32 s68, s68, s0
    v_mfma_f32_16x16x32_bf16 v[40:43], v[68:71], v[240:243], v[40:43]
    v_mfma_f32_16x16x32_bf16 v[44:47], v[68:71], v[244:247], v[44:47]
    ds_read_b64_tr_b16 v[112:113], v131 offset:36864
    ds_read_b64_tr_b16 v[114:115], v131 offset:37376
    s_add_u32 m0, s57, 114688
    s_add_u32 s64, s55, 860416
    buffer_load_dwordx4 v122, s[36:39], s64 offen lds
    s_lshl_b32 s0, s69, 7
    s_add_u32 m0, s57, 122880
    s_add_u32 s64, s56, 860160
    buffer_load_dwordx4 v122, s[36:39], s64 offen lds
    s_mul_i32 s82, s70, 401408
    s_add_u32 s82, s82, s0
    s_waitcnt lgkmcnt(4)
    v_mfma_f32_16x16x32_bf16 v[16:19], v[96:99], v[248:251], v[16:19]
    v_mfma_f32_16x16x32_bf16 v[20:23], v[96:99], v[252:255], v[20:23]
    v_mfma_f32_16x16x32_bf16 v[32:35], v[100:103], v[248:251], v[32:35]
    v_mfma_f32_16x16x32_bf16 v[36:39], v[100:103], v[252:255], v[36:39]
    s_waitcnt lgkmcnt(0)
    v_mfma_f32_16x16x32_bf16 v[24:27], v[108:111], v[248:251], v[24:27]
    v_mfma_f32_16x16x32_bf16 v[28:31], v[108:111], v[252:255], v[28:31]
    s_waitcnt vmcnt(10)
    s_barrier
    ds_read_b64_tr_b16 v[96:97], v132 offset:49152
    ds_read_b64_tr_b16 v[98:99], v132 offset:49664
    v_mfma_f32_16x16x32_bf16 v[40:43], v[112:115], v[248:251], v[40:43]
    v_mfma_f32_16x16x32_bf16 v[44:47], v[112:115], v[252:255], v[44:47]
    ds_read_b64_tr_b16 v[100:101], v133 offset:49152
    ds_read_b64_tr_b16 v[102:103], v133 offset:49664
    s_add_u32 m0, s57, 32768
    s_add_u32 s64, s55, 1032448
    buffer_load_dwordx4 v122, s[36:39], s64 offen lds
    ds_read_b64_tr_b16 v[104:105], v132 offset:53248
    ds_read_b64_tr_b16 v[106:107], v132 offset:53760
    s_add_u32 m0, s57, 40960
    s_add_u32 s64, s56, 1032192
    buffer_load_dwordx4 v122, s[36:39], s64 offen lds
    s_waitcnt lgkmcnt(4)
    v_mfma_f32_16x16x32_bf16 v[64:67], v[96:99], v[144:147], 0
    v_mfma_f32_16x16x32_bf16 v[68:71], v[96:99], v[148:151], 0
    ds_read_b64_tr_b16 v[108:109], v133 offset:53248
    ds_read_b64_tr_b16 v[110:111], v133 offset:53760
    v_mul_f32 v16, s65, v16
    v_mul_f32 v17, s65, v17
    v_mul_f32 v18, s65, v18
    v_mul_f32 v19, s65, v19
    v_mul_f32 v20, s65, v20
    v_mul_f32 v21, s65, v21
    v_mul_f32 v22, s65, v22
    v_mul_f32 v23, s65, v23
    s_waitcnt lgkmcnt(4)
    v_mfma_f32_16x16x32_bf16 v[72:75], v[100:103], v[144:147], 0
    v_mfma_f32_16x16x32_bf16 v[76:79], v[100:103], v[148:151], 0
    ds_read_b64_tr_b16 v[112:113], v130 offset:49152
    ds_read_b64_tr_b16 v[114:115], v130 offset:49664
    v_mul_f32 v24, s65, v24
    v_mul_f32 v25, s65, v25
    v_mul_f32 v26, s65, v26
    v_mul_f32 v27, s65, v27
    v_mul_f32 v28, s65, v28
    v_mul_f32 v29, s65, v29
    v_mul_f32 v30, s65, v30
    v_mul_f32 v31, s65, v31
    s_waitcnt lgkmcnt(4)
    v_mfma_f32_16x16x32_bf16 v[64:67], v[104:107], v[152:155], v[64:67]
    v_mfma_f32_16x16x32_bf16 v[68:71], v[104:107], v[156:159], v[68:71]
    ds_read_b64_tr_b16 v[116:117], v131 offset:49152
    ds_read_b64_tr_b16 v[118:119], v131 offset:49664
    v_cvt_pk_bf16_f32 v136, v16, v17
    v_cvt_pk_bf16_f32 v137, v18, v19
    v_cvt_pk_bf16_f32 v138, v20, v21
    v_cvt_pk_bf16_f32 v139, v22, v23
    v_cvt_pk_bf16_f32 v140, v24, v25
    v_cvt_pk_bf16_f32 v141, v26, v27
    v_cvt_pk_bf16_f32 v142, v28, v29
    v_cvt_pk_bf16_f32 v143, v30, v31
    s_waitcnt lgkmcnt(4)
    v_mfma_f32_16x16x32_bf16 v[72:75], v[108:111], v[152:155], v[72:75]
    v_mfma_f32_16x16x32_bf16 v[76:79], v[108:111], v[156:159], v[76:79]
    ds_read_b64_tr_b16 v[96:97], v130 offset:53248
    ds_read_b64_tr_b16 v[98:99], v130 offset:53760
    s_add_u32 s59, s62, 0
    v_permlane16_swap_b32 v136, v138
    v_permlane16_swap_b32 v137, v139
    v_permlane16_swap_b32 v140, v142
    v_permlane16_swap_b32 v141, v143
    buffer_store_dwordx4 v[136:139], v134, s[28:31], s59 offen offset:0 sc1
    buffer_store_dwordx4 v[140:143], v134, s[28:31], s59 offen offset:1024 sc1
    v_mul_f32 v32, s65, v32
    s_waitcnt lgkmcnt(4)
    v_mfma_f32_16x16x32_bf16 v[64:67], v[112:115], v[160:163], v[64:67]
    v_mfma_f32_16x16x32_bf16 v[68:71], v[112:115], v[164:167], v[68:71]
    ds_read_b64_tr_b16 v[100:101], v131 offset:53248
    ds_read_b64_tr_b16 v[102:103], v131 offset:53760
    v_mul_f32 v33, s65, v33
    v_mul_f32 v34, s65, v34
    v_mul_f32 v35, s65, v35
    v_mul_f32 v36, s65, v36
    v_mul_f32 v37, s65, v37
    v_mul_f32 v38, s65, v38
    v_mul_f32 v39, s65, v39
    v_mul_f32 v40, s65, v40
    s_waitcnt lgkmcnt(4)
    v_mfma_f32_16x16x32_bf16 v[72:75], v[116:119], v[160:163], v[72:75]
    v_mfma_f32_16x16x32_bf16 v[76:79], v[116:119], v[164:167], v[76:79]
    s_waitcnt vmcnt(8)
    s_barrier
    ds_read_b64_tr_b16 v[104:105], v132 offset:0
    ds_read_b64_tr_b16 v[106:107], v132 offset:512
    v_mul_f32 v41, s65, v41
    v_mul_f32 v42, s65, v42
    v_mul_f32 v43, s65, v43
    v_mul_f32 v44, s65, v44
    v_mul_f32 v45, s65, v45
    v_mul_f32 v46, s65, v46
    v_mul_f32 v47, s65, v47
    v_cvt_pk_bf16_f32 v136, v32, v33
    s_waitcnt lgkmcnt(4)
    v_mfma_f32_16x16x32_bf16 v[64:67], v[96:99], v[168:171], v[64:67]
    v_mfma_f32_16x16x32_bf16 v[68:71], v[96:99], v[172:175], v[68:71]
    ds_read_b64_tr_b16 v[108:109], v133 offset:0
    ds_read_b64_tr_b16 v[110:111], v133 offset:512
    v_cvt_pk_bf16_f32 v137, v34, v35
    v_cvt_pk_bf16_f32 v138, v36, v37
    v_cvt_pk_bf16_f32 v139, v38, v39
    v_cvt_pk_bf16_f32 v140, v40, v41
    v_cvt_pk_bf16_f32 v141, v42, v43
    v_cvt_pk_bf16_f32 v142, v44, v45
    v_cvt_pk_bf16_f32 v143, v46, v47
    s_add_u32 s59, s62, 4096
    s_waitcnt lgkmcnt(4)
    v_mfma_f32_16x16x32_bf16 v[72:75], v[100:103], v[168:171], v[72:75]
    v_mfma_f32_16x16x32_bf16 v[76:79], v[100:103], v[172:175], v[76:79]
    ds_read_b64_tr_b16 v[112:113], v132 offset:4096
    ds_read_b64_tr_b16 v[114:115], v132 offset:4608
    v_permlane16_swap_b32 v136, v138
    v_permlane16_swap_b32 v137, v139
    v_permlane16_swap_b32 v140, v142
    v_permlane16_swap_b32 v141, v143
    buffer_store_dwordx4 v[136:139], v134, s[28:31], s59 offen offset:0 sc1
    buffer_store_dwordx4 v[140:143], v134, s[28:31], s59 offen offset:1024 sc1
    s_waitcnt lgkmcnt(4)
    v_mfma_f32_16x16x32_bf16 v[64:67], v[104:107], v[176:179], v[64:67]
    v_mfma_f32_16x16x32_bf16 v[68:71], v[104:107], v[180:183], v[68:71]
    ds_read_b64_tr_b16 v[116:117], v133 offset:4096
    ds_read_b64_tr_b16 v[118:119], v133 offset:4608
    s_waitcnt lgkmcnt(4)
    v_mfma_f32_16x16x32_bf16 v[72:75], v[108:111], v[176:179], v[72:75]
    v_mfma_f32_16x16x32_bf16 v[76:79], v[108:111], v[180:183], v[76:79]
    ds_read_b64_tr_b16 v[96:97], v130 offset:0
    ds_read_b64_tr_b16 v[98:99], v130 offset:512
    s_waitcnt lgkmcnt(4)
    v_mfma_f32_16x16x32_bf16 v[64:67], v[112:115], v[184:187], v[64:67]
    v_mfma_f32_16x16x32_bf16 v[68:71], v[112:115], v[188:191], v[68:71]
    ds_read_b64_tr_b16 v[100:101], v131 offset:0
    ds_read_b64_tr_b16 v[102:103], v131 offset:512
    s_waitcnt lgkmcnt(4)
    v_mfma_f32_16x16x32_bf16 v[72:75], v[116:119], v[184:187], v[72:75]
    v_mfma_f32_16x16x32_bf16 v[76:79], v[116:119], v[188:191], v[76:79]
    ds_read_b64_tr_b16 v[104:105], v130 offset:4096
    ds_read_b64_tr_b16 v[106:107], v130 offset:4608
    s_waitcnt lgkmcnt(4)
    v_mfma_f32_16x16x32_bf16 v[64:67], v[96:99], v[192:195], v[64:67]
    v_mfma_f32_16x16x32_bf16 v[68:71], v[96:99], v[196:199], v[68:71]
    ds_read_b64_tr_b16 v[108:109], v131 offset:4096
    ds_read_b64_tr_b16 v[110:111], v131 offset:4608
    s_waitcnt lgkmcnt(4)
    v_mfma_f32_16x16x32_bf16 v[72:75], v[100:103], v[192:195], v[72:75]
    v_mfma_f32_16x16x32_bf16 v[76:79], v[100:103], v[196:199], v[76:79]
    s_waitcnt vmcnt(4)
    s_barrier
    ds_read_b64_tr_b16 v[112:113], v132 offset:16384
    ds_read_b64_tr_b16 v[114:115], v132 offset:16896
    s_waitcnt lgkmcnt(4)
    v_mfma_f32_16x16x32_bf16 v[64:67], v[104:107], v[200:203], v[64:67]
    v_mfma_f32_16x16x32_bf16 v[68:71], v[104:107], v[204:207], v[68:71]
    ds_read_b64_tr_b16 v[116:117], v133 offset:16384
    ds_read_b64_tr_b16 v[118:119], v133 offset:16896
    s_waitcnt lgkmcnt(4)
    v_mfma_f32_16x16x32_bf16 v[72:75], v[108:111], v[200:203], v[72:75]
    v_mfma_f32_16x16x32_bf16 v[76:79], v[108:111], v[204:207], v[76:79]
    ds_read_b64_tr_b16 v[96:97], v132 offset:20480
    ds_read_b64_tr_b16 v[98:99], v132 offset:20992
    s_waitcnt lgkmcnt(4)
    v_mfma_f32_16x16x32_bf16 v[64:67], v[112:115], v[208:211], v[64:67]
    v_mfma_f32_16x16x32_bf16 v[68:71], v[112:115], v[212:215], v[68:71]
    ds_read_b64_tr_b16 v[100:101], v133 offset:20480
    ds_read_b64_tr_b16 v[102:103], v133 offset:20992
    s_waitcnt lgkmcnt(4)
    v_mfma_f32_16x16x32_bf16 v[72:75], v[116:119], v[208:211], v[72:75]
    v_mfma_f32_16x16x32_bf16 v[76:79], v[116:119], v[212:215], v[76:79]
    ds_read_b64_tr_b16 v[104:105], v130 offset:16384
    ds_read_b64_tr_b16 v[106:107], v130 offset:16896
    s_waitcnt lgkmcnt(4)
    v_mfma_f32_16x16x32_bf16 v[64:67], v[96:99], v[216:219], v[64:67]
    v_mfma_f32_16x16x32_bf16 v[68:71], v[96:99], v[220:223], v[68:71]
    ds_read_b64_tr_b16 v[108:109], v131 offset:16384
    ds_read_b64_tr_b16 v[110:111], v131 offset:16896
    s_waitcnt lgkmcnt(4)
    v_mfma_f32_16x16x32_bf16 v[72:75], v[100:103], v[216:219], v[72:75]
    v_mfma_f32_16x16x32_bf16 v[76:79], v[100:103], v[220:223], v[76:79]
    ds_read_b64_tr_b16 v[112:113], v130 offset:20480
    ds_read_b64_tr_b16 v[114:115], v130 offset:20992
    s_waitcnt lgkmcnt(4)
    v_mfma_f32_16x16x32_bf16 v[64:67], v[104:107], v[224:227], v[64:67]
    v_mfma_f32_16x16x32_bf16 v[68:71], v[104:107], v[228:231], v[68:71]
    ds_read_b64_tr_b16 v[116:117], v131 offset:20480
    ds_read_b64_tr_b16 v[118:119], v131 offset:20992
    s_waitcnt lgkmcnt(4)
    v_mfma_f32_16x16x32_bf16 v[72:75], v[108:111], v[224:227], v[72:75]
    v_mfma_f32_16x16x32_bf16 v[76:79], v[108:111], v[228:231], v[76:79]
    ds_read_b64_tr_b16 v[96:97], v132 offset:32768
    ds_read_b64_tr_b16 v[98:99], v132 offset:33280
    s_waitcnt lgkmcnt(4)
    v_mfma_f32_16x16x32_bf16 v[64:67], v[112:115], v[232:235], v[64:67]
    v_mfma_f32_16x16x32_bf16 v[68:71], v[112:115], v[236:239], v[68:71]
    ds_read_b64_tr_b16 v[100:101], v133 offset:32768
    ds_read_b64_tr_b16 v[102:103], v133 offset:33280
    s_waitcnt lgkmcnt(4)
    v_mfma_f32_16x16x32_bf16 v[72:75], v[116:119], v[232:235], v[72:75]
    v_mfma_f32_16x16x32_bf16 v[76:79], v[116:119], v[236:239], v[76:79]
    ds_read_b64_tr_b16 v[104:105], v132 offset:36864
    ds_read_b64_tr_b16 v[106:107], v132 offset:37376
    s_waitcnt lgkmcnt(4)
    v_mfma_f32_16x16x32_bf16 v[64:67], v[96:99], v[240:243], v[64:67]
    v_mfma_f32_16x16x32_bf16 v[68:71], v[96:99], v[244:247], v[68:71]
    ds_read_b64_tr_b16 v[108:109], v133 offset:36864
    ds_read_b64_tr_b16 v[110:111], v133 offset:37376
    s_waitcnt lgkmcnt(4)
    v_mfma_f32_16x16x32_bf16 v[72:75], v[100:103], v[240:243], v[72:75]
    v_mfma_f32_16x16x32_bf16 v[76:79], v[100:103], v[244:247], v[76:79]
    ds_read_b64_tr_b16 v[112:113], v132 offset:57344
    ds_read_b64_tr_b16 v[114:115], v132 offset:57856
    s_waitcnt lgkmcnt(4)
    v_mfma_f32_16x16x32_bf16 v[64:67], v[104:107], v[248:251], v[64:67]
    v_mfma_f32_16x16x32_bf16 v[68:71], v[104:107], v[252:255], v[68:71]
    ds_read_b64_tr_b16 v[116:117], v133 offset:57344
    ds_read_b64_tr_b16 v[118:119], v133 offset:57856
    s_waitcnt lgkmcnt(4)
    v_mfma_f32_16x16x32_bf16 v[72:75], v[108:111], v[248:251], v[72:75]
    v_mfma_f32_16x16x32_bf16 v[76:79], v[108:111], v[252:255], v[76:79]
    ds_read_b64_tr_b16 v[96:97], v132 offset:61440
    ds_read_b64_tr_b16 v[98:99], v132 offset:61952
    s_bitcmp0_b32 s53, 0
    s_cbranch_scc1 gated_mix__mha_block__glu_gated_geglu__prompt_kernel_idle27
    s_waitcnt lgkmcnt(4)
    v_mfma_f32_16x16x32_bf16 v[16:19], v[112:115], v[144:147], 0
    v_mfma_f32_16x16x32_bf16 v[20:23], v[112:115], v[148:151], 0
    ds_read_b64_tr_b16 v[100:101], v133 offset:61440
    ds_read_b64_tr_b16 v[102:103], v133 offset:61952
    s_waitcnt lgkmcnt(4)
    v_mfma_f32_16x16x32_bf16 v[24:27], v[116:119], v[144:147], 0
    v_mfma_f32_16x16x32_bf16 v[28:31], v[116:119], v[148:151], 0
    ds_read_b64_tr_b16 v[104:105], v130 offset:57344
    ds_read_b64_tr_b16 v[106:107], v130 offset:57856
    v_mul_f32 v64, s65, v64
    v_mul_f32 v65, s65, v65
    v_mul_f32 v66, s65, v66
    v_mul_f32 v67, s65, v67
    v_mul_f32 v68, s65, v68
    v_mul_f32 v69, s65, v69
    s_waitcnt lgkmcnt(4)
    v_mfma_f32_16x16x32_bf16 v[16:19], v[96:99], v[152:155], v[16:19]
    v_mfma_f32_16x16x32_bf16 v[20:23], v[96:99], v[156:159], v[20:23]
    ds_read_b64_tr_b16 v[108:109], v131 offset:57344
    ds_read_b64_tr_b16 v[110:111], v131 offset:57856
    v_mul_f32 v70, s65, v70
    v_mul_f32 v71, s65, v71
    v_mul_f32 v72, s65, v72
    v_mul_f32 v73, s65, v73
    v_mul_f32 v74, s65, v74
    v_mul_f32 v75, s65, v75
    s_waitcnt lgkmcnt(4)
    v_mfma_f32_16x16x32_bf16 v[24:27], v[100:103], v[152:155], v[24:27]
    v_mfma_f32_16x16x32_bf16 v[28:31], v[100:103], v[156:159], v[28:31]
    ds_read_b64_tr_b16 v[112:113], v130 offset:61440
    ds_read_b64_tr_b16 v[114:115], v130 offset:61952
    v_mul_f32 v76, s65, v76
    v_mul_f32 v77, s65, v77
    v_mul_f32 v78, s65, v78
    v_mul_f32 v79, s65, v79
    v_cvt_pk_bf16_f32 v136, v64, v65
    v_cvt_pk_bf16_f32 v137, v66, v67
    s_waitcnt lgkmcnt(4)
    v_mfma_f32_16x16x32_bf16 v[16:19], v[104:107], v[160:163], v[16:19]
    v_mfma_f32_16x16x32_bf16 v[20:23], v[104:107], v[164:167], v[20:23]
    ds_read_b64_tr_b16 v[116:117], v131 offset:61440
    ds_read_b64_tr_b16 v[118:119], v131 offset:61952
    v_cvt_pk_bf16_f32 v138, v68, v69
    v_cvt_pk_bf16_f32 v139, v70, v71
    v_cvt_pk_bf16_f32 v140, v72, v73
    v_cvt_pk_bf16_f32 v141, v74, v75
    v_cvt_pk_bf16_f32 v142, v76, v77
    v_cvt_pk_bf16_f32 v143, v78, v79
    s_waitcnt lgkmcnt(4)
    v_mfma_f32_16x16x32_bf16 v[24:27], v[108:111], v[160:163], v[24:27]
    v_mfma_f32_16x16x32_bf16 v[28:31], v[108:111], v[164:167], v[28:31]
    ds_read_b64_tr_b16 v[96:97], v132 offset:8192
    ds_read_b64_tr_b16 v[98:99], v132 offset:8704
    s_add_u32 s59, s62, 8192
    v_permlane16_swap_b32 v136, v138
    v_permlane16_swap_b32 v137, v139
    v_permlane16_swap_b32 v140, v142
    v_permlane16_swap_b32 v141, v143
    buffer_store_dwordx4 v[136:139], v134, s[28:31], s59 offen offset:0 sc1
    s_waitcnt lgkmcnt(4)
    v_mfma_f32_16x16x32_bf16 v[16:19], v[112:115], v[168:171], v[16:19]
    v_mfma_f32_16x16x32_bf16 v[20:23], v[112:115], v[172:175], v[20:23]
    ds_read_b64_tr_b16 v[100:101], v133 offset:8192
    ds_read_b64_tr_b16 v[102:103], v133 offset:8704
    buffer_store_dwordx4 v[140:143], v134, s[28:31], s59 offen offset:1024 sc1
    s_waitcnt lgkmcnt(4)
    v_mfma_f32_16x16x32_bf16 v[24:27], v[116:119], v[168:171], v[24:27]
    v_mfma_f32_16x16x32_bf16 v[28:31], v[116:119], v[172:175], v[28:31]
    ds_read_b64_tr_b16 v[104:105], v132 offset:12288
    ds_read_b64_tr_b16 v[106:107], v132 offset:12800
    s_waitcnt lgkmcnt(4)
    v_mfma_f32_16x16x32_bf16 v[16:19], v[96:99], v[176:179], v[16:19]
    v_mfma_f32_16x16x32_bf16 v[20:23], v[96:99], v[180:183], v[20:23]
    ds_read_b64_tr_b16 v[108:109], v133 offset:12288
    ds_read_b64_tr_b16 v[110:111], v133 offset:12800
    s_waitcnt lgkmcnt(4)
    v_mfma_f32_16x16x32_bf16 v[24:27], v[100:103], v[176:179], v[24:27]
    v_mfma_f32_16x16x32_bf16 v[28:31], v[100:103], v[180:183], v[28:31]
    ds_read_b64_tr_b16 v[112:113], v130 offset:8192
    ds_read_b64_tr_b16 v[114:115], v130 offset:8704
    s_waitcnt lgkmcnt(4)
    v_mfma_f32_16x16x32_bf16 v[16:19], v[104:107], v[184:187], v[16:19]
    v_mfma_f32_16x16x32_bf16 v[20:23], v[104:107], v[188:191], v[20:23]
    ds_read_b64_tr_b16 v[116:117], v131 offset:8192
    ds_read_b64_tr_b16 v[118:119], v131 offset:8704
    s_waitcnt lgkmcnt(4)
    v_mfma_f32_16x16x32_bf16 v[24:27], v[108:111], v[184:187], v[24:27]
    v_mfma_f32_16x16x32_bf16 v[28:31], v[108:111], v[188:191], v[28:31]
    ds_read_b64_tr_b16 v[96:97], v130 offset:12288
    ds_read_b64_tr_b16 v[98:99], v130 offset:12800
    s_waitcnt lgkmcnt(4)
    v_mfma_f32_16x16x32_bf16 v[16:19], v[112:115], v[192:195], v[16:19]
    v_mfma_f32_16x16x32_bf16 v[20:23], v[112:115], v[196:199], v[20:23]
    ds_read_b64_tr_b16 v[100:101], v131 offset:12288
    ds_read_b64_tr_b16 v[102:103], v131 offset:12800
    s_waitcnt lgkmcnt(4)
    v_mfma_f32_16x16x32_bf16 v[24:27], v[116:119], v[192:195], v[24:27]
    v_mfma_f32_16x16x32_bf16 v[28:31], v[116:119], v[196:199], v[28:31]
    ds_read_b64_tr_b16 v[104:105], v132 offset:24576
    ds_read_b64_tr_b16 v[106:107], v132 offset:25088
    s_waitcnt lgkmcnt(4)
    v_mfma_f32_16x16x32_bf16 v[16:19], v[96:99], v[200:203], v[16:19]
    v_mfma_f32_16x16x32_bf16 v[20:23], v[96:99], v[204:207], v[20:23]
    ds_read_b64_tr_b16 v[108:109], v133 offset:24576
    ds_read_b64_tr_b16 v[110:111], v133 offset:25088
    s_waitcnt lgkmcnt(4)
    v_mfma_f32_16x16x32_bf16 v[24:27], v[100:103], v[200:203], v[24:27]
    v_mfma_f32_16x16x32_bf16 v[28:31], v[100:103], v[204:207], v[28:31]
    ds_read_b64_tr_b16 v[112:113], v132 offset:28672
    ds_read_b64_tr_b16 v[114:115], v132 offset:29184
    s_waitcnt lgkmcnt(4)
    v_mfma_f32_16x16x32_bf16 v[16:19], v[104:107], v[208:211], v[16:19]
    v_mfma_f32_16x16x32_bf16 v[20:23], v[104:107], v[212:215], v[20:23]
    ds_read_b64_tr_b16 v[116:117], v133 offset:28672
    ds_read_b64_tr_b16 v[118:119], v133 offset:29184
    s_waitcnt lgkmcnt(4)
    v_mfma_f32_16x16x32_bf16 v[24:27], v[108:111], v[208:211], v[24:27]
    v_mfma_f32_16x16x32_bf16 v[28:31], v[108:111], v[212:215], v[28:31]
    ds_read_b64_tr_b16 v[96:97], v130 offset:24576
    ds_read_b64_tr_b16 v[98:99], v130 offset:25088
    s_waitcnt lgkmcnt(4)
    v_mfma_f32_16x16x32_bf16 v[16:19], v[112:115], v[216:219], v[16:19]
    v_mfma_f32_16x16x32_bf16 v[20:23], v[112:115], v[220:223], v[20:23]
    ds_read_b64_tr_b16 v[100:101], v131 offset:24576
    ds_read_b64_tr_b16 v[102:103], v131 offset:25088
    s_waitcnt lgkmcnt(4)
    v_mfma_f32_16x16x32_bf16 v[24:27], v[116:119], v[216:219], v[24:27]
    v_mfma_f32_16x16x32_bf16 v[28:31], v[116:119], v[220:223], v[28:31]
    ds_read_b64_tr_b16 v[104:105], v130 offset:28672
    ds_read_b64_tr_b16 v[106:107], v130 offset:29184
    s_waitcnt lgkmcnt(4)
    v_mfma_f32_16x16x32_bf16 v[16:19], v[96:99], v[224:227], v[16:19]
    v_mfma_f32_16x16x32_bf16 v[20:23], v[96:99], v[228:231], v[20:23]
    ds_read_b64_tr_b16 v[108:109], v131 offset:28672
    ds_read_b64_tr_b16 v[110:111], v131 offset:29184
    s_waitcnt lgkmcnt(4)
    v_mfma_f32_16x16x32_bf16 v[24:27], v[100:103], v[224:227], v[24:27]
    v_mfma_f32_16x16x32_bf16 v[28:31], v[100:103], v[228:231], v[28:31]
    ds_read_b64_tr_b16 v[112:113], v132 offset:40960
    ds_read_b64_tr_b16 v[114:115], v132 offset:41472
    s_waitcnt lgkmcnt(4)
    v_mfma_f32_16x16x32_bf16 v[16:19], v[104:107], v[232:235], v[16:19]
    v_mfma_f32_16x16x32_bf16 v[20:23], v[104:107], v[236:239], v[20:23]
    ds_read_b64_tr_b16 v[116:117], v133 offset:40960
    ds_read_b64_tr_b16 v[118:119], v133 offset:41472
    s_waitcnt lgkmcnt(4)
    v_mfma_f32_16x16x32_bf16 v[24:27], v[108:111], v[232:235], v[24:27]
    v_mfma_f32_16x16x32_bf16 v[28:31], v[108:111], v[236:239], v[28:31]
    ds_read_b64_tr_b16 v[96:97], v132 offset:45056
    ds_read_b64_tr_b16 v[98:99], v132 offset:45568
    s_waitcnt lgkmcnt(4)
    v_mfma_f32_16x16x32_bf16 v[16:19], v[112:115], v[240:243], v[16:19]
    v_mfma_f32_16x16x32_bf16 v[20:23], v[112:115], v[244:247], v[20:23]
    ds_read_b64_tr_b16 v[100:101], v133 offset:45056
    ds_read_b64_tr_b16 v[102:103], v133 offset:45568
    s_waitcnt lgkmcnt(4)
    v_mfma_f32_16x16x32_bf16 v[24:27], v[116:119], v[240:243], v[24:27]
    v_mfma_f32_16x16x32_bf16 v[28:31], v[116:119], v[244:247], v[28:31]
    s_waitcnt lgkmcnt(2)
    v_mfma_f32_16x16x32_bf16 v[16:19], v[96:99], v[248:251], v[16:19]
    v_mfma_f32_16x16x32_bf16 v[20:23], v[96:99], v[252:255], v[20:23]
    s_waitcnt lgkmcnt(0)
    v_mfma_f32_16x16x32_bf16 v[24:27], v[100:103], v[248:251], v[24:27]
    v_mfma_f32_16x16x32_bf16 v[28:31], v[100:103], v[252:255], v[28:31]
    s_nop 3
    v_mul_f32 v16, s65, v16
    v_mul_f32 v17, s65, v17
    v_mul_f32 v18, s65, v18
    v_mul_f32 v19, s65, v19
    v_mul_f32 v20, s65, v20
    v_mul_f32 v21, s65, v21
    v_mul_f32 v22, s65, v22
    v_mul_f32 v23, s65, v23
    v_mul_f32 v24, s65, v24
    v_mul_f32 v25, s65, v25
    v_mul_f32 v26, s65, v26
    v_mul_f32 v27, s65, v27
    v_mul_f32 v28, s65, v28
    v_mul_f32 v29, s65, v29
    v_mul_f32 v30, s65, v30
    v_mul_f32 v31, s65, v31
    v_cvt_pk_bf16_f32 v136, v16, v17
    v_cvt_pk_bf16_f32 v137, v18, v19
    v_cvt_pk_bf16_f32 v138, v20, v21
    v_cvt_pk_bf16_f32 v139, v22, v23
    v_cvt_pk_bf16_f32 v140, v24, v25
    v_cvt_pk_bf16_f32 v141, v26, v27
    v_cvt_pk_bf16_f32 v142, v28, v29
    v_cvt_pk_bf16_f32 v143, v30, v31
    s_add_u32 s59, s63, 12288
    v_permlane16_swap_b32 v136, v138
    v_permlane16_swap_b32 v137, v139
    v_permlane16_swap_b32 v140, v142
    v_permlane16_swap_b32 v141, v143
    buffer_store_dwordx4 v[136:139], v134, s[28:31], s59 offen offset:0 sc1
    buffer_store_dwordx4 v[140:143], v134, s[28:31], s59 offen offset:1024 sc1
    s_branch gated_mix__mha_block__glu_gated_geglu__prompt_kernel_fin28
gated_mix__mha_block__glu_gated_geglu__prompt_kernel_idle27:
    v_mul_f32 v64, s65, v64
    v_mul_f32 v65, s65, v65
    v_mul_f32 v66, s65, v66
    v_mul_f32 v67, s65, v67
    v_mul_f32 v68, s65, v68
    v_mul_f32 v69, s65, v69
    v_mul_f32 v70, s65, v70
    v_mul_f32 v71, s65, v71
    v_mul_f32 v72, s65, v72
    v_mul_f32 v73, s65, v73
    v_mul_f32 v74, s65, v74
    v_mul_f32 v75, s65, v75
    v_mul_f32 v76, s65, v76
    v_mul_f32 v77, s65, v77
    v_mul_f32 v78, s65, v78
    v_mul_f32 v79, s65, v79
    v_cvt_pk_bf16_f32 v136, v64, v65
    v_cvt_pk_bf16_f32 v137, v66, v67
    v_cvt_pk_bf16_f32 v138, v68, v69
    v_cvt_pk_bf16_f32 v139, v70, v71
    v_cvt_pk_bf16_f32 v140, v72, v73
    v_cvt_pk_bf16_f32 v141, v74, v75
    v_cvt_pk_bf16_f32 v142, v76, v77
    v_cvt_pk_bf16_f32 v143, v78, v79
    s_add_u32 s59, s62, 8192
    v_permlane16_swap_b32 v136, v138
    v_permlane16_swap_b32 v137, v139
    v_permlane16_swap_b32 v140, v142
    v_permlane16_swap_b32 v141, v143
    buffer_store_dwordx4 v[136:139], v134, s[28:31], s59 offen offset:0 sc1
    buffer_store_dwordx4 v[140:143], v134, s[28:31], s59 offen offset:1024 sc1
gated_mix__mha_block__glu_gated_geglu__prompt_kernel_fin28:
    s_waitcnt vmcnt(0) lgkmcnt(0)
    s_barrier
    s_lshl_b32 s3, s26, 9
    s_add_u32 s3, s3, 155648
    v_lshl_add_u32 v8, v0, 3, s3
    v_mov_b64 v[6:7], 0
    ds_write_b64 v8, v[6:7]
    ds_write_b64 v8, v[6:7] offset:4096
    s_waitcnt lgkmcnt(0)
    s_barrier
    s_branch gated_mix__mha_block__glu_gated_geglu__prompt_kernel_g_plain
gated_mix__mha_block__glu_gated_geglu__prompt_kernel_a_plain:
    v_and_b32 v8, 3, v0
    v_lshlrev_b32 v8, 6, v8
    buffer_load_dword v7, v8, s[48:51], 0 offen sc1
    v_add_u32 v144, 28672, v134
    v_add_u32 v145, 57344, v134
    v_add_u32 v146, 86016, v134
    v_add_u32 v147, 14336, v10
    v_add_u32 v148, 28672, v10
    v_add_u32 v149, 43008, v10
    v_add_u32 v150, 57344, v10
    v_add_u32 v151, 71680, v10
    v_add_u32 v152, 86016, v10
    v_add_u32 v153, 100352, v10
    s_add_u32 s0, s70, 1
    s_and_b32 s0, s0, 3
    s_mul_i32 s0, s0, 12288
    s_add_u32 s0, s0, 106496
    v_add_u32 v154, s0, v134
    s_add_u32 s0, s70, 2
    s_and_b32 s0, s0, 3
    s_mul_i32 s0, s0, 12288
    s_add_u32 s0, s0, 110592
    v_add_u32 v155, s0, v134
    s_add_u32 s0, s70, 3
    s_and_b32 s0, s0, 3
    s_mul_i32 s0, s0, 12288
    s_add_u32 s0, s0, 114688
    v_add_u32 v156, s0, v134
    s_add_u32 s0, s70, 4
    s_and_b32 s0, s0, 3
    s_mul_i32 s0, s0, 12288
    s_add_u32 s0, s0, 106496
    v_add_u32 v157, s0, v134
    s_lshl_b32 s0, s70, 8
    s_add_u32 s0, s0, 157696
    v_lshl_add_u32 v158, v0, 2, s0
    v_and_b32 v159, 3, v0
    v_lshlrev_b32 v159, 8, v159
    v_add_u32 v159, 157696, v159
    s_and_b32 s0, s66, 1
    v_lshrrev_b32 v120, 5, v0
    v_or_b32 v121, s0, v120
    v_xor_b32 v121, s0, v121
    v_add_u32 v121, -1, v121
    v_xor_b32 v120, 1, v120
    v_and_b32 v120, s0, v120
    v_add_u32 v120, -1, v120
    v_and_b32 v122, 31, v0
    v_lshlrev_b32 v122, 2, v122
    v_and_b32 v13, 31, v0
    v_cmp_eq_u32 s[0:1], 28, v13
    v_mov_b32 v13, 0x3f803f80
    s_nop 0
    v_cndmask_b32 v13, 0, v13, s[0:1]
    v_mov_b32 v160, v13
    v_mov_b32 v161, v13
    v_mov_b32 v162, v13
    v_mov_b32 v163, v13
    v_mov_b32 v164, v13
    v_mov_b32 v165, v13
    v_mov_b32 v166, v13
    v_mov_b32 v167, v13
    v_mov_b32 v168, v13
    v_mov_b32 v169, v13
    v_mov_b32 v170, v13
    v_mov_b32 v171, v13
    v_mov_b32 v172, v13
    v_mov_b32 v173, v13
    v_mov_b32 v174, v13
    v_mov_b32 v175, v13
    v_mov_b32 v176, v13
    v_mov_b32 v177, v13
    v_mov_b32 v178, v13
    v_mov_b32 v179, v13
    v_mov_b32 v180, v13
    v_mov_b32 v181, v13
    v_mov_b32 v182, v13
    v_mov_b32 v183, v13
    v_mov_b32 v184, v13
    v_mov_b32 v185, v13
    v_mov_b32 v186, v13
    v_mov_b32 v187, v13
    v_mov_b32 v188, v13
    v_mov_b32 v189, v13
    v_mov_b32 v190, v13
    v_mov_b32 v191, v13
    s_waitcnt vmcnt(0)
    v_cmp_gt_u32 vcc, 64, v7
    s_nop 0
    s_cbranch_vccz gated_mix__mha_block__glu_gated_geglu__prompt_kernel_ok29
    s_mov_b32 s3, 131072
gated_mix__mha_block__glu_gated_geglu__prompt_kernel_again30:
    buffer_load_dword v7, v8, s[48:51], 0 offen sc1
    s_waitcnt vmcnt(0)
    v_cmp_gt_u32 vcc, 64, v7
    s_nop 0
    s_cbranch_vccz gated_mix__mha_block__glu_gated_geglu__prompt_kernel_ok29
    s_sub_u32 s3, s3, 1
    s_cbranch_scc0 gated_mix__mha_block__glu_gated_geglu__prompt_kernel_again30
gated_mix__mha_block__glu_gated_geglu__prompt_kernel_ok29:
    s_branch gated_mix__mha_block__glu_gated_geglu__prompt_kernel_a_poll
gated_mix__mha_block__glu_gated_geglu__prompt_kernel_a_late:
    s_mov_b64 exec, 0x1ffff
    buffer_load_dword v6, v12, s[28:31], 0 offen sc1
    s_mov_b64 exec, -1
    v_mul_f32 v1, v64, v64
    v_mul_f32 v2, v65, v65
    v_mul_f32 v3, v66, v66
    v_mul_f32 v4, v67, v67
    v_fmamk_f32 v1, v1, 0xbdd2d3e8, v15
    v_fmamk_f32 v2, v2, 0xbdd2d3e8, v15
    v_fmamk_f32 v3, v3, 0xbdd2d3e8, v15
    v_fmamk_f32 v4, v4, 0xbdd2d3e8, v15
    v_mul_f32 v1, v1, v64
    v_mul_f32 v2, v2, v65
    v_mul_f32 v3, v3, v66
    v_mul_f32 v4, v4, v67
    v_exp_f32 v1, v1
    v_exp_f32 v2, v2
    v_exp_f32 v3, v3
    v_exp_f32 v4, v4
    v_mul_f32 v72, v64, v72
    v_mul_f32 v73, v65, v73
    v_mul_f32 v74, v66, v74
    v_mul_f32 v75, v67, v75
    v_add_f32 v1, 1.0, v1
    v_add_f32 v2, 1.0, v2
    v_add_f32 v3, 1.0, v3
    v_add_f32 v4, 1.0, v4
    v_rcp_f32 v1, v1
    v_rcp_f32 v2, v2
    v_rcp_f32 v3, v3
    v_rcp_f32 v4, v4
    v_mul_f32 v72, v72, v1
    v_mul_f32 v73, v73, v2
    v_mul_f32 v74, v74, v3
    v_mul_f32 v75, v75, v4
    v_cvt_pk_bf16_f32 v136, v72, v73
    v_cvt_pk_bf16_f32 v137, v74, v75
    v_mul_f32 v1, v68, v68
    v_mul_f32 v2, v69, v69
    v_mul_f32 v3, v70, v70
    v_mul_f32 v4, v71, v71
    v_fmamk_f32 v1, v1, 0xbdd2d3e8, v15
    v_fmamk_f32 v2, v2, 0xbdd2d3e8, v15
    v_fmamk_f32 v3, v3, 0xbdd2d3e8, v15
    v_fmamk_f32 v4, v4, 0xbdd2d3e8, v15
    v_mul_f32 v1, v1, v68
    v_mul_f32 v2, v2, v69
    v_mul_f32 v3, v3, v70
    v_mul_f32 v4, v4, v71
    v_exp_f32 v1, v1
    v_exp_f32 v2, v2
    v_exp_f32 v3, v3
    v_exp_f32 v4, v4
    v_mul_f32 v76, v68, v76
    v_mul_f32 v77, v69, v77
    v_mul_f32 v78, v70, v78
    v_mul_f32 v79, v71, v79
    v_add_f32 v1, 1.0, v1
    v_add_f32 v2, 1.0, v2
    v_add_f32 v3, 1.0, v3
    v_add_f32 v4, 1.0, v4
    v_rcp_f32 v1, v1
    v_rcp_f32 v2, v2
    v_rcp_f32 v3, v3
    v_rcp_f32 v4, v4
    v_mul_f32 v76, v76, v1
    v_mul_f32 v77, v77, v2
    v_mul_f32 v78, v78, v3
    v_mul_f32 v79, v79, v4
    v_cvt_pk_bf16_f32 v138, v76, v77
    v_cvt_pk_bf16_f32 v139, v78, v79
    s_nop 0
    v_permlane16_swap_b32 v136, v138
    v_permlane16_swap_b32 v137, v139
    s_waitcnt vmcnt(0)
    s_mov_b64 exec, 0x1ffff
    v_cmp_eq_u32 vcc, 0, v6
    s_mov_b64 exec, -1
    s_cbranch_vccz gated_mix__mha_block__glu_gated_geglu__prompt_kernel_a_mid
    v_mul_f32 v1, v80, v80
    v_mul_f32 v2, v81, v81
    v_mul_f32 v3, v82, v82
    v_mul_f32 v4, v83, v83
    v_fmamk_f32 v1, v1, 0xbdd2d3e8, v15
    v_fmamk_f32 v2, v2, 0xbdd2d3e8, v15
    v_fmamk_f32 v3, v3, 0xbdd2d3e8, v15
    v_fmamk_f32 v4, v4, 0xbdd2d3e8, v15
    v_mul_f32 v1, v1, v80
    v_mul_f32 v2, v2, v81
    v_mul_f32 v3, v3, v82
    v_mul_f32 v4, v4, v83
    v_exp_f32 v1, v1
    v_exp_f32 v2, v2
    v_exp_f32 v3, v3
    v_exp_f32 v4, v4
    v_mul_f32 v88, v80, v88
    v_mul_f32 v89, v81, v89
    v_mul_f32 v90, v82, v90
    v_mul_f32 v91, v83, v91
    v_add_f32 v1, 1.0, v1
    v_add_f32 v2, 1.0, v2
    v_add_f32 v3, 1.0, v3
    v_add_f32 v4, 1.0, v4
    v_rcp_f32 v1, v1
    v_rcp_f32 v2, v2
    v_rcp_f32 v3, v3
    v_rcp_f32 v4, v4
    v_mul_f32 v88, v88, v1
    v_mul_f32 v89, v89, v2
    v_mul_f32 v90, v90, v3
    v_mul_f32 v91, v91, v4
    v_cvt_pk_bf16_f32 v140, v88, v89
    v_cvt_pk_bf16_f32 v141, v90, v91
    v_mul_f32 v1, v84, v84
    v_mul_f32 v2, v85, v85
    v_mul_f32 v3, v86, v86
    v_mul_f32 v4, v87, v87
    v_fmamk_f32 v1, v1, 0xbdd2d3e8, v15
    v_fmamk_f32 v2, v2, 0xbdd2d3e8, v15
    v_fmamk_f32 v3, v3, 0xbdd2d3e8, v15
    v_fmamk_f32 v4, v4, 0xbdd2d3e8, v15
    v_mul_f32 v1, v1, v84
    v_mul_f32 v2, v2, v85
    v_mul_f32 v3, v3, v86
    v_mul_f32 v4, v4, v87
    v_exp_f32 v1, v1
    v_exp_f32 v2, v2
    v_exp_f32 v3, v3
    v_exp_f32 v4, v4
    v_mul_f32 v92, v84, v92
    v_mul_f32 v93, v85, v93
    v_mul_f32 v94, v86, v94
    v_mul_f32 v95, v87, v95
    v_add_f32 v1, 1.0, v1
    v_add_f32 v2, 1.0, v2
    v_add_f32 v3, 1.0, v3
    v_add_f32 v4, 1.0, v4
    v_rcp_f32 v1, v1
    v_rcp_f32 v2, v2
    v_rcp_f32 v3, v3
    v_rcp_f32 v4, v4
    v_mul_f32 v92, v92, v1
    v_mul_f32 v93, v93, v2
    v_mul_f32 v94, v94, v3
    v_mul_f32 v95, v95, v4
    v_cvt_pk_bf16_f32 v142, v92, v93
    v_cvt_pk_bf16_f32 v143, v94, v95
    s_nop 0
    v_permlane16_swap_b32 v140, v142
    v_permlane16_swap_b32 v141, v143
    s_add_u32 s59, s63, 4096
    buffer_store_dwordx4 v[136:139], v134, s[28:31], s59 offen sc1
    s_add_u32 s59, s63, 5120
    buffer_store_dwordx4 v[140:143], v134, s[28:31], s59 offen sc1
gated_mix__mha_block__glu_gated_geglu__prompt_kernel_a_poll:
    s_mov_b64 exec, 0x1ffff
    buffer_load_dword v6, v12, s[28:31], 0 offen sc1
    s_mov_b64 exec, -1
    s_waitcnt vmcnt(0)
    s_mov_b64 exec, 0x1ffff
    v_cmp_eq_u32 vcc, 0, v6
    s_nop 0
    s_cbranch_vccz gated_mix__mha_block__glu_gated_geglu__prompt_kernel_ok31
    s_mov_b32 s3, 131072
gated_mix__mha_block__glu_gated_geglu__prompt_kernel_again32:
    buffer_load_dword v6, v12, s[28:31], 0 offen sc1
    s_waitcnt vmcnt(0)
    v_cmp_eq_u32 vcc, 0, v6
    s_nop 0
    s_cbranch_vccz gated_mix__mha_block__glu_gated_geglu__prompt_kernel_ok31
    s_sub_u32 s3, s3, 1
    s_cbranch_scc0 gated_mix__mha_block__glu_gated_geglu__prompt_kernel_again32
gated_mix__mha_block__glu_gated_geglu__prompt_kernel_ok31:
    s_mov_b64 exec, -1
    s_mov_b32 s60, 0
    buffer_load_dwordx4 v[224:227], v134, s[28:31], s80 offen sc1
    buffer_load_dwordx4 v[228:231], v134, s[28:31], s80 offen offset:1024 sc1
    buffer_load_dwordx4 v[192:195], v134, s[72:75], s60 offen sc1
    buffer_load_dwordx4 v[196:199], v134, s[72:75], s60 offen offset:1024 sc1
    buffer_load_dwordx4 v[232:235], v134, s[28:31], s81 offen sc1
    buffer_load_dwordx4 v[236:239], v134, s[28:31], s81 offen offset:1024 sc1
    s_mov_b64 exec, s[84:85]
    buffer_load_dwordx4 v[160:163], v10, s[76:79], s60 offen sc1
    buffer_load_dwordx4 v[164:167], v147, s[76:79], s60 offen sc1
    s_mov_b64 exec, -1
    buffer_load_dwordx4 v[240:243], v134, s[28:31], s82 offen sc1
    buffer_load_dwordx4 v[244:247], v134, s[28:31], s82 offen offset:1024 sc1
    buffer_load_dwordx4 v[248:251], v134, s[28:31], s83 offen sc1
    buffer_load_dwordx4 v[252:255], v134, s[28:31], s83 offen offset:1024 sc1
    buffer_load_dwordx4 v[200:203], v144, s[72:75], s60 offen sc1
    buffer_load_dwordx4 v[204:207], v144, s[72:75], s60 offen offset:1024 sc1
    buffer_load_dword v11, v122, s[28:31], s61 offen sc1
    ds_write_b32 v14, v14
    s_branch gated_mix__mha_block__glu_gated_geglu__prompt_kernel_a_go
gated_mix__mha_block__glu_gated_geglu__prompt_kernel_a_mid:
    s_mov_b32 s60, 0
    buffer_load_dwordx4 v[224:227], v134, s[28:31], s80 offen sc1
    v_mul_f32 v1, v80, v80
    v_mul_f32 v2, v81, v81
    v_mul_f32 v3, v82, v82
    v_mul_f32 v4, v83, v83
    buffer_load_dwordx4 v[228:231], v134, s[28:31], s80 offen offset:1024 sc1
    v_fmamk_f32 v1, v1, 0xbdd2d3e8, v15
    v_fmamk_f32 v2, v2, 0xbdd2d3e8, v15
    v_fmamk_f32 v3, v3, 0xbdd2d3e8, v15
    v_fmamk_f32 v4, v4, 0xbdd2d3e8, v15
    buffer_load_dwordx4 v[192:195], v134, s[72:75], s60 offen sc1
    v_mul_f32 v1, v1, v80
    v_mul_f32 v2, v2, v81
    v_mul_f32 v3, v3, v82
    v_mul_f32 v4, v4, v83
    buffer_load_dwordx4 v[196:199], v134, s[72:75], s60 offen offset:1024 sc1
    v_exp_f32 v1, v1
    v_exp_f32 v2, v2
    v_exp_f32 v3, v3
    v_exp_f32 v4, v4
    buffer_load_dwordx4 v[232:235], v134, s[28:31], s81 offen sc1
    v_mul_f32 v88, v80, v88
    v_mul_f32 v89, v81, v89
    v_mul_f32 v90, v82, v90
    v_mul_f32 v91, v83, v91
    buffer_load_dwordx4 v[236:239], v134, s[28:31], s81 offen offset:1024 sc1
    v_add_f32 v1, 1.0, v1
    v_add_f32 v2, 1.0, v2
    v_add_f32 v3, 1.0, v3
    v_add_f32 v4, 1.0, v4
    s_mov_b64 exec, s[84:85]
    buffer_load_dwordx4 v[160:163], v10, s[76:79], s60 offen sc1
    buffer_load_dwordx4 v[164:167], v147, s[76:79], s60 offen sc1
    s_mov_b64 exec, -1
    v_rcp_f32 v1, v1
    v_rcp_f32 v2, v2
    v_rcp_f32 v3, v3
    v_rcp_f32 v4, v4
    buffer_load_dwordx4 v[240:243], v134, s[28:31], s82 offen sc1
    v_mul_f32 v88, v88, v1
    v_mul_f32 v89, v89, v2
    v_mul_f32 v90, v90, v3
    v_mul_f32 v91, v91, v4
    buffer_load_dwordx4 v[244:247], v134, s[28:31], s82 offen offset:1024 sc1
    v_cvt_pk_bf16_f32 v140, v88, v89
    v_cvt_pk_bf16_f32 v141, v90, v91
    v_mul_f32 v1, v84, v84
    v_mul_f32 v2, v85, v85
    buffer_load_dwordx4 v[248:251], v134, s[28:31], s83 offen sc1
    v_mul_f32 v3, v86, v86
    v_mul_f32 v4, v87, v87
    v_fmamk_f32 v1, v1, 0xbdd2d3e8, v15
    v_fmamk_f32 v2, v2, 0xbdd2d3e8, v15
    buffer_load_dwordx4 v[252:255], v134, s[28:31], s83 offen offset:1024 sc1
    v_fmamk_f32 v3, v3, 0xbdd2d3e8, v15
    v_fmamk_f32 v4, v4, 0xbdd2d3e8, v15
    v_mul_f32 v1, v1, v84
    v_mul_f32 v2, v2, v85
    buffer_load_dwordx4 v[200:203], v144, s[72:75], s60 offen sc1
    v_mul_f32 v3, v3, v86
    v_mul_f32 v4, v4, v87
    v_exp_f32 v1, v1
    v_exp_f32 v2, v2
    buffer_load_dwordx4 v[204:207], v144, s[72:75], s60 offen offset:1024 sc1
    v_exp_f32 v3, v3
    v_exp_f32 v4, v4
    v_mul_f32 v92, v84, v92
    v_mul_f32 v93, v85, v93
    buffer_load_dword v11, v122, s[28:31], s61 offen sc1
    v_mul_f32 v94, v86, v94
    v_mul_f32 v95, v87, v95
    v_add_f32 v1, 1.0, v1
    v_add_f32 v2, 1.0, v2
    v_add_f32 v3, 1.0, v3
    v_add_f32 v4, 1.0, v4
    v_rcp_f32 v1, v1
    v_rcp_f32 v2, v2
    v_rcp_f32 v3, v3
    v_rcp_f32 v4, v4
    v_mul_f32 v92, v92, v1
    v_mul_f32 v93, v93, v2
    v_mul_f32 v94, v94, v3
    v_mul_f32 v95, v95, v4
    v_cvt_pk_bf16_f32 v142, v92, v93
    v_cvt_pk_bf16_f32 v143, v94, v95
    s_nop 0
    v_permlane16_swap_b32 v140, v142
    v_permlane16_swap_b32 v141, v143
    s_add_u32 s59, s63, 4096
    buffer_store_dwordx4 v[136:139], v134, s[28:31], s59 offen sc1
    s_add_u32 s59, s63, 5120
    buffer_store_dwordx4 v[140:143], v134, s[28:31], s59 offen sc1
    s_branch gated_mix__mha_block__glu_gated_geglu__prompt_kernel_a_go
gated_mix__mha_block__glu_gated_geglu__prompt_kernel_a_e2:
    s_mov_b64 exec, 0x1ffff
    v_cmp_eq_u32 vcc, 0, v6
    s_mov_b64 exec, -1
    s_cbranch_vccnz gated_mix__mha_block__glu_gated_geglu__prompt_kernel_a_late
    s_mov_b32 s60, 0
    buffer_load_dwordx4 v[224:227], v134, s[28:31], s80 offen sc1
    v_mul_f32 v1, v64, v64
    v_mul_f32 v2, v65, v65
    v_mul_f32 v3, v66, v66
    v_mul_f32 v4, v67, v67
    v_fmamk_f32 v1, v1, 0xbdd2d3e8, v15
    v_fmamk_f32 v2, v2, 0xbdd2d3e8, v15
    buffer_load_dwordx4 v[228:231], v134, s[28:31], s80 offen offset:1024 sc1
    v_fmamk_f32 v3, v3, 0xbdd2d3e8, v15
    v_fmamk_f32 v4, v4, 0xbdd2d3e8, v15
    v_mul_f32 v1, v1, v64
    v_mul_f32 v2, v2, v65
    v_mul_f32 v3, v3, v66
    v_mul_f32 v4, v4, v67
    buffer_load_dwordx4 v[192:195], v134, s[72:75], s60 offen sc1
    v_exp_f32 v1, v1
    v_exp_f32 v2, v2
    v_exp_f32 v3, v3
    v_exp_f32 v4, v4
    v_mul_f32 v72, v64, v72
    v_mul_f32 v73, v65, v73
    buffer_load_dwordx4 v[196:199], v134, s[72:75], s60 offen offset:1024 sc1
    v_mul_f32 v74, v66, v74
    v_mul_f32 v75, v67, v75
    v_add_f32 v1, 1.0, v1
    v_add_f32 v2, 1.0, v2
    v_add_f32 v3, 1.0, v3
    v_add_f32 v4, 1.0, v4
    buffer_load_dwordx4 v[232:235], v134, s[28:31], s81 offen sc1
    v_rcp_f32 v1, v1
    v_rcp_f32 v2, v2
    v_rcp_f32 v3, v3
    v_rcp_f32 v4, v4
    v_mul_f32 v72, v72, v1
    v_mul_f32 v73, v73, v2
    buffer_load_dwordx4 v[236:239], v134, s[28:31], s81 offen offset:1024 sc1
    v_mul_f32 v74, v74, v3
    v_mul_f32 v75, v75, v4
    v_cvt_pk_bf16_f32 v136, v72, v73
    v_cvt_pk_bf16_f32 v137, v74, v75
    v_mul_f32 v1, v68, v68
    v_mul_f32 v2, v69, v69
    s_mov_b64 exec, s[84:85]
    buffer_load_dwordx4 v[160:163], v10, s[76:79], s60 offen sc1
    buffer_load_dwordx4 v[164:167], v147, s[76:79], s60 offen sc1
    s_mov_b64 exec, -1
    v_mul_f32 v3, v70, v70
    v_mul_f32 v4, v71, v71
    v_fmamk_f32 v1, v1, 0xbdd2d3e8, v15
    v_fmamk_f32 v2, v2, 0xbdd2d3e8, v15
    v_fmamk_f32 v3, v3, 0xbdd2d3e8, v15
    v_fmamk_f32 v4, v4, 0xbdd2d3e8, v15
    buffer_load_dwordx4 v[240:243], v134, s[28:31], s82 offen sc1
    v_mul_f32 v1, v1, v68
    v_mul_f32 v2, v2, v69
    v_mul_f32 v3, v3, v70
    v_mul_f32 v4, v4, v71
    v_exp_f32 v1, v1
    v_exp_f32 v2, v2
    buffer_load_dwordx4 v[244:247], v134, s[28:31], s82 offen offset:1024 sc1
    v_exp_f32 v3, v3
    v_exp_f32 v4, v4
    v_mul_f32 v76, v68, v76
    v_mul_f32 v77, v69, v77
    v_mul_f32 v78, v70, v78
    v_mul_f32 v79, v71, v79
    buffer_load_dwordx4 v[248:251], v134, s[28:31], s83 offen sc1
    v_add_f32 v1, 1.0, v1
    v_add_f32 v2, 1.0, v2
    v_add_f32 v3, 1.0, v3
    v_add_f32 v4, 1.0, v4
    v_rcp_f32 v1, v1
    v_rcp_f32 v2, v2
    buffer_load_dwordx4 v[252:255], v134, s[28:31], s83 offen offset:1024 sc1
    v_rcp_f32 v3, v3
    v_rcp_f32 v4, v4
    v_mul_f32 v76, v76, v1
    v_mul_f32 v77, v77, v2
    v_mul_f32 v78, v78, v3
    v_mul_f32 v79, v79, v4
    buffer_load_dwordx4 v[200:203], v144, s[72:75], s60 offen sc1
    v_cvt_pk_bf16_f32 v138, v76, v77
    v_cvt_pk_bf16_f32 v139, v78, v79
    s_nop 0
    v_permlane16_swap_b32 v136, v138
    v_permlane16_swap_b32 v137, v139
    v_mul_f32 v1, v80, v80
    v_mul_f32 v2, v81, v81
    buffer_load_dwordx4 v[204:207], v144, s[72:75], s60 offen offset:1024 sc1
    v_mul_f32 v3, v82, v82
    v_mul_f32 v4, v83, v83
    v_fmamk_f32 v1, v1, 0xbdd2d3e8, v15
    v_fmamk_f32 v2, v2, 0xbdd2d3e8, v15
    v_fmamk_f32 v3, v3, 0xbdd2d3e8, v15
    v_fmamk_f32 v4, v4, 0xbdd2d3e8, v15
    buffer_load_dword v11, v122, s[28:31], s61 offen sc1
    v_mul_f32 v1, v1, v80
    v_mul_f32 v2, v2, v81
    v_mul_f32 v3, v3, v82
    v_mul_f32 v4, v4, v83
    v_exp_f32 v1, v1
    v_exp_f32 v2, v2
    v_exp_f32 v3, v3
    v_exp_f32 v4, v4
    v_mul_f32 v88, v80, v88
    v_mul_f32 v89, v81, v89
    v_mul_f32 v90, v82, v90
    v_mul_f32 v91, v83, v91
    v_add_f32 v1, 1.0, v1
    v_add_f32 v2, 1.0, v2
    v_add_f32 v3, 1.0, v3
    v_add_f32 v4, 1.0, v4
    v_rcp_f32 v1, v1
    v_rcp_f32 v2, v2
    v_rcp_f32 v3, v3
    v_rcp_f32 v4, v4
    v_mul_f32 v88, v88, v1
    v_mul_f32 v89, v89, v2
    v_mul_f32 v90, v90, v3
    v_mul_f32 v91, v91, v4
    v_cvt_pk_bf16_f32 v140, v88, v89
    v_cvt_pk_bf16_f32 v141, v90, v91
    v_mul_f32 v1, v84, v84
    v_mul_f32 v2, v85, v85
    v_mul_f32 v3, v86, v86
    v_mul_f32 v4, v87, v87
    v_fmamk_f32 v1, v1, 0xbdd2d3e8, v15
    v_fmamk_f32 v2, v2, 0xbdd2d3e8, v15
    v_fmamk_f32 v3, v3, 0xbdd2d3e8, v15
    v_fmamk_f32 v4, v4, 0xbdd2d3e8, v15
    v_mul_f32 v1, v1, v84
    v_mul_f32 v2, v2, v85
    v_mul_f32 v3, v3, v86
    v_mul_f32 v4, v4, v87
    v_exp_f32 v1, v1
    v_exp_f32 v2, v2
    v_exp_f32 v3, v3
    v_exp_f32 v4, v4
    v_mul_f32 v92, v84, v92
    v_mul_f32 v93, v85, v93
    v_mul_f32 v94, v86, v94
    v_mul_f32 v95, v87, v95
    v_add_f32 v1, 1.0, v1
    v_add_f32 v2, 1.0, v2
    v_add_f32 v3, 1.0, v3
    v_add_f32 v4, 1.0, v4
    v_rcp_f32 v1, v1
    v_rcp_f32 v2, v2
    v_rcp_f32 v3, v3
    v_rcp_f32 v4, v4
    v_mul_f32 v92, v92, v1
    v_mul_f32 v93, v93, v2
    v_mul_f32 v94, v94, v3
    v_mul_f32 v95, v95, v4
    v_cvt_pk_bf16_f32 v142, v92, v93
    v_cvt_pk_bf16_f32 v143, v94, v95
    s_nop 0
    v_permlane16_swap_b32 v140, v142
    v_permlane16_swap_b32 v141, v143
    s_add_u32 s59, s63, 4096
    buffer_store_dwordx4 v[136:139], v134, s[28:31], s59 offen sc1
    s_add_u32 s59, s63, 5120
    buffer_store_dwordx4 v[140:143], v134, s[28:31], s59 offen sc1
gated_mix__mha_block__glu_gated_geglu__prompt_kernel_a_go:
    s_mov_b32 s62, 0x30800000
    v_mov_b32 v7, 0x4e800000
    s_waitcnt vmcnt(13)
    v_and_b32 v224, v224, v120
    v_and_b32 v225, v225, v120
    v_and_b32 v230, v230, v121
    v_and_b32 v231, v231, v121
    s_waitcnt vmcnt(12)
    v_mfma_f32_32x32x16_bf16 v[80:95], v[192:195], v[224:227], 0
    s_waitcnt vmcnt(11)
    v_mfma_f32_32x32x16_bf16 v[80:95], v[196:199], v[228:231], v[80:95]
    s_setprio 1
    s_waitcnt vmcnt(9)
    v_and_b32 v232, v232, v120
    v_and_b32 v233, v233, v120
    v_and_b32 v238, v238, v121
    v_and_b32 v239, v239, v121
    v_mfma_f32_32x32x16_bf16 v[96:111], v[192:195], v[232:235], 0
    s_nop 4
    v_exp_f32 v80, v80
    v_exp_f32 v81, v81
    v_exp_f32 v82, v82
    v_exp_f32 v83, v83
    v_cvt_pk_bf16_f32 v112, v80, v81
    v_cvt_pk_bf16_f32 v113, v82, v83
    s_mov_b64 exec, s[84:85]
    buffer_load_dwordx4 v[168:171], v148, s[76:79], s60 offen sc1
    buffer_load_dwordx4 v[172:175], v149, s[76:79], s60 offen sc1
    s_mov_b64 exec, -1
    v_exp_f32 v84, v84
    v_exp_f32 v85, v85
    v_exp_f32 v86, v86
    v_exp_f32 v87, v87
    v_cvt_pk_bf16_f32 v114, v84, v85
    v_cvt_pk_bf16_f32 v115, v86, v87
    v_mfma_f32_32x32x16_bf16 v[96:111], v[196:199], v[236:239], v[96:111]
    v_exp_f32 v88, v88
    v_exp_f32 v89, v89
    v_exp_f32 v90, v90
    v_exp_f32 v91, v91
    v_cvt_pk_bf16_f32 v116, v88, v89
    v_cvt_pk_bf16_f32 v117, v90, v91
    s_waitcnt vmcnt(9)
    v_mfma_f32_32x32x16_bf16 v[16:31], v[160:163], v[112:115], 0
    v_exp_f32 v92, v92
    v_exp_f32 v93, v93
    v_exp_f32 v94, v94
    v_exp_f32 v95, v95
    v_cvt_pk_bf16_f32 v118, v92, v93
    v_cvt_pk_bf16_f32 v119, v94, v95
    s_waitcnt vmcnt(7)
    v_and_b32 v240, v240, v120
    v_and_b32 v241, v241, v120
    v_and_b32 v246, v246, v121
    v_and_b32 v247, v247, v121
    v_mfma_f32_32x32x16_bf16 v[80:95], v[192:195], v[240:243], 0
    v_exp_f32 v96, v96
    v_exp_f32 v97, v97
    v_exp_f32 v98, v98
    v_exp_f32 v99, v99
    v_cvt_pk_bf16_f32 v112, v96, v97
    v_cvt_pk_bf16_f32 v113, v98, v99
    v_mfma_f32_32x32x16_bf16 v[16:31], v[164:167], v[116:119], v[16:31]
    buffer_load_dwordx4 v[208:211], v145, s[72:75], s60 offen sc1
    buffer_load_dwordx4 v[212:215], v145, s[72:75], s60 offen offset:1024 sc1
    v_exp_f32 v100, v100
    v_exp_f32 v101, v101
    v_exp_f32 v102, v102
    v_exp_f32 v103, v103
    v_cvt_pk_bf16_f32 v114, v100, v101
    v_cvt_pk_bf16_f32 v115, v102, v103
    v_mfma_f32_32x32x16_bf16 v[80:95], v[196:199], v[244:247], v[80:95]
    v_exp_f32 v104, v104
    v_exp_f32 v105, v105
    v_exp_f32 v106, v106
    v_exp_f32 v107, v107
    v_cvt_pk_bf16_f32 v116, v104, v105
    v_cvt_pk_bf16_f32 v117, v106, v107
    v_mfma_f32_32x32x16_bf16 v[32:47], v[160:163], v[112:115], 0
    v_exp_f32 v108, v108
    v_exp_f32 v109, v109
    v_exp_f32 v110, v110
    v_exp_f32 v111, v111
    v_cvt_pk_bf16_f32 v118, v108, v109
    v_cvt_pk_bf16_f32 v119, v110, v111
    s_waitcnt vmcnt(7)
    v_and_b32 v248, v248, v120
    v_and_b32 v249, v249, v120
    v_and_b32 v254, v254, v121
    v_and_b32 v255, v255, v121
    v_mfma_f32_32x32x16_bf16 v[96:111], v[192:195], v[248:251], 0
    v_exp_f32 v80, v80
    v_exp_f32 v81, v81
    v_exp_f32 v82, v82
    v_exp_f32 v83, v83
    v_cvt_pk_bf16_f32 v112, v80, v81
    v_cvt_pk_bf16_f32 v113, v82, v83
    v_mfma_f32_32x32x16_bf16 v[32:47], v[164:167], v[116:119], v[32:47]
    s_mov_b64 exec, s[84:85]
    buffer_load_dwordx4 v[176:179], v150, s[76:79], s60 offen sc1
    buffer_load_dwordx4 v[180:183], v151, s[76:79], s60 offen sc1
    s_mov_b64 exec, -1
    v_exp_f32 v84, v84
    v_exp_f32 v85, v85
    v_exp_f32 v86, v86
    v_exp_f32 v87, v87
    v_cvt_pk_bf16_f32 v114, v84, v85
    v_cvt_pk_bf16_f32 v115, v86, v87
    v_mfma_f32_32x32x16_bf16 v[96:111], v[196:199], v[252:255], v[96:111]
    v_exp_f32 v88, v88
    v_exp_f32 v89, v89
    v_exp_f32 v90, v90
    v_exp_f32 v91, v91
    v_cvt_pk_bf16_f32 v116, v88, v89
    v_cvt_pk_bf16_f32 v117, v90, v91
    v_mfma_f32_32x32x16_bf16 v[48:63], v[160:163], v[112:115], 0
    v_exp_f32 v92, v92
    v_exp_f32 v93, v93
    v_exp_f32 v94, v94
    v_exp_f32 v95, v95
    v_cvt_pk_bf16_f32 v118, v92, v93
    v_cvt_pk_bf16_f32 v119, v94, v95
    s_waitcnt vmcnt(7)
    v_mfma_f32_32x32x16_bf16 v[80:95], v[200:203], v[224:227], 0
    v_exp_f32 v96, v96
    v_exp_f32 v97, v97
    v_exp_f32 v98, v98
    v_exp_f32 v99, v99
    v_cvt_pk_bf16_f32 v112, v96, v97
    v_cvt_pk_bf16_f32 v113, v98, v99
    v_mfma_f32_32x32x16_bf16 v[48:63], v[164:167], v[116:119], v[48:63]
    buffer_load_dwordx4 v[216:219], v146, s[72:75], s60 offen sc1
    buffer_load_dwordx4 v[220:223], v146, s[72:75], s60 offen offset:1024 sc1
    v_exp_f32 v100, v100
    v_exp_f32 v101, v101
    v_exp_f32 v102, v102
    v_exp_f32 v103, v103
    v_cvt_pk_bf16_f32 v114, v100, v101
    v_cvt_pk_bf16_f32 v115, v102, v103
    v_mfma_f32_32x32x16_bf16 v[80:95], v[204:207], v[228:231], v[80:95]
    v_exp_f32 v104, v104
    v_exp_f32 v105, v105
    v_exp_f32 v106, v106
    v_exp_f32 v107, v107
    v_cvt_pk_bf16_f32 v116, v104, v105
    v_cvt_pk_bf16_f32 v117, v106, v107
    v_mfma_f32_32x32x16_bf16 v[64:79], v[160:163], v[112:115], 0
    v_exp_f32 v108, v108
    v_exp_f32 v109, v109
    v_exp_f32 v110, v110
    v_exp_f32 v111, v111
    v_cvt_pk_bf16_f32 v118, v108, v109
    v_cvt_pk_bf16_f32 v119, v110, v111
    v_mfma_f32_32x32x16_bf16 v[96:111], v[200:203], v[232:235], 0
    v_exp_f32 v80, v80
    v_exp_f32 v81, v81
    v_exp_f32 v82, v82
    v_exp_f32 v83, v83
    v_cvt_pk_bf16_f32 v112, v80, v81
    v_cvt_pk_bf16_f32 v113, v82, v83
    v_mfma_f32_32x32x16_bf16 v[64:79], v[164:167], v[116:119], v[64:79]
    s_mov_b64 exec, s[84:85]
    buffer_load_dwordx4 v[184:187], v152, s[76:79], s60 offen sc1
    buffer_load_dwordx4 v[188:191], v153, s[76:79], s60 offen sc1
    s_mov_b64 exec, -1
    v_exp_f32 v84, v84
    v_exp_f32 v85, v85
    v_exp_f32 v86, v86
    v_exp_f32 v87, v87
    v_cvt_pk_bf16_f32 v114, v84, v85
    v_cvt_pk_bf16_f32 v115, v86, v87
    v_mfma_f32_32x32x16_bf16 v[96:111], v[204:207], v[236:239], v[96:111]
    v_exp_f32 v88, v88
    v_exp_f32 v89, v89
    v_exp_f32 v90, v90
    v_exp_f32 v91, v91
    v_cvt_pk_bf16_f32 v116, v88, v89
    v_cvt_pk_bf16_f32 v117, v90, v91
    s_waitcnt vmcnt(8)
    v_mfma_f32_32x32x16_bf16 v[16:31], v[168:171], v[112:115], v[16:31]
    ds_write_b32 v14, v14
    v_exp_f32 v92, v92
    v_exp_f32 v93, v93
    v_exp_f32 v94, v94
    v_exp_f32 v95, v95
    v_cvt_pk_bf16_f32 v118, v92, v93
    v_cvt_pk_bf16_f32 v119, v94, v95
    v_mfma_f32_32x32x16_bf16 v[80:95], v[200:203], v[240:243], 0
    v_exp_f32 v96, v96
    v_exp_f32 v97, v97
    v_exp_f32 v98, v98
    v_exp_f32 v99, v99
    v_cvt_pk_bf16_f32 v112, v96, v97
    v_cvt_pk_bf16_f32 v113, v98, v99
    v_mfma_f32_32x32x16_bf16 v[16:31], v[172:175], v[116:119], v[16:31]
    s_add_u32 s60, s60, 114688
    buffer_load_dwordx4 v[192:195], v134, s[72:75], s60 offen sc1
    buffer_load_dwordx4 v[196:199], v134, s[72:75], s60 offen offset:1024 sc1
    v_exp_f32 v100, v100
    v_exp_f32 v101, v101
    v_exp_f32 v102, v102
    v_exp_f32 v103, v103
    v_cvt_pk_bf16_f32 v114, v100, v101
    v_cvt_pk_bf16_f32 v115, v102, v103
    v_mfma_f32_32x32x16_bf16 v[80:95], v[204:207], v[244:247], v[80:95]
    v_exp_f32 v104, v104
    v_exp_f32 v105, v105
    v_exp_f32 v106, v106
    v_exp_f32 v107, v107
    v_cvt_pk_bf16_f32 v116, v104, v105
    v_cvt_pk_bf16_f32 v117, v106, v107
    v_mfma_f32_32x32x16_bf16 v[32:47], v[168:171], v[112:115], v[32:47]
    v_exp_f32 v108, v108
    v_exp_f32 v109, v109
    v_exp_f32 v110, v110
    v_exp_f32 v111, v111
    v_cvt_pk_bf16_f32 v118, v108, v109
    v_cvt_pk_bf16_f32 v119, v110, v111
    v_mfma_f32_32x32x16_bf16 v[96:111], v[200:203], v[248:251], 0
    v_exp_f32 v80, v80
    v_exp_f32 v81, v81
    v_exp_f32 v82, v82
    v_exp_f32 v83, v83
    v_cvt_pk_bf16_f32 v112, v80, v81
    v_cvt_pk_bf16_f32 v113, v82, v83
    v_mfma_f32_32x32x16_bf16 v[32:47], v[172:175], v[116:119], v[32:47]
    s_mov_b64 exec, s[84:85]
    buffer_load_dwordx4 v[160:163], v10, s[76:79], s60 offen sc1
    buffer_load_dwordx4 v[164:167], v147, s[76:79], s60 offen sc1
    s_mov_b64 exec, -1
    v_exp_f32 v84, v84
    v_exp_f32 v85, v85
    v_exp_f32 v86, v86
    v_exp_f32 v87, v87
    v_cvt_pk_bf16_f32 v114, v84, v85
    v_cvt_pk_bf16_f32 v115, v86, v87
    v_mfma_f32_32x32x16_bf16 v[96:111], v[204:207], v[252:255], v[96:111]
    v_exp_f32 v88, v88
    v_exp_f32 v89, v89
    v_exp_f32 v90, v90
    v_exp_f32 v91, v91
    v_cvt_pk_bf16_f32 v116, v88, v89
    v_cvt_pk_bf16_f32 v117, v90, v91
    v_mfma_f32_32x32x16_bf16 v[48:63], v[168:171], v[112:115], v[48:63]
    v_exp_f32 v92, v92
    v_exp_f32 v93, v93
    v_exp_f32 v94, v94
    v_exp_f32 v95, v95
    v_cvt_pk_bf16_f32 v118, v92, v93
    v_cvt_pk_bf16_f32 v119, v94, v95
    s_waitcnt vmcnt(10)
    v_mfma_f32_32x32x16_bf16 v[80:95], v[208:211], v[224:227], 0
    v_exp_f32 v96, v96
    v_exp_f32 v97, v97
    v_exp_f32 v98, v98
    v_exp_f32 v99, v99
    v_cvt_pk_bf16_f32 v112, v96, v97
    v_cvt_pk_bf16_f32 v113, v98, v99
    v_mfma_f32_32x32x16_bf16 v[48:63], v[172:175], v[116:119], v[48:63]
    buffer_load_dwordx4 v[200:203], v144, s[72:75], s60 offen sc1
    buffer_load_dwordx4 v[204:207], v144, s[72:75], s60 offen offset:1024 sc1
    v_exp_f32 v100, v100
    v_exp_f32 v101, v101
    v_exp_f32 v102, v102
    v_exp_f32 v103, v103
    v_cvt_pk_bf16_f32 v114, v100, v101
    v_cvt_pk_bf16_f32 v115, v102, v103
    v_mfma_f32_32x32x16_bf16 v[80:95], v[212:215], v[228:231], v[80:95]
    v_exp_f32 v104, v104
    v_exp_f32 v105, v105
    v_exp_f32 v106, v106
    v_exp_f32 v107, v107
    v_cvt_pk_bf16_f32 v116, v104, v105
    v_cvt_pk_bf16_f32 v117, v106, v107
    v_mfma_f32_32x32x16_bf16 v[64:79], v[168:171], v[112:115], v[64:79]
    v_exp_f32 v108, v108
    v_exp_f32 v109, v109
    v_exp_f32 v110, v110
    v_exp_f32 v111, v111
    v_cvt_pk_bf16_f32 v118, v108, v109
    v_cvt_pk_bf16_f32 v119, v110, v111
    v_mfma_f32_32x32x16_bf16 v[96:111], v[208:211], v[232:235], 0
    v_exp_f32 v80, v80
    v_exp_f32 v81, v81
    v_exp_f32 v82, v82
    v_exp_f32 v83, v83
    v_cvt_pk_bf16_f32 v112, v80, v81
    v_cvt_pk_bf16_f32 v113, v82, v83
    v_mfma_f32_32x32x16_bf16 v[64:79], v[172:175], v[116:119], v[64:79]
    s_mov_b64 exec, s[84:85]
    buffer_load_dwordx4 v[168:171], v148, s[76:79], s60 offen sc1
    buffer_load_dwordx4 v[172:175], v149, s[76:79], s60 offen sc1
    s_mov_b64 exec, -1
    v_exp_f32 v84, v84
    v_exp_f32 v85, v85
    v_exp_f32 v86, v86
    v_exp_f32 v87, v87
    v_cvt_pk_bf16_f32 v114, v84, v85
    v_cvt_pk_bf16_f32 v115, v86, v87
    v_mfma_f32_32x32x16_bf16 v[96:111], v[212:215], v[236:239], v[96:111]
    v_exp_f32 v88, v88
    v_exp_f32 v89, v89
    v_exp_f32 v90, v90
    v_exp_f32 v91, v91
    v_cvt_pk_bf16_f32 v116, v88, v89
    v_cvt_pk_bf16_f32 v117, v90, v91
    s_waitcnt vmcnt(12)
    v_mfma_f32_32x32x16_bf16 v[16:31], v[176:179], v[112:115], v[16:31]
    v_exp_f32 v92, v92
    v_exp_f32 v93, v93
    v_exp_f32 v94, v94
    v_exp_f32 v95, v95
    v_cvt_pk_bf16_f32 v118, v92, v93
    v_cvt_pk_bf16_f32 v119, v94, v95
    v_mfma_f32_32x32x16_bf16 v[80:95], v[208:211], v[240:243], 0
    v_exp_f32 v96, v96
    v_exp_f32 v97, v97
    v_exp_f32 v98, v98
    v_exp_f32 v99, v99
    v_cvt_pk_bf16_f32 v112, v96, v97
    v_cvt_pk_bf16_f32 v113, v98, v99
    v_mfma_f32_32x32x16_bf16 v[16:31], v[180:183], v[116:119], v[16:31]
    v_exp_f32 v100, v100
    v_exp_f32 v101, v101
    v_exp_f32 v102, v102
    v_exp_f32 v103, v103
    v_cvt_pk_bf16_f32 v114, v100, v101
    v_cvt_pk_bf16_f32 v115, v102, v103
    v_mfma_f32_32x32x16_bf16 v[80:95], v[212:215], v[244:247], v[80:95]
    v_exp_f32 v104, v104
    v_exp_f32 v105, v105
    v_exp_f32 v106, v106
    v_exp_f32 v107, v107
    v_cvt_pk_bf16_f32 v116, v104, v105
    v_cvt_pk_bf16_f32 v117, v106, v107
    v_mfma_f32_32x32x16_bf16 v[32:47], v[176:179], v[112:115], v[32:47]
    v_exp_f32 v108, v108
    v_exp_f32 v109, v109
    v_exp_f32 v110, v110
    v_exp_f32 v111, v111
    v_cvt_pk_bf16_f32 v118, v108, v109
    v_cvt_pk_bf16_f32 v119, v110, v111
    v_mfma_f32_32x32x16_bf16 v[96:111], v[208:211], v[248:251], 0
    v_exp_f32 v80, v80
    v_exp_f32 v81, v81
    v_exp_f32 v82, v82
    v_exp_f32 v83, v83
    v_cvt_pk_bf16_f32 v112, v80, v81
    v_cvt_pk_bf16_f32 v113, v82, v83
    v_mfma_f32_32x32x16_bf16 v[32:47], v[180:183], v[116:119], v[32:47]
    v_exp_f32 v84, v84
    v_exp_f32 v85, v85
    v_exp_f32 v86, v86
    v_exp_f32 v87, v87
    v_cvt_pk_bf16_f32 v114, v84, v85
    v_cvt_pk_bf16_f32 v115, v86, v87
    v_mfma_f32_32x32x16_bf16 v[96:111], v[212:215], v[252:255], v[96:111]
    buffer_load_dwordx4 v[208:211], v145, s[72:75], s60 offen sc1
    buffer_load_dwordx4 v[212:215], v145, s[72:75], s60 offen offset:1024 sc1
    v_exp_f32 v88, v88
    v_exp_f32 v89, v89
    v_exp_f32 v90, v90
    v_exp_f32 v91, v91
    v_cvt_pk_bf16_f32 v116, v88, v89
    v_cvt_pk_bf16_f32 v117, v90, v91
    v_mfma_f32_32x32x16_bf16 v[48:63], v[176:179], v[112:115], v[48:63]
    v_exp_f32 v92, v92
    v_exp_f32 v93, v93
    v_exp_f32 v94, v94
    v_exp_f32 v95, v95
    v_cvt_pk_bf16_f32 v118, v92, v93
    v_cvt_pk_bf16_f32 v119, v94, v95
    s_waitcnt vmcnt(12)
    v_mfma_f32_32x32x16_bf16 v[80:95], v[216:219], v[224:227], 0
    v_exp_f32 v96, v96
    v_exp_f32 v97, v97
    v_exp_f32 v98, v98
    v_exp_f32 v99, v99
    v_cvt_pk_bf16_f32 v112, v96, v97
    v_cvt_pk_bf16_f32 v113, v98, v99
    v_mfma_f32_32x32x16_bf16 v[48:63], v[180:183], v[116:119], v[48:63]
    v_exp_f32 v100, v100
    v_exp_f32 v101, v101
    v_exp_f32 v102, v102
    v_exp_f32 v103, v103
    v_cvt_pk_bf16_f32 v114, v100, v101
    v_cvt_pk_bf16_f32 v115, v102, v103
    v_mfma_f32_32x32x16_bf16 v[80:95], v[220:223], v[228:231], v[80:95]
    v_exp_f32 v104, v104
    v_exp_f32 v105, v105
    v_exp_f32 v106, v106
    v_exp_f32 v107, v107
    v_cvt_pk_bf16_f32 v116, v104, v105
    v_cvt_pk_bf16_f32 v117, v106, v107
    v_mfma_f32_32x32x16_bf16 v[64:79], v[176:179], v[112:115], v[64:79]
    v_exp_f32 v108, v108
    v_exp_f32 v109, v109
    v_exp_f32 v110, v110
    v_exp_f32 v111, v111
    v_cvt_pk_bf16_f32 v118, v108, v109
    v_cvt_pk_bf16_f32 v119, v110, v111
    v_mfma_f32_32x32x16_bf16 v[96:111], v[216:219], v[232:235], 0
    v_exp_f32 v80, v80
    v_exp_f32 v81, v81
    v_exp_f32 v82, v82
    v_exp_f32 v83, v83
    v_cvt_pk_bf16_f32 v112, v80, v81
    v_cvt_pk_bf16_f32 v113, v82, v83
    v_mfma_f32_32x32x16_bf16 v[64:79], v[180:183], v[116:119], v[64:79]
    s_mov_b64 exec, s[84:85]
    buffer_load_dwordx4 v[176:179], v150, s[76:79], s60 offen sc1
    buffer_load_dwordx4 v[180:183], v151, s[76:79], s60 offen sc1
    s_mov_b64 exec, -1
    v_exp_f32 v84, v84
    v_exp_f32 v85, v85
    v_exp_f32 v86, v86
    v_exp_f32 v87, v87
    v_cvt_pk_bf16_f32 v114, v84, v85
    v_cvt_pk_bf16_f32 v115, v86, v87
    v_mfma_f32_32x32x16_bf16 v[96:111], v[220:223], v[236:239], v[96:111]
    v_exp_f32 v88, v88
    v_exp_f32 v89, v89
    v_exp_f32 v90, v90
    v_exp_f32 v91, v91
    v_cvt_pk_bf16_f32 v116, v88, v89
    v_cvt_pk_bf16_f32 v117, v90, v91
    s_waitcnt vmcnt(12)
    v_mfma_f32_32x32x16_bf16 v[16:31], v[184:187], v[112:115], v[16:31]
    v_exp_f32 v92, v92
    v_exp_f32 v93, v93
    v_exp_f32 v94, v94
    v_exp_f32 v95, v95
    v_cvt_pk_bf16_f32 v118, v92, v93
    v_cvt_pk_bf16_f32 v119, v94, v95
    v_mfma_f32_32x32x16_bf16 v[80:95], v[216:219], v[240:243], 0
    v_exp_f32 v96, v96
    v_exp_f32 v97, v97
    v_exp_f32 v98, v98
    v_exp_f32 v99, v99
    v_cvt_pk_bf16_f32 v112, v96, v97
    v_cvt_pk_bf16_f32 v113, v98, v99
    v_mfma_f32_32x32x16_bf16 v[16:31], v[188:191], v[116:119], v[16:31]
    v_exp_f32 v100, v100
    v_exp_f32 v101, v101
    v_exp_f32 v102, v102
    v_exp_f32 v103, v103
    v_cvt_pk_bf16_f32 v114, v100, v101
    v_cvt_pk_bf16_f32 v115, v102, v103
    v_mfma_f32_32x32x16_bf16 v[80:95], v[220:223], v[244:247], v[80:95]
    v_exp_f32 v104, v104
    v_exp_f32 v105, v105
    v_exp_f32 v106, v106
    v_exp_f32 v107, v107
    v_cvt_pk_bf16_f32 v116, v104, v105
    v_cvt_pk_bf16_f32 v117, v106, v107
    v_mfma_f32_32x32x16_bf16 v[32:47], v[184:187], v[112:115], v[32:47]
    v_exp_f32 v108, v108
    v_exp_f32 v109, v109
    v_exp_f32 v110, v110
    v_exp_f32 v111, v111
    v_cvt_pk_bf16_f32 v118, v108, v109
    v_cvt_pk_bf16_f32 v119, v110, v111
    v_mfma_f32_32x32x16_bf16 v[96:111], v[216:219], v[248:251], 0
    v_exp_f32 v80, v80
    v_exp_f32 v81, v81
    v_exp_f32 v82, v82
    v_exp_f32 v83, v83
    v_cvt_pk_bf16_f32 v112, v80, v81
    v_cvt_pk_bf16_f32 v113, v82, v83
    v_mfma_f32_32x32x16_bf16 v[32:47], v[188:191], v[116:119], v[32:47]
    v_exp_f32 v84, v84
    v_exp_f32 v85, v85
    v_exp_f32 v86, v86
    v_exp_f32 v87, v87
    v_cvt_pk_bf16_f32 v114, v84, v85
    v_cvt_pk_bf16_f32 v115, v86, v87
    v_mfma_f32_32x32x16_bf16 v[96:111], v[220:223], v[252:255], v[96:111]
    buffer_load_dwordx4 v[216:219], v146, s[72:75], s60 offen sc1
    buffer_load_dwordx4 v[220:223], v146, s[72:75], s60 offen offset:1024 sc1
    v_exp_f32 v88, v88
    v_exp_f32 v89, v89
    v_exp_f32 v90, v90
    v_exp_f32 v91, v91
    v_cvt_pk_bf16_f32 v116, v88, v89
    v_cvt_pk_bf16_f32 v117, v90, v91
    v_mfma_f32_32x32x16_bf16 v[48:63], v[184:187], v[112:115], v[48:63]
    v_exp_f32 v92, v92
    v_exp_f32 v93, v93
    v_exp_f32 v94, v94
    v_exp_f32 v95, v95
    v_cvt_pk_bf16_f32 v118, v92, v93
    v_cvt_pk_bf16_f32 v119, v94, v95
    s_waitcnt vmcnt(12)
    v_mfma_f32_32x32x16_bf16 v[80:95], v[192:195], v[224:227], 0
    v_exp_f32 v96, v96
    v_exp_f32 v97, v97
    v_exp_f32 v98, v98
    v_exp_f32 v99, v99
    v_cvt_pk_bf16_f32 v112, v96, v97
    v_cvt_pk_bf16_f32 v113, v98, v99
    v_mfma_f32_32x32x16_bf16 v[48:63], v[188:191], v[116:119], v[48:63]
    v_exp_f32 v100, v100
    v_exp_f32 v101, v101
    v_exp_f32 v102, v102
    v_exp_f32 v103, v103
    v_cvt_pk_bf16_f32 v114, v100, v101
    v_cvt_pk_bf16_f32 v115, v102, v103
    v_mfma_f32_32x32x16_bf16 v[80:95], v[196:199], v[228:231], v[80:95]
    v_exp_f32 v104, v104
    v_exp_f32 v105, v105
    v_exp_f32 v106, v106
    v_exp_f32 v107, v107
    v_cvt_pk_bf16_f32 v116, v104, v105
    v_cvt_pk_bf16_f32 v117, v106, v107
    v_mfma_f32_32x32x16_bf16 v[64:79], v[184:187], v[112:115], v[64:79]
    v_exp_f32 v108, v108
    v_exp_f32 v109, v109
    v_exp_f32 v110, v110
    v_exp_f32 v111, v111
    v_cvt_pk_bf16_f32 v118, v108, v109
    v_cvt_pk_bf16_f32 v119, v110, v111
    s_mov_b32 s56, 1
gated_mix__mha_block__glu_gated_geglu__prompt_kernel_aloop33:
    v_mfma_f32_32x32x16_bf16 v[96:111], v[192:195], v[232:235], 0
    v_exp_f32 v80, v80
    v_exp_f32 v81, v81
    v_exp_f32 v82, v82
    v_exp_f32 v83, v83
    v_cvt_pk_bf16_f32 v112, v80, v81
    v_cvt_pk_bf16_f32 v113, v82, v83
    v_mfma_f32_32x32x16_bf16 v[64:79], v[188:191], v[116:119], v[64:79]
    s_mov_b64 exec, s[84:85]
    buffer_load_dwordx4 v[184:187], v152, s[76:79], s60 offen sc1
    buffer_load_dwordx4 v[188:191], v153, s[76:79], s60 offen sc1
    s_mov_b64 exec, -1
    v_exp_f32 v84, v84
    v_exp_f32 v85, v85
    v_exp_f32 v86, v86
    v_exp_f32 v87, v87
    v_cvt_pk_bf16_f32 v114, v84, v85
    v_cvt_pk_bf16_f32 v115, v86, v87
    v_mfma_f32_32x32x16_bf16 v[96:111], v[196:199], v[236:239], v[96:111]
    v_exp_f32 v88, v88
    v_exp_f32 v89, v89
    v_exp_f32 v90, v90
    v_exp_f32 v91, v91
    v_cvt_pk_bf16_f32 v116, v88, v89
    v_cvt_pk_bf16_f32 v117, v90, v91
    s_waitcnt vmcnt(12)
    v_mfma_f32_32x32x16_bf16 v[16:31], v[160:163], v[112:115], v[16:31]
    v_exp_f32 v92, v92
    v_exp_f32 v93, v93
    v_exp_f32 v94, v94
    v_exp_f32 v95, v95
    v_cvt_pk_bf16_f32 v118, v92, v93
    v_cvt_pk_bf16_f32 v119, v94, v95
    v_mfma_f32_32x32x16_bf16 v[80:95], v[192:195], v[240:243], 0
    v_exp_f32 v96, v96
    v_exp_f32 v97, v97
    v_exp_f32 v98, v98
    v_exp_f32 v99, v99
    v_cvt_pk_bf16_f32 v112, v96, v97
    v_cvt_pk_bf16_f32 v113, v98, v99
    v_mfma_f32_32x32x16_bf16 v[16:31], v[164:167], v[116:119], v[16:31]
    v_exp_f32 v100, v100
    v_exp_f32 v101, v101
    v_exp_f32 v102, v102
    v_exp_f32 v103, v103
    v_cvt_pk_bf16_f32 v114, v100, v101
    v_cvt_pk_bf16_f32 v115, v102, v103
    v_mfma_f32_32x32x16_bf16 v[80:95], v[196:199], v[244:247], v[80:95]
    v_exp_f32 v104, v104
    v_exp_f32 v105, v105
    v_exp_f32 v106, v106
    v_exp_f32 v107, v107
    v_cvt_pk_bf16_f32 v116, v104, v105
    v_cvt_pk_bf16_f32 v117, v106, v107
    v_mfma_f32_32x32x16_bf16 v[32:47], v[160:163], v[112:115], v[32:47]
    v_exp_f32 v108, v108
    v_exp_f32 v109, v109
    v_exp_f32 v110, v110
    v_exp_f32 v111, v111
    v_cvt_pk_bf16_f32 v118, v108, v109
    v_cvt_pk_bf16_f32 v119, v110, v111
    v_mfma_f32_32x32x16_bf16 v[96:111], v[192:195], v[248:251], 0
    v_exp_f32 v80, v80
    v_exp_f32 v81, v81
    v_exp_f32 v82, v82
    v_exp_f32 v83, v83
    v_cvt_pk_bf16_f32 v112, v80, v81
    v_cvt_pk_bf16_f32 v113, v82, v83
    v_mfma_f32_32x32x16_bf16 v[32:47], v[164:167], v[116:119], v[32:47]
    v_exp_f32 v84, v84
    v_exp_f32 v85, v85
    v_exp_f32 v86, v86
    v_exp_f32 v87, v87
    v_cvt_pk_bf16_f32 v114, v84, v85
    v_cvt_pk_bf16_f32 v115, v86, v87
    v_mfma_f32_32x32x16_bf16 v[96:111], v[196:199], v[252:255], v[96:111]
    s_add_u32 s60, s60, 114688
    buffer_load_dwordx4 v[192:195], v134, s[72:75], s60 offen sc1
    buffer_load_dwordx4 v[196:199], v134, s[72:75], s60 offen offset:1024 sc1
    v_exp_f32 v88, v88
    v_exp_f32 v89, v89
    v_exp_f32 v90, v90
    v_exp_f32 v91, v91
    v_cvt_pk_bf16_f32 v116, v88, v89
    v_cvt_pk_bf16_f32 v117, v90, v91
    v_mfma_f32_32x32x16_bf16 v[48:63], v[160:163], v[112:115], v[48:63]
    v_exp_f32 v92, v92
    v_exp_f32 v93, v93
    v_exp_f32 v94, v94
    v_exp_f32 v95, v95
    v_cvt_pk_bf16_f32 v118, v92, v93
    v_cvt_pk_bf16_f32 v119, v94, v95
    s_waitcnt vmcnt(12)
    v_mfma_f32_32x32x16_bf16 v[80:95], v[200:203], v[224:227], 0
    v_exp_f32 v96, v96
    v_exp_f32 v97, v97
    v_exp_f32 v98, v98
    v_exp_f32 v99, v99
    v_cvt_pk_bf16_f32 v112, v96, v97
    v_cvt_pk_bf16_f32 v113, v98, v99
    v_mfma_f32_32x32x16_bf16 v[48:63], v[164:167], v[116:119], v[48:63]
    v_exp_f32 v100, v100
    v_exp_f32 v101, v101
    v_exp_f32 v102, v102
    v_exp_f32 v103, v103
    v_cvt_pk_bf16_f32 v114, v100, v101
    v_cvt_pk_bf16_f32 v115, v102, v103
    v_mfma_f32_32x32x16_bf16 v[80:95], v[204:207], v[228:231], v[80:95]
    v_exp_f32 v104, v104
    v_exp_f32 v105, v105
    v_exp_f32 v106, v106
    v_exp_f32 v107, v107
    v_cvt_pk_bf16_f32 v116, v104, v105
    v_cvt_pk_bf16_f32 v117, v106, v107
    v_mfma_f32_32x32x16_bf16 v[64:79], v[160:163], v[112:115], v[64:79]
    v_exp_f32 v108, v108
    v_exp_f32 v109, v109
    v_exp_f32 v110, v110
    v_exp_f32 v111, v111
    v_cvt_pk_bf16_f32 v118, v108, v109
    v_cvt_pk_bf16_f32 v119, v110, v111
    v_mfma_f32_32x32x16_bf16 v[96:111], v[200:203], v[232:235], 0
    v_exp_f32 v80, v80
    v_exp_f32 v81, v81
    v_exp_f32 v82, v82
    v_exp_f32 v83, v83
    v_cvt_pk_bf16_f32 v112, v80, v81
    v_cvt_pk_bf16_f32 v113, v82, v83
    v_mfma_f32_32x32x16_bf16 v[64:79], v[164:167], v[116:119], v[64:79]
    s_mov_b64 exec, s[84:85]
    buffer_load_dwordx4 v[160:163], v10, s[76:79], s60 offen sc1
    buffer_load_dwordx4 v[164:167], v147, s[76:79], s60 offen sc1
    s_mov_b64 exec, -1
    v_exp_f32 v84, v84
    v_exp_f32 v85, v85
    v_exp_f32 v86, v86
    v_exp_f32 v87, v87
    v_cvt_pk_bf16_f32 v114, v84, v85
    v_cvt_pk_bf16_f32 v115, v86, v87
    v_mfma_f32_32x32x16_bf16 v[96:111], v[204:207], v[236:239], v[96:111]
    v_exp_f32 v88, v88
    v_exp_f32 v89, v89
    v_exp_f32 v90, v90
    v_exp_f32 v91, v91
    v_cvt_pk_bf16_f32 v116, v88, v89
    v_cvt_pk_bf16_f32 v117, v90, v91
    s_waitcnt vmcnt(12)
    v_mfma_f32_32x32x16_bf16 v[16:31], v[168:171], v[112:115], v[16:31]
    v_exp_f32 v92, v92
    v_exp_f32 v93, v93
    v_exp_f32 v94, v94
    v_exp_f32 v95, v95
    v_cvt_pk_bf16_f32 v118, v92, v93
    v_cvt_pk_bf16_f32 v119, v94, v95
    v_mfma_f32_32x32x16_bf16 v[80:95], v[200:203], v[240:243], 0
    v_exp_f32 v96, v96
    v_exp_f32 v97, v97
    v_exp_f32 v98, v98
    v_exp_f32 v99, v99
    v_cvt_pk_bf16_f32 v112, v96, v97
    v_cvt_pk_bf16_f32 v113, v98, v99
    v_mfma_f32_32x32x16_bf16 v[16:31], v[172:175], v[116:119], v[16:31]
    v_exp_f32 v100, v100
    v_exp_f32 v101, v101
    v_exp_f32 v102, v102
    v_exp_f32 v103, v103
    v_cvt_pk_bf16_f32 v114, v100, v101
    v_cvt_pk_bf16_f32 v115, v102, v103
    v_mfma_f32_32x32x16_bf16 v[80:95], v[204:207], v[244:247], v[80:95]
    v_exp_f32 v104, v104
    v_exp_f32 v105, v105
    v_exp_f32 v106, v106
    v_exp_f32 v107, v107
    v_cvt_pk_bf16_f32 v116, v104, v105
    v_cvt_pk_bf16_f32 v117, v106, v107
    v_mfma_f32_32x32x16_bf16 v[32:47], v[168:171], v[112:115], v[32:47]
    v_exp_f32 v108, v108
    v_exp_f32 v109, v109
    v_exp_f32 v110, v110
    v_exp_f32 v111, v111
    v_cvt_pk_bf16_f32 v118, v108, v109
    v_cvt_pk_bf16_f32 v119, v110, v111
    v_mfma_f32_32x32x16_bf16 v[96:111], v[200:203], v[248:251], 0
    v_exp_f32 v80, v80
    v_exp_f32 v81, v81
    v_exp_f32 v82, v82
    v_exp_f32 v83, v83
    v_cvt_pk_bf16_f32 v112, v80, v81
    v_cvt_pk_bf16_f32 v113, v82, v83
    v_mfma_f32_32x32x16_bf16 v[32:47], v[172:175], v[116:119], v[32:47]
    v_exp_f32 v84, v84
    v_exp_f32 v85, v85
    v_exp_f32 v86, v86
    v_exp_f32 v87, v87
    v_cvt_pk_bf16_f32 v114, v84, v85
    v_cvt_pk_bf16_f32 v115, v86, v87
    v_mfma_f32_32x32x16_bf16 v[96:111], v[204:207], v[252:255], v[96:111]
    buffer_load_dwordx4 v[200:203], v144, s[72:75], s60 offen sc1
    buffer_load_dwordx4 v[204:207], v144, s[72:75], s60 offen offset:1024 sc1
    v_exp_f32 v88, v88
    v_exp_f32 v89, v89
    v_exp_f32 v90, v90
    v_exp_f32 v91, v91
    v_cvt_pk_bf16_f32 v116, v88, v89
    v_cvt_pk_bf16_f32 v117, v90, v91
    v_mfma_f32_32x32x16_bf16 v[48:63], v[168:171], v[112:115], v[48:63]
    v_exp_f32 v92, v92
    v_exp_f32 v93, v93
    v_exp_f32 v94, v94
    v_exp_f32 v95, v95
    v_cvt_pk_bf16_f32 v118, v92, v93
    v_cvt_pk_bf16_f32 v119, v94, v95
    s_waitcnt vmcnt(12)
    v_mfma_f32_32x32x16_bf16 v[80:95], v[208:211], v[224:227], 0
    v_exp_f32 v96, v96
    v_exp_f32 v97, v97
    v_exp_f32 v98, v98
    v_exp_f32 v99, v99
    v_cvt_pk_bf16_f32 v112, v96, v97
    v_cvt_pk_bf16_f32 v113, v98, v99
    v_mfma_f32_32x32x16_bf16 v[48:63], v[172:175], v[116:119], v[48:63]
    v_exp_f32 v100, v100
    v_exp_f32 v101, v101
    v_exp_f32 v102, v102
    v_exp_f32 v103, v103
    v_cvt_pk_bf16_f32 v114, v100, v101
    v_cvt_pk_bf16_f32 v115, v102, v103
    v_mfma_f32_32x32x16_bf16 v[80:95], v[212:215], v[228:231], v[80:95]
    v_exp_f32 v104, v104
    v_exp_f32 v105, v105
    v_exp_f32 v106, v106
    v_exp_f32 v107, v107
    v_cvt_pk_bf16_f32 v116, v104, v105
    v_cvt_pk_bf16_f32 v117, v106, v107
    v_mfma_f32_32x32x16_bf16 v[64:79], v[168:171], v[112:115], v[64:79]
    v_exp_f32 v108, v108
    v_exp_f32 v109, v109
    v_exp_f32 v110, v110
    v_exp_f32 v111, v111
    v_cvt_pk_bf16_f32 v118, v108, v109
    v_cvt_pk_bf16_f32 v119, v110, v111
    v_mfma_f32_32x32x16_bf16 v[96:111], v[208:211], v[232:235], 0
    v_exp_f32 v80, v80
    v_exp_f32 v81, v81
    v_exp_f32 v82, v82
    v_exp_f32 v83, v83
    v_cvt_pk_bf16_f32 v112, v80, v81
    v_cvt_pk_bf16_f32 v113, v82, v83
    v_mfma_f32_32x32x16_bf16 v[64:79], v[172:175], v[116:119], v[64:79]
    s_mov_b64 exec, s[84:85]
    buffer_load_dwordx4 v[168:171], v148, s[76:79], s60 offen sc1
    buffer_load_dwordx4 v[172:175], v149, s[76:79], s60 offen sc1
    s_mov_b64 exec, -1
    v_exp_f32 v84, v84
    v_exp_f32 v85, v85
    v_exp_f32 v86, v86
    v_exp_f32 v87, v87
    v_cvt_pk_bf16_f32 v114, v84, v85
    v_cvt_pk_bf16_f32 v115, v86, v87
    v_mfma_f32_32x32x16_bf16 v[96:111], v[212:215], v[236:239], v[96:111]
    v_exp_f32 v88, v88
    v_exp_f32 v89, v89
    v_exp_f32 v90, v90
    v_exp_f32 v91, v91
    v_cvt_pk_bf16_f32 v116, v88, v89
    v_cvt_pk_bf16_f32 v117, v90, v91
    s_waitcnt vmcnt(12)
    v_mfma_f32_32x32x16_bf16 v[16:31], v[176:179], v[112:115], v[16:31]
    v_exp_f32 v92, v92
    v_exp_f32 v93, v93
    v_exp_f32 v94, v94
    v_exp_f32 v95, v95
    v_cvt_pk_bf16_f32 v118, v92, v93
    v_cvt_pk_bf16_f32 v119, v94, v95
    v_mfma_f32_32x32x16_bf16 v[80:95], v[208:211], v[240:243], 0
    v_exp_f32 v96, v96
    v_exp_f32 v97, v97
    v_exp_f32 v98, v98
    v_exp_f32 v99, v99
    v_cvt_pk_bf16_f32 v112, v96, v97
    v_cvt_pk_bf16_f32 v113, v98, v99
    v_mfma_f32_32x32x16_bf16 v[16:31], v[180:183], v[116:119], v[16:31]
    v_exp_f32 v100, v100
    v_exp_f32 v101, v101
    v_exp_f32 v102, v102
    v_exp_f32 v103, v103
    v_cvt_pk_bf16_f32 v114, v100, v101
    v_cvt_pk_bf16_f32 v115, v102, v103
    v_mfma_f32_32x32x16_bf16 v[80:95], v[212:215], v[244:247], v[80:95]
    v_exp_f32 v104, v104
    v_exp_f32 v105, v105
    v_exp_f32 v106, v106
    v_exp_f32 v107, v107
    v_cvt_pk_bf16_f32 v116, v104, v105
    v_cvt_pk_bf16_f32 v117, v106, v107
    v_mfma_f32_32x32x16_bf16 v[32:47], v[176:179], v[112:115], v[32:47]
    v_exp_f32 v108, v108
    v_exp_f32 v109, v109
    v_exp_f32 v110, v110
    v_exp_f32 v111, v111
    v_cvt_pk_bf16_f32 v118, v108, v109
    v_cvt_pk_bf16_f32 v119, v110, v111
    v_mfma_f32_32x32x16_bf16 v[96:111], v[208:211], v[248:251], 0
    v_exp_f32 v80, v80
    v_exp_f32 v81, v81
    v_exp_f32 v82, v82
    v_exp_f32 v83, v83
    v_cvt_pk_bf16_f32 v112, v80, v81
    v_cvt_pk_bf16_f32 v113, v82, v83
    v_mfma_f32_32x32x16_bf16 v[32:47], v[180:183], v[116:119], v[32:47]
    v_exp_f32 v84, v84
    v_exp_f32 v85, v85
    v_exp_f32 v86, v86
    v_exp_f32 v87, v87
    v_cvt_pk_bf16_f32 v114, v84, v85
    v_cvt_pk_bf16_f32 v115, v86, v87
    v_mfma_f32_32x32x16_bf16 v[96:111], v[212:215], v[252:255], v[96:111]
    buffer_load_dwordx4 v[208:211], v145, s[72:75], s60 offen sc1
    buffer_load_dwordx4 v[212:215], v145, s[72:75], s60 offen offset:1024 sc1
    v_exp_f32 v88, v88
    v_exp_f32 v89, v89
    v_exp_f32 v90, v90
    v_exp_f32 v91, v91
    v_cvt_pk_bf16_f32 v116, v88, v89
    v_cvt_pk_bf16_f32 v117, v90, v91
    v_mfma_f32_32x32x16_bf16 v[48:63], v[176:179], v[112:115], v[48:63]
    v_exp_f32 v92, v92
    v_exp_f32 v93, v93
    v_exp_f32 v94, v94
    v_exp_f32 v95, v95
    v_cvt_pk_bf16_f32 v118, v92, v93
    v_cvt_pk_bf16_f32 v119, v94, v95
    s_waitcnt vmcnt(12)
    v_mfma_f32_32x32x16_bf16 v[80:95], v[216:219], v[224:227], 0
    v_exp_f32 v96, v96
    v_exp_f32 v97, v97
    v_exp_f32 v98, v98
    v_exp_f32 v99, v99
    v_cvt_pk_bf16_f32 v112, v96, v97
    v_cvt_pk_bf16_f32 v113, v98, v99
    v_mfma_f32_32x32x16_bf16 v[48:63], v[180:183], v[116:119], v[48:63]
    v_exp_f32 v100, v100
    v_exp_f32 v101, v101
    v_exp_f32 v102, v102
    v_exp_f32 v103, v103
    v_cvt_pk_bf16_f32 v114, v100, v101
    v_cvt_pk_bf16_f32 v115, v102, v103
    v_mfma_f32_32x32x16_bf16 v[80:95], v[220:223], v[228:231], v[80:95]
    v_exp_f32 v104, v104
    v_exp_f32 v105, v105
    v_exp_f32 v106, v106
    v_exp_f32 v107, v107
    v_cvt_pk_bf16_f32 v116, v104, v105
    v_cvt_pk_bf16_f32 v117, v106, v107
    v_mfma_f32_32x32x16_bf16 v[64:79], v[176:179], v[112:115], v[64:79]
    v_exp_f32 v108, v108
    v_exp_f32 v109, v109
    v_exp_f32 v110, v110
    v_exp_f32 v111, v111
    v_cvt_pk_bf16_f32 v118, v108, v109
    v_cvt_pk_bf16_f32 v119, v110, v111
    v_mfma_f32_32x32x16_bf16 v[96:111], v[216:219], v[232:235], 0
    v_exp_f32 v80, v80
    v_exp_f32 v81, v81
    v_exp_f32 v82, v82
    v_exp_f32 v83, v83
    v_cvt_pk_bf16_f32 v112, v80, v81
    v_cvt_pk_bf16_f32 v113, v82, v83
    v_mfma_f32_32x32x16_bf16 v[64:79], v[180:183], v[116:119], v[64:79]
    s_mov_b64 exec, s[84:85]
    buffer_load_dwordx4 v[176:179], v150, s[76:79], s60 offen sc1
    buffer_load_dwordx4 v[180:183], v151, s[76:79], s60 offen sc1
    s_mov_b64 exec, -1
    v_exp_f32 v84, v84
    v_exp_f32 v85, v85
    v_exp_f32 v86, v86
    v_exp_f32 v87, v87
    v_cvt_pk_bf16_f32 v114, v84, v85
    v_cvt_pk_bf16_f32 v115, v86, v87
    v_mfma_f32_32x32x16_bf16 v[96:111], v[220:223], v[236:239], v[96:111]
    v_exp_f32 v88, v88
    v_exp_f32 v89, v89
    v_exp_f32 v90, v90
    v_exp_f32 v91, v91
    v_cvt_pk_bf16_f32 v116, v88, v89
    v_cvt_pk_bf16_f32 v117, v90, v91
    s_waitcnt vmcnt(12)
    v_mfma_f32_32x32x16_bf16 v[16:31], v[184:187], v[112:115], v[16:31]
    v_exp_f32 v92, v92
    v_exp_f32 v93, v93
    v_exp_f32 v94, v94
    v_exp_f32 v95, v95
    v_cvt_pk_bf16_f32 v118, v92, v93
    v_cvt_pk_bf16_f32 v119, v94, v95
    v_mfma_f32_32x32x16_bf16 v[80:95], v[216:219], v[240:243], 0
    v_exp_f32 v96, v96
    v_exp_f32 v97, v97
    v_exp_f32 v98, v98
    v_exp_f32 v99, v99
    v_cvt_pk_bf16_f32 v112, v96, v97
    v_cvt_pk_bf16_f32 v113, v98, v99
    v_mfma_f32_32x32x16_bf16 v[16:31], v[188:191], v[116:119], v[16:31]
    v_exp_f32 v100, v100
    v_exp_f32 v101, v101
    v_exp_f32 v102, v102
    v_exp_f32 v103, v103
    v_cvt_pk_bf16_f32 v114, v100, v101
    v_cvt_pk_bf16_f32 v115, v102, v103
    v_mfma_f32_32x32x16_bf16 v[80:95], v[220:223], v[244:247], v[80:95]
    v_exp_f32 v104, v104
    v_exp_f32 v105, v105
    v_exp_f32 v106, v106
    v_exp_f32 v107, v107
    v_cvt_pk_bf16_f32 v116, v104, v105
    v_cvt_pk_bf16_f32 v117, v106, v107
    v_mfma_f32_32x32x16_bf16 v[32:47], v[184:187], v[112:115], v[32:47]
    v_exp_f32 v108, v108
    v_exp_f32 v109, v109
    v_exp_f32 v110, v110
    v_exp_f32 v111, v111
    v_cvt_pk_bf16_f32 v118, v108, v109
    v_cvt_pk_bf16_f32 v119, v110, v111
    v_mfma_f32_32x32x16_bf16 v[96:111], v[216:219], v[248:251], 0
    v_exp_f32 v80, v80
    v_exp_f32 v81, v81
    v_exp_f32 v82, v82
    v_exp_f32 v83, v83
    v_cvt_pk_bf16_f32 v112, v80, v81
    v_cvt_pk_bf16_f32 v113, v82, v83
    v_mfma_f32_32x32x16_bf16 v[32:47], v[188:191], v[116:119], v[32:47]
    v_exp_f32 v84, v84
    v_exp_f32 v85, v85
    v_exp_f32 v86, v86
    v_exp_f32 v87, v87
    v_cvt_pk_bf16_f32 v114, v84, v85
    v_cvt_pk_bf16_f32 v115, v86, v87
    v_mfma_f32_32x32x16_bf16 v[96:111], v[220:223], v[252:255], v[96:111]
    buffer_load_dwordx4 v[216:219], v146, s[72:75], s60 offen sc1
    buffer_load_dwordx4 v[220:223], v146, s[72:75], s60 offen offset:1024 sc1
    v_exp_f32 v88, v88
    v_exp_f32 v89, v89
    v_exp_f32 v90, v90
    v_exp_f32 v91, v91
    v_cvt_pk_bf16_f32 v116, v88, v89
    v_cvt_pk_bf16_f32 v117, v90, v91
    v_mfma_f32_32x32x16_bf16 v[48:63], v[184:187], v[112:115], v[48:63]
    v_exp_f32 v92, v92
    v_exp_f32 v93, v93
    v_exp_f32 v94, v94
    v_exp_f32 v95, v95
    v_cvt_pk_bf16_f32 v118, v92, v93
    v_cvt_pk_bf16_f32 v119, v94, v95
    s_waitcnt vmcnt(12)
    v_mfma_f32_32x32x16_bf16 v[80:95], v[192:195], v[224:227], 0
    v_exp_f32 v96, v96
    v_exp_f32 v97, v97
    v_exp_f32 v98, v98
    v_exp_f32 v99, v99
    v_cvt_pk_bf16_f32 v112, v96, v97
    v_cvt_pk_bf16_f32 v113, v98, v99
    v_mfma_f32_32x32x16_bf16 v[48:63], v[188:191], v[116:119], v[48:63]
    v_exp_f32 v100, v100
    v_exp_f32 v101, v101
    v_exp_f32 v102, v102
    v_exp_f32 v103, v103
    v_cvt_pk_bf16_f32 v114, v100, v101
    v_cvt_pk_bf16_f32 v115, v102, v103
    v_mfma_f32_32x32x16_bf16 v[80:95], v[196:199], v[228:231], v[80:95]
    v_exp_f32 v104, v104
    v_exp_f32 v105, v105
    v_exp_f32 v106, v106
    v_exp_f32 v107, v107
    v_cvt_pk_bf16_f32 v116, v104, v105
    v_cvt_pk_bf16_f32 v117, v106, v107
    v_mfma_f32_32x32x16_bf16 v[64:79], v[184:187], v[112:115], v[64:79]
    s_sub_u32 s56, s56, 1
    v_exp_f32 v108, v108
    v_exp_f32 v109, v109
    v_exp_f32 v110, v110
    v_exp_f32 v111, v111
    v_cvt_pk_bf16_f32 v118, v108, v109
    v_cvt_pk_bf16_f32 v119, v110, v111
    s_cbranch_scc0 gated_mix__mha_block__glu_gated_geglu__prompt_kernel_aloop33
    v_mfma_f32_32x32x16_bf16 v[96:111], v[192:195], v[232:235], 0
    v_exp_f32 v80, v80
    v_exp_f32 v81, v81
    v_exp_f32 v82, v82
    v_exp_f32 v83, v83
    v_cvt_pk_bf16_f32 v112, v80, v81
    v_cvt_pk_bf16_f32 v113, v82, v83
    v_mfma_f32_32x32x16_bf16 v[64:79], v[188:191], v[116:119], v[64:79]
    s_mov_b64 exec, s[84:85]
    buffer_load_dwordx4 v[184:187], v152, s[76:79], s60 offen sc1
    buffer_load_dwordx4 v[188:191], v153, s[76:79], s60 offen sc1
    s_mov_b64 exec, -1
    v_exp_f32 v84, v84
    v_exp_f32 v85, v85
    v_exp_f32 v86, v86
    v_exp_f32 v87, v87
    v_cvt_pk_bf16_f32 v114, v84, v85
    v_cvt_pk_bf16_f32 v115, v86, v87
    v_mfma_f32_32x32x16_bf16 v[96:111], v[196:199], v[236:239], v[96:111]
    v_exp_f32 v88, v88
    v_exp_f32 v89, v89
    v_exp_f32 v90, v90
    v_exp_f32 v91, v91
    v_cvt_pk_bf16_f32 v116, v88, v89
    v_cvt_pk_bf16_f32 v117, v90, v91
    s_waitcnt vmcnt(12)
    v_mfma_f32_32x32x16_bf16 v[16:31], v[160:163], v[112:115], v[16:31]
    v_exp_f32 v92, v92
    v_exp_f32 v93, v93
    v_exp_f32 v94, v94
    v_exp_f32 v95, v95
    v_cvt_pk_bf16_f32 v118, v92, v93
    v_cvt_pk_bf16_f32 v119, v94, v95
    v_mfma_f32_32x32x16_bf16 v[80:95], v[192:195], v[240:243], 0
    v_exp_f32 v96, v96
    v_exp_f32 v97, v97
    v_exp_f32 v98, v98
    v_exp_f32 v99, v99
    v_cvt_pk_bf16_f32 v112, v96, v97
    v_cvt_pk_bf16_f32 v113, v98, v99
    v_mfma_f32_32x32x16_bf16 v[16:31], v[164:167], v[116:119], v[16:31]
    v_exp_f32 v100, v100
    v_exp_f32 v101, v101
    v_exp_f32 v102, v102
    v_exp_f32 v103, v103
    v_cvt_pk_bf16_f32 v114, v100, v101
    v_cvt_pk_bf16_f32 v115, v102, v103
    v_mfma_f32_32x32x16_bf16 v[80:95], v[196:199], v[244:247], v[80:95]
    v_exp_f32 v104, v104
    v_exp_f32 v105, v105
    v_exp_f32 v106, v106
    v_exp_f32 v107, v107
    v_cvt_pk_bf16_f32 v116, v104, v105
    v_cvt_pk_bf16_f32 v117, v106, v107
    v_mfma_f32_32x32x16_bf16 v[32:47], v[160:163], v[112:115], v[32:47]
    v_exp_f32 v108, v108
    v_exp_f32 v109, v109
    v_exp_f32 v110, v110
    v_exp_f32 v111, v111
    v_cvt_pk_bf16_f32 v118, v108, v109
    v_cvt_pk_bf16_f32 v119, v110, v111
    v_mfma_f32_32x32x16_bf16 v[96:111], v[192:195], v[248:251], 0
    v_exp_f32 v80, v80
    v_exp_f32 v81, v81
    v_exp_f32 v82, v82
    v_exp_f32 v83, v83
    v_cvt_pk_bf16_f32 v112, v80, v81
    v_cvt_pk_bf16_f32 v113, v82, v83
    v_mfma_f32_32x32x16_bf16 v[32:47], v[164:167], v[116:119], v[32:47]
    v_exp_f32 v84, v84
    v_exp_f32 v85, v85
    v_exp_f32 v86, v86
    v_exp_f32 v87, v87
    v_cvt_pk_bf16_f32 v114, v84, v85
    v_cvt_pk_bf16_f32 v115, v86, v87
    v_mfma_f32_32x32x16_bf16 v[96:111], v[196:199], v[252:255], v[96:111]
    v_exp_f32 v88, v88
    v_exp_f32 v89, v89
    v_exp_f32 v90, v90
    v_exp_f32 v91, v91
    v_cvt_pk_bf16_f32 v116, v88, v89
    v_cvt_pk_bf16_f32 v117, v90, v91
    v_mfma_f32_32x32x16_bf16 v[48:63], v[160:163], v[112:115], v[48:63]
    v_exp_f32 v92, v92
    v_exp_f32 v93, v93
    v_exp_f32 v94, v94
    v_exp_f32 v95, v95
    v_cvt_pk_bf16_f32 v118, v92, v93
    v_cvt_pk_bf16_f32 v119, v94, v95
    s_waitcnt vmcnt(10)
    v_mfma_f32_32x32x16_bf16 v[80:95], v[200:203], v[224:227], 0
    v_exp_f32 v96, v96
    v_exp_f32 v97, v97
    v_exp_f32 v98, v98
    v_exp_f32 v99, v99
    v_cvt_pk_bf16_f32 v112, v96, v97
    v_cvt_pk_bf16_f32 v113, v98, v99
    v_mfma_f32_32x32x16_bf16 v[48:63], v[164:167], v[116:119], v[48:63]
    v_exp_f32 v100, v100
    v_exp_f32 v101, v101
    v_exp_f32 v102, v102
    v_exp_f32 v103, v103
    v_cvt_pk_bf16_f32 v114, v100, v101
    v_cvt_pk_bf16_f32 v115, v102, v103
    v_mfma_f32_32x32x16_bf16 v[80:95], v[204:207], v[228:231], v[80:95]
    v_exp_f32 v104, v104
    v_exp_f32 v105, v105
    v_exp_f32 v106, v106
    v_exp_f32 v107, v107
    v_cvt_pk_bf16_f32 v116, v104, v105
    v_cvt_pk_bf16_f32 v117, v106, v107
    v_mfma_f32_32x32x16_bf16 v[64:79], v[160:163], v[112:115], v[64:79]
    v_exp_f32 v108, v108
    v_exp_f32 v109, v109
    v_exp_f32 v110, v110
    v_exp_f32 v111, v111
    v_cvt_pk_bf16_f32 v118, v108, v109
    v_cvt_pk_bf16_f32 v119, v110, v111
    v_mfma_f32_32x32x16_bf16 v[96:111], v[200:203], v[232:235], 0
    v_exp_f32 v80, v80
    v_exp_f32 v81, v81
    v_exp_f32 v82, v82
    v_exp_f32 v83, v83
    v_cvt_pk_bf16_f32 v112, v80, v81
    v_cvt_pk_bf16_f32 v113, v82, v83
    v_mfma_f32_32x32x16_bf16 v[64:79], v[164:167], v[116:119], v[64:79]
    v_exp_f32 v84, v84
    v_exp_f32 v85, v85
    v_exp_f32 v86, v86
    v_exp_f32 v87, v87
    v_cvt_pk_bf16_f32 v114, v84, v85
    v_cvt_pk_bf16_f32 v115, v86, v87
    v_mfma_f32_32x32x16_bf16 v[96:111], v[204:207], v[236:239], v[96:111]
    v_exp_f32 v88, v88
    v_exp_f32 v89, v89
    v_exp_f32 v90, v90
    v_exp_f32 v91, v91
    v_cvt_pk_bf16_f32 v116, v88, v89
    v_cvt_pk_bf16_f32 v117, v90, v91
    s_waitcnt vmcnt(8)
    v_mfma_f32_32x32x16_bf16 v[16:31], v[168:171], v[112:115], v[16:31]
    v_exp_f32 v92, v92
    v_exp_f32 v93, v93
    v_exp_f32 v94, v94
    v_exp_f32 v95, v95
    v_cvt_pk_bf16_f32 v118, v92, v93
    v_cvt_pk_bf16_f32 v119, v94, v95
    v_mfma_f32_32x32x16_bf16 v[80:95], v[200:203], v[240:243], 0
    v_exp_f32 v96, v96
    v_exp_f32 v97, v97
    v_exp_f32 v98, v98
    v_exp_f32 v99, v99
    v_cvt_pk_bf16_f32 v112, v96, v97
    v_cvt_pk_bf16_f32 v113, v98, v99
    v_mfma_f32_32x32x16_bf16 v[16:31], v[172:175], v[116:119], v[16:31]
    v_exp_f32 v100, v100
    v_exp_f32 v101, v101
    v_exp_f32 v102, v102
    v_exp_f32 v103, v103
    v_cvt_pk_bf16_f32 v114, v100, v101
    v_cvt_pk_bf16_f32 v115, v102, v103
    v_mfma_f32_32x32x16_bf16 v[80:95], v[204:207], v[244:247], v[80:95]
    v_exp_f32 v104, v104
    v_exp_f32 v105, v105
    v_exp_f32 v106, v106
    v_exp_f32 v107, v107
    v_cvt_pk_bf16_f32 v116, v104, v105
    v_cvt_pk_bf16_f32 v117, v106, v107
    v_mfma_f32_32x32x16_bf16 v[32:47], v[168:171], v[112:115], v[32:47]
    v_exp_f32 v108, v108
    v_exp_f32 v109, v109
    v_exp_f32 v110, v110
    v_exp_f32 v111, v111
    v_cvt_pk_bf16_f32 v118, v108, v109
    v_cvt_pk_bf16_f32 v119, v110, v111
    v_mfma_f32_32x32x16_bf16 v[96:111], v[200:203], v[248:251], 0
    v_exp_f32 v80, v80
    v_exp_f32 v81, v81
    v_exp_f32 v82, v82
    v_exp_f32 v83, v83
    v_cvt_pk_bf16_f32 v112, v80, v81
    v_cvt_pk_bf16_f32 v113, v82, v83
    v_mfma_f32_32x32x16_bf16 v[32:47], v[172:175], v[116:119], v[32:47]
    v_exp_f32 v84, v84
    v_exp_f32 v85, v85
    v_exp_f32 v86, v86
    v_exp_f32 v87, v87
    v_cvt_pk_bf16_f32 v114, v84, v85
    v_cvt_pk_bf16_f32 v115, v86, v87
    v_mfma_f32_32x32x16_bf16 v[96:111], v[204:207], v[252:255], v[96:111]
    v_exp_f32 v88, v88
    v_exp_f32 v89, v89
    v_exp_f32 v90, v90
    v_exp_f32 v91, v91
    v_cvt_pk_bf16_f32 v116, v88, v89
    v_cvt_pk_bf16_f32 v117, v90, v91
    v_mfma_f32_32x32x16_bf16 v[48:63], v[168:171], v[112:115], v[48:63]
    v_exp_f32 v92, v92
    v_exp_f32 v93, v93
    v_exp_f32 v94, v94
    v_exp_f32 v95, v95
    v_cvt_pk_bf16_f32 v118, v92, v93
    v_cvt_pk_bf16_f32 v119, v94, v95
    s_waitcnt vmcnt(6)
    v_mfma_f32_32x32x16_bf16 v[80:95], v[208:211], v[224:227], 0
    v_exp_f32 v96, v96
    v_exp_f32 v97, v97
    v_exp_f32 v98, v98
    v_exp_f32 v99, v99
    v_cvt_pk_bf16_f32 v112, v96, v97
    v_cvt_pk_bf16_f32 v113, v98, v99
    v_mfma_f32_32x32x16_bf16 v[48:63], v[172:175], v[116:119], v[48:63]
    v_exp_f32 v100, v100
    v_exp_f32 v101, v101
    v_exp_f32 v102, v102
    v_exp_f32 v103, v103
    v_cvt_pk_bf16_f32 v114, v100, v101
    v_cvt_pk_bf16_f32 v115, v102, v103
    v_mfma_f32_32x32x16_bf16 v[80:95], v[212:215], v[228:231], v[80:95]
    v_exp_f32 v104, v104
    v_exp_f32 v105, v105
    v_exp_f32 v106, v106
    v_exp_f32 v107, v107
    v_cvt_pk_bf16_f32 v116, v104, v105
    v_cvt_pk_bf16_f32 v117, v106, v107
    v_mfma_f32_32x32x16_bf16 v[64:79], v[168:171], v[112:115], v[64:79]
    v_exp_f32 v108, v108
    v_exp_f32 v109, v109
    v_exp_f32 v110, v110
    v_exp_f32 v111, v111
    v_cvt_pk_bf16_f32 v118, v108, v109
    v_cvt_pk_bf16_f32 v119, v110, v111
    v_mfma_f32_32x32x16_bf16 v[96:111], v[208:211], v[232:235], 0
    v_exp_f32 v80, v80
    v_exp_f32 v81, v81
    v_exp_f32 v82, v82
    v_exp_f32 v83, v83
    v_cvt_pk_bf16_f32 v112, v80, v81
    v_cvt_pk_bf16_f32 v113, v82, v83
    v_mfma_f32_32x32x16_bf16 v[64:79], v[172:175], v[116:119], v[64:79]
    v_exp_f32 v84, v84
    v_exp_f32 v85, v85
    v_exp_f32 v86, v86
    v_exp_f32 v87, v87
    v_cvt_pk_bf16_f32 v114, v84, v85
    v_cvt_pk_bf16_f32 v115, v86, v87
    v_mfma_f32_32x32x16_bf16 v[96:111], v[212:215], v[236:239], v[96:111]
    v_exp_f32 v88, v88
    v_exp_f32 v89, v89
    v_exp_f32 v90, v90
    v_exp_f32 v91, v91
    v_cvt_pk_bf16_f32 v116, v88, v89
    v_cvt_pk_bf16_f32 v117, v90, v91
    s_waitcnt vmcnt(4)
    v_mfma_f32_32x32x16_bf16 v[16:31], v[176:179], v[112:115], v[16:31]
    v_exp_f32 v92, v92
    v_exp_f32 v93, v93
    v_exp_f32 v94, v94
    v_exp_f32 v95, v95
    v_cvt_pk_bf16_f32 v118, v92, v93
    v_cvt_pk_bf16_f32 v119, v94, v95
    v_mfma_f32_32x32x16_bf16 v[80:95], v[208:211], v[240:243], 0
    v_exp_f32 v96, v96
    v_exp_f32 v97, v97
    v_exp_f32 v98, v98
    v_exp_f32 v99, v99
    v_cvt_pk_bf16_f32 v112, v96, v97
    v_cvt_pk_bf16_f32 v113, v98, v99
    v_mfma_f32_32x32x16_bf16 v[16:31], v[180:183], v[116:119], v[16:31]
    v_exp_f32 v100, v100
    v_exp_f32 v101, v101
    v_exp_f32 v102, v102
    v_exp_f32 v103, v103
    v_cvt_pk_bf16_f32 v114, v100, v101
    v_cvt_pk_bf16_f32 v115, v102, v103
    v_mfma_f32_32x32x16_bf16 v[80:95], v[212:215], v[244:247], v[80:95]
    v_exp_f32 v104, v104
    v_exp_f32 v105, v105
    v_exp_f32 v106, v106
    v_exp_f32 v107, v107
    v_cvt_pk_bf16_f32 v116, v104, v105
    v_cvt_pk_bf16_f32 v117, v106, v107
    v_mfma_f32_32x32x16_bf16 v[32:47], v[176:179], v[112:115], v[32:47]
    v_exp_f32 v108, v108
    v_exp_f32 v109, v109
    v_exp_f32 v110, v110
    v_exp_f32 v111, v111
    v_cvt_pk_bf16_f32 v118, v108, v109
    v_cvt_pk_bf16_f32 v119, v110, v111
    v_mfma_f32_32x32x16_bf16 v[96:111], v[208:211], v[248:251], 0
    v_exp_f32 v80, v80
    v_exp_f32 v81, v81
    v_exp_f32 v82, v82
    v_exp_f32 v83, v83
    v_cvt_pk_bf16_f32 v112, v80, v81
    v_cvt_pk_bf16_f32 v113, v82, v83
    v_mfma_f32_32x32x16_bf16 v[32:47], v[180:183], v[116:119], v[32:47]
    v_exp_f32 v84, v84
    v_exp_f32 v85, v85
    v_exp_f32 v86, v86
    v_exp_f32 v87, v87
    v_cvt_pk_bf16_f32 v114, v84, v85
    v_cvt_pk_bf16_f32 v115, v86, v87
    v_mfma_f32_32x32x16_bf16 v[96:111], v[212:215], v[252:255], v[96:111]
    v_exp_f32 v88, v88
    v_exp_f32 v89, v89
    v_exp_f32 v90, v90
    v_exp_f32 v91, v91
    v_cvt_pk_bf16_f32 v116, v88, v89
    v_cvt_pk_bf16_f32 v117, v90, v91
    v_mfma_f32_32x32x16_bf16 v[48:63], v[176:179], v[112:115], v[48:63]
    v_exp_f32 v92, v92
    v_exp_f32 v93, v93
    v_exp_f32 v94, v94
    v_exp_f32 v95, v95
    v_cvt_pk_bf16_f32 v118, v92, v93
    v_cvt_pk_bf16_f32 v119, v94, v95
    s_waitcnt vmcnt(2)
    v_mfma_f32_32x32x16_bf16 v[80:95], v[216:219], v[224:227], 0
    v_exp_f32 v96, v96
    v_exp_f32 v97, v97
    v_exp_f32 v98, v98
    v_exp_f32 v99, v99
    v_cvt_pk_bf16_f32 v112, v96, v97
    v_cvt_pk_bf16_f32 v113, v98, v99
    v_mfma_f32_32x32x16_bf16 v[48:63], v[180:183], v[116:119], v[48:63]
    v_exp_f32 v100, v100
    v_exp_f32 v101, v101
    v_exp_f32 v102, v102
    v_exp_f32 v103, v103
    v_cvt_pk_bf16_f32 v114, v100, v101
    v_cvt_pk_bf16_f32 v115, v102, v103
    v_mfma_f32_32x32x16_bf16 v[80:95], v[220:223], v[228:231], v[80:95]
    v_exp_f32 v104, v104
    v_exp_f32 v105, v105
    v_exp_f32 v106, v106
    v_exp_f32 v107, v107
    v_cvt_pk_bf16_f32 v116, v104, v105
    v_cvt_pk_bf16_f32 v117, v106, v107
    v_mfma_f32_32x32x16_bf16 v[64:79], v[176:179], v[112:115], v[64:79]
    v_exp_f32 v108, v108
    v_exp_f32 v109, v109
    v_exp_f32 v110, v110
    v_exp_f32 v111, v111
    v_cvt_pk_bf16_f32 v118, v108, v109
    v_cvt_pk_bf16_f32 v119, v110, v111
    v_mfma_f32_32x32x16_bf16 v[96:111], v[216:219], v[232:235], 0
    v_exp_f32 v80, v80
    v_exp_f32 v81, v81
    v_exp_f32 v82, v82
    v_exp_f32 v83, v83
    v_cvt_pk_bf16_f32 v112, v80, v81
    v_cvt_pk_bf16_f32 v113, v82, v83
    v_mfma_f32_32x32x16_bf16 v[64:79], v[180:183], v[116:119], v[64:79]
    v_exp_f32 v84, v84
    v_exp_f32 v85, v85
    v_exp_f32 v86, v86
    v_exp_f32 v87, v87
    v_cvt_pk_bf16_f32 v114, v84, v85
    v_cvt_pk_bf16_f32 v115, v86, v87
    v_mfma_f32_32x32x16_bf16 v[96:111], v[220:223], v[236:239], v[96:111]
    v_exp_f32 v88, v88
    v_exp_f32 v89, v89
    v_exp_f32 v90, v90
    v_exp_f32 v91, v91
    v_cvt_pk_bf16_f32 v116, v88, v89
    v_cvt_pk_bf16_f32 v117, v90, v91
    s_waitcnt vmcnt(0)
    v_mfma_f32_32x32x16_bf16 v[16:31], v[184:187], v[112:115], v[16:31]
    v_exp_f32 v92, v92
    v_exp_f32 v93, v93
    v_exp_f32 v94, v94
    v_exp_f32 v95, v95
    v_cvt_pk_bf16_f32 v118, v92, v93
    v_cvt_pk_bf16_f32 v119, v94, v95
    v_mfma_f32_32x32x16_bf16 v[80:95], v[216:219], v[240:243], 0
    v_exp_f32 v96, v96
    v_exp_f32 v97, v97
    v_exp_f32 v98, v98
    v_exp_f32 v99, v99
    v_cvt_pk_bf16_f32 v112, v96, v97
    v_cvt_pk_bf16_f32 v113, v98, v99
    v_mfma_f32_32x32x16_bf16 v[16:31], v[188:191], v[116:119], v[16:31]
    v_exp_f32 v100, v100
    v_exp_f32 v101, v101
    v_exp_f32 v102, v102
    v_exp_f32 v103, v103
    v_cvt_pk_bf16_f32 v114, v100, v101
    v_cvt_pk_bf16_f32 v115, v102, v103
    v_mfma_f32_32x32x16_bf16 v[80:95], v[220:223], v[244:247], v[80:95]
    v_exp_f32 v104, v104
    v_exp_f32 v105, v105
    v_exp_f32 v106, v106
    v_exp_f32 v107, v107
    v_cvt_pk_bf16_f32 v116, v104, v105
    v_cvt_pk_bf16_f32 v117, v106, v107
    v_mfma_f32_32x32x16_bf16 v[32:47], v[184:187], v[112:115], v[32:47]
    v_exp_f32 v108, v108
    ds_write_b128 v154, v[16:19] offset:0
    v_exp_f32 v109, v109
    ds_write_b128 v154, v[20:23] offset:1024
    v_exp_f32 v110, v110
    ds_write_b128 v154, v[24:27] offset:2048
    v_exp_f32 v111, v111
    ds_write_b128 v154, v[28:31] offset:3072
    v_cvt_pk_bf16_f32 v118, v108, v109
    v_cvt_pk_bf16_f32 v119, v110, v111
    v_mfma_f32_32x32x16_bf16 v[96:111], v[216:219], v[248:251], 0
    v_exp_f32 v80, v80
    v_exp_f32 v81, v81
    v_exp_f32 v82, v82
    v_exp_f32 v83, v83
    v_cvt_pk_bf16_f32 v112, v80, v81
    v_cvt_pk_bf16_f32 v113, v82, v83
    v_mfma_f32_32x32x16_bf16 v[32:47], v[188:191], v[116:119], v[32:47]
    v_exp_f32 v84, v84
    v_exp_f32 v85, v85
    v_exp_f32 v86, v86
    v_exp_f32 v87, v87
    v_cvt_pk_bf16_f32 v114, v84, v85
    v_cvt_pk_bf16_f32 v115, v86, v87
    v_mfma_f32_32x32x16_bf16 v[96:111], v[220:223], v[252:255], v[96:111]
    v_exp_f32 v88, v88
    v_exp_f32 v89, v89
    v_exp_f32 v90, v90
    v_exp_f32 v91, v91
    v_cvt_pk_bf16_f32 v116, v88, v89
    v_cvt_pk_bf16_f32 v117, v90, v91
    v_mfma_f32_32x32x16_bf16 v[48:63], v[184:187], v[112:115], v[48:63]
    v_exp_f32 v92, v92
    ds_write_b128 v155, v[32:35] offset:0
    v_exp_f32 v93, v93
    ds_write_b128 v155, v[36:39] offset:1024
    v_exp_f32 v94, v94
    ds_write_b128 v155, v[40:43] offset:2048
    v_exp_f32 v95, v95
    ds_write_b128 v155, v[44:47] offset:3072
    v_cvt_pk_bf16_f32 v118, v92, v93
    v_cvt_pk_bf16_f32 v119, v94, v95
    v_exp_f32 v96, v96
    v_exp_f32 v97, v97
    v_exp_f32 v98, v98
    v_exp_f32 v99, v99
    v_cvt_pk_bf16_f32 v112, v96, v97
    v_cvt_pk_bf16_f32 v113, v98, v99
    v_mfma_f32_32x32x16_bf16 v[48:63], v[188:191], v[116:119], v[48:63]
    v_exp_f32 v100, v100
    v_exp_f32 v101, v101
    v_exp_f32 v102, v102
    v_exp_f32 v103, v103
    v_cvt_pk_bf16_f32 v114, v100, v101
    v_cvt_pk_bf16_f32 v115, v102, v103
    v_exp_f32 v104, v104
    v_exp_f32 v105, v105
    v_exp_f32 v106, v106
    v_exp_f32 v107, v107
    v_cvt_pk_bf16_f32 v116, v104, v105
    v_cvt_pk_bf16_f32 v117, v106, v107
    v_mfma_f32_32x32x16_bf16 v[64:79], v[184:187], v[112:115], v[64:79]
    v_exp_f32 v108, v108
    ds_write_b128 v156, v[48:51] offset:0
    v_exp_f32 v109, v109
    ds_write_b128 v156, v[52:55] offset:1024
    v_exp_f32 v110, v110
    ds_write_b128 v156, v[56:59] offset:2048
    v_exp_f32 v111, v111
    ds_write_b128 v156, v[60:63] offset:3072
    v_cvt_pk_bf16_f32 v118, v108, v109
    v_cvt_pk_bf16_f32 v119, v110, v111
    ds_write_b32 v158, v158
    ds_read_b32 v6, v159
    v_mfma_f32_32x32x16_bf16 v[64:79], v[188:191], v[116:119], v[64:79]
    s_waitcnt lgkmcnt(0)
    v_cmp_eq_u32 vcc, 0, v6
    s_nop 0
    s_cbranch_vccz gated_mix__mha_block__glu_gated_geglu__prompt_kernel_ok34
    s_mov_b32 s3, 131072
gated_mix__mha_block__glu_gated_geglu__prompt_kernel_again35:
    ds_read_b32 v6, v159
    s_waitcnt lgkmcnt(0)
    v_cmp_eq_u32 vcc, 0, v6
    s_nop 0
    s_cbranch_vccz gated_mix__mha_block__glu_gated_geglu__prompt_kernel_ok34
    s_sub_u32 s3, s3, 1
    s_cbranch_scc0 gated_mix__mha_block__glu_gated_geglu__prompt_kernel_again35
gated_mix__mha_block__glu_gated_geglu__prompt_kernel_ok34:
    ds_read_b128 v[172:175], v157 offset:3072
    ds_read_b128 v[188:191], v157 offset:7168
    ds_read_b128 v[204:207], v157 offset:11264
    ds_read_b128 v[160:163], v157 offset:0
    ds_read_b128 v[176:179], v157 offset:4096
    ds_read_b128 v[192:195], v157 offset:8192
    ds_read_b128 v[164:167], v157 offset:1024
    ds_read_b128 v[180:183], v157 offset:5120
    ds_read_b128 v[196:199], v157 offset:9216
    ds_read_b128 v[168:171], v157 offset:2048
    ds_read_b128 v[184:187], v157 offset:6144
    ds_read_b128 v[200:203], v157 offset:10240
    s_waitcnt lgkmcnt(10)
    v_add_f32 v172, v172, v188
    v_add_f32 v173, v173, v189
    v_add_f32 v174, v174, v190
    v_add_f32 v175, v175, v191
    s_waitcnt lgkmcnt(9)
    v_add_f32 v76, v76, v204
    v_add_f32 v77, v77, v205
    v_add_f32 v78, v78, v206
    v_add_f32 v79, v79, v207
    v_add_f32 v76, v76, v172
    v_add_f32 v77, v77, v173
    v_add_f32 v78, v78, v174
    v_add_f32 v79, v79, v175
    v_mov_b32 v8, v76
    v_mov_b32 v9, v76
    s_waitcnt lgkmcnt(7)
    v_add_f32 v160, v160, v176
    v_add_f32 v161, v161, v177
    v_add_f32 v162, v162, v178
    v_add_f32 v163, v163, v179
    s_waitcnt lgkmcnt(6)
    v_add_f32 v64, v64, v192
    v_add_f32 v65, v65, v193
    v_add_f32 v66, v66, v194
    v_add_f32 v67, v67, v195
    v_add_f32 v64, v64, v160
    v_add_f32 v65, v65, v161
    v_add_f32 v66, v66, v162
    v_add_f32 v67, v67, v163
    v_permlane32_swap_b32 v8, v9
    v_rcp_f32 v12, v9
    s_waitcnt lgkmcnt(4)
    v_add_f32 v164, v164, v180
    v_add_f32 v165, v165, v181
    v_add_f32 v166, v166, v182
    v_add_f32 v167, v167, v183
    s_waitcnt lgkmcnt(3)
    v_add_f32 v68, v68, v196
    v_add_f32 v69, v69, v197
    v_add_f32 v70, v70, v198
    v_add_f32 v71, v71, v199
    v_add_f32 v68, v68, v164
    v_add_f32 v69, v69, v165
    v_add_f32 v70, v70, v166
    v_add_f32 v71, v71, v167
    v_med3_f32 v8, v9, s62, v7
    v_mul_f32 v12, v12, v11
    v_cmp_neq_f32 vcc, v8, v9
    s_waitcnt lgkmcnt(1)
    v_add_f32 v168, v168, v184
    v_add_f32 v169, v169, v185
    v_add_f32 v170, v170, v186
    v_add_f32 v171, v171, v187
    s_waitcnt lgkmcnt(0)
    v_add_f32 v72, v72, v200
    v_add_f32 v73, v73, v201
    v_add_f32 v74, v74, v202
    v_add_f32 v75, v75, v203
    v_add_f32 v72, v72, v168
    v_add_f32 v73, v73, v169
    v_add_f32 v74, v74, v170
    v_add_f32 v75, v75, v171
    s_cbranch_vccnz gated_mix__mha_block__glu_gated_geglu__prompt_kernel_slow
gated_mix__mha_block__glu_gated_geglu__prompt_kernel_a_fin:
    s_nop 2
    v_mul_f32 v64, v64, v12
    v_mul_f32 v65, v65, v12
    v_mul_f32 v66, v66, v12
    v_mul_f32 v67, v67, v12
    v_mul_f32 v68, v68, v12
    v_mul_f32 v69, v69, v12
    v_mul_f32 v70, v70, v12
    v_mul_f32 v71, v71, v12
    v_cvt_pk_bf16_f32 v112, v64, v65
    v_cvt_pk_bf16_f32 v113, v66, v67
    v_cvt_pk_bf16_f32 v114, v68, v69
    v_cvt_pk_bf16_f32 v115, v70, v71
    buffer_store_dwordx4 v[112:115], v134, s[28:31], s86 offen sc1
    v_mul_f32 v72, v72, v12
    v_mul_f32 v73, v73, v12
    v_mul_f32 v74, v74, v12
    v_mul_f32 v75, v75, v12
    v_mul_f32 v76, v76, v12
    v_mul_f32 v77, v77, v12
    v_mul_f32 v78, v78, v12
    v_mul_f32 v79, v79, v12
    v_cvt_pk_bf16_f32 v116, v72, v73
    v_cvt_pk_bf16_f32 v117, v74, v75
    v_cvt_pk_bf16_f32 v118, v76, v77
    v_cvt_pk_bf16_f32 v119, v78, v79
    s_mov_b32 exec_lo, 0
    v_mov_b64 v[118:119], 0
    s_mov_b32 exec_lo, -1
    buffer_store_dwordx4 v[116:119], v134, s[28:31], s86 offen offset:1024 sc1
    s_lshl_b32 s56, s68, 5
    s_add_u32 s56, s56, s70
    s_lshl_b32 s54, s56, 7
    s_add_u32 s54, s54, 15761408
    v_lshlrev_b32 v5, 9, v0
    s_lshl_b32 s58, s56, 11
    s_add_u32 s58, s58, 12845056
    s_lshl_b32 s57, s70, 11
    s_waitcnt vmcnt(0)
    v_mov_b32 v8, 1
    s_mov_b64 exec, 1
    buffer_store_dword v8, off, s[28:31], s87 sc1
    s_mov_b64 exec, -1
    s_cmp_ge_u32 s69, 7
    s_cbranch_scc1 gated_mix__mha_block__glu_gated_geglu__prompt_kernel_a_done
    s_mov_b64 exec, 15
    buffer_load_dword v6, v5, s[28:31], s54 offen sc1
    s_mov_b64 exec, -1
    s_waitcnt lgkmcnt(0)
    s_barrier
    s_waitcnt vmcnt(0)
    s_mov_b64 exec, 15
    v_cmp_ne_u32 vcc, 1, v6
    s_nop 0
    s_cbranch_vccz gated_mix__mha_block__glu_gated_geglu__prompt_kernel_ok36
    s_mov_b32 s3, 131072
gated_mix__mha_block__glu_gated_geglu__prompt_kernel_again37:
    buffer_load_dword v6, v5, s[28:31], s54 offen sc1
    s_waitcnt vmcnt(0)
    v_cmp_ne_u32 vcc, 1, v6
    s_nop 0
    s_cbranch_vccz gated_mix__mha_block__glu_gated_geglu__prompt_kernel_ok36
    s_sub_u32 s3, s3, 1
    s_cbranch_scc0 gated_mix__mha_block__glu_gated_geglu__prompt_kernel_again37
gated_mix__mha_block__glu_gated_geglu__prompt_kernel_ok36:
    s_mov_b64 exec, -1
    s_add_u32 m0, s57, 57344
    s_add_u32 s56, s58, 0
    buffer_load_dwordx4 v134, s[28:31], s56 offen offset:0 sc1 lds
    buffer_load_dwordx4 v134, s[28:31], s56 offen offset:1024 sc1 lds
    s_add_u32 m0, s57, 65536
    s_add_u32 s56, s58, 8192
    buffer_load_dwordx4 v134, s[28:31], s56 offen offset:0 sc1 lds
    buffer_load_dwordx4 v134, s[28:31], s56 offen offset:1024 sc1 lds
    s_add_u32 m0, s57, 73728
    s_add_u32 s56, s58, 16384
    buffer_load_dwordx4 v134, s[28:31], s56 offen offset:0 sc1 lds
    buffer_load_dwordx4 v134, s[28:31], s56 offen offset:1024 sc1 lds
    s_add_u32 m0, s57, 81920
    s_add_u32 s56, s58, 24576
    buffer_load_dwordx4 v134, s[28:31], s56 offen offset:0 sc1 lds
    buffer_load_dwordx4 v134, s[28:31], s56 offen offset:1024 sc1 lds
    s_waitcnt vmcnt(6)
    s_barrier
    s_waitcnt vmcnt(4)
    s_barrier
    s_waitcnt vmcnt(2)
    s_barrier
    s_waitcnt vmcnt(0)
    s_barrier
gated_mix__mha_block__glu_gated_geglu__prompt_kernel_a_done:
    s_endpgm
gated_mix__mha_block__glu_gated_geglu__prompt_kernel_g_plain:
    s_add_u32 m0, s80, 0
    s_add_u32 s0, s82, 0
    buffer_load_dwordx4 v9, s[72:75], s0 offen lds
    buffer_load_dwordx4 v10, s[72:75], s0 offen offset:1024 lds
    s_add_u32 m0, s80, 2048
    s_add_u32 s0, s82, 14336
    buffer_load_dwordx4 v9, s[72:75], s0 offen lds
    buffer_load_dwordx4 v10, s[72:75], s0 offen offset:1024 lds
    s_add_u32 m0, s80, 4096
    s_add_u32 s0, s82, 28672
    buffer_load_dwordx4 v9, s[72:75], s0 offen lds
    buffer_load_dwordx4 v10, s[72:75], s0 offen offset:1024 lds
    s_add_u32 m0, s80, 6144
    s_add_u32 s0, s82, 43008
    buffer_load_dwordx4 v9, s[72:75], s0 offen lds
    buffer_load_dwordx4 v10, s[72:75], s0 offen offset:1024 lds
    s_add_u32 m0, s80, 8192
    s_add_u32 s0, s82, 57344
    buffer_load_dwordx4 v9, s[72:75], s0 offen lds
    buffer_load_dwordx4 v10, s[72:75], s0 offen offset:1024 lds
    s_add_u32 m0, s80, 10240
    s_add_u32 s0, s82, 71680
    buffer_load_dwordx4 v9, s[72:75], s0 offen lds
    buffer_load_dwordx4 v10, s[72:75], s0 offen offset:1024 lds
    s_setprio 2
    s_and_b32 s0, s2, 7
    s_lshr_b32 s1, s2, 3
    s_lshl_b32 s66, s0, 1
    s_lshr_b32 s67, s2, 7
    s_add_u32 s66, s66, s67
    s_and_b32 s67, s1, 15
    s_and_b32 s70, s26, 3
    s_lshl_b32 s0, s26, 8
    s_add_u32 s0, s0, 155648
    v_lshl_add_u32 v14, v0, 2, s0
    s_mov_b32 s76, s8
    s_mov_b32 s77, s9
    s_mov_b32 s78, 401408
    s_mov_b32 s79, 0x00020000
    s_and_b32 s1, s70, 1
    s_lshl_b32 s1, s1, 3
    v_and_b32 v5, 1, v0
    v_lshlrev_b32 v5, 2, v5
    v_bfe_u32 v6, v0, 1, 1
    v_add_u32 v5, v5, v6
    v_bfe_u32 v6, v0, 4, 1
    v_lshl_add_u32 v5, v6, 1, v5
    v_and_b32 v6, 8, v0
    v_xor_b32 v5, v5, v6
    v_xor_b32 v5, s1, v5
    v_lshrrev_b32 v6, 5, v0
    v_bfe_u32 v7, v0, 2, 2
    v_lshl_add_u32 v6, v6, 2, v7
    v_lshlrev_b32 v6, 7, v6
    v_lshl_add_u32 v11, v5, 3, v6
    s_lshl_b32 s0, s69, 7
    s_mul_i32 s83, s70, 100352
    s_add_u32 s83, s83, s0
    s_and_b32 s1, s70, 1
    s_lshl_b32 s86, s1, 6
    s_add_u32 s86, s86, s0
    s_lshr_b32 s0, s70, 1
    s_lshl_b32 s1, s68, 1
    s_add_u32 s0, s0, s1
    s_lshl_b32 s85, s0, 7
    s_add_u32 s85, s85, 14942208
    s_mul_i32 s0, s0, 28672
    s_add_u32 s86, s86, s0
    s_mul_i32 s84, s68, 229376
    s_mul_i32 s0, s70, 28672
    s_add_u32 s84, s84, s0
    s_add_u32 s84, s84, 5505024
    s_lshr_b32 s0, s68, 1
    s_lshl_b32 s0, s0, 4
    s_mul_i32 s1, s70, 7
    s_lshr_b32 s1, s1, 1
    s_add_u32 s0, s0, s1
    s_lshl_b32 s0, s0, 7
    s_add_u32 s0, s0, 15728640
    v_and_b32 v5, 3, v0
    v_lshl_add_u32 v12, v5, 7, s0
    v_and_b32 v8, 3, v0
    v_lshlrev_b32 v8, 6, v8
    buffer_load_dword v7, v8, s[48:51], 0 offen sc1
    s_waitcnt vmcnt(1)
    s_branch gated_mix__mha_block__glu_gated_geglu__prompt_kernel_g_go
gated_mix__mha_block__glu_gated_geglu__prompt_kernel_g_e2:
    v_mul_f32 v1, v64, v64
    v_mul_f32 v2, v65, v65
    v_mul_f32 v3, v66, v66
    v_mul_f32 v4, v67, v67
    v_fmamk_f32 v1, v1, 0xbdd2d3e8, v15
    v_fmamk_f32 v2, v2, 0xbdd2d3e8, v15
    v_fmamk_f32 v3, v3, 0xbdd2d3e8, v15
    v_fmamk_f32 v4, v4, 0xbdd2d3e8, v15
    v_mul_f32 v1, v1, v64
    v_mul_f32 v2, v2, v65
    v_mul_f32 v3, v3, v66
    v_mul_f32 v4, v4, v67
    v_exp_f32 v1, v1
    v_exp_f32 v2, v2
    v_exp_f32 v3, v3
    v_exp_f32 v4, v4
    v_mul_f32 v72, v64, v72
    v_mul_f32 v73, v65, v73
    v_mul_f32 v74, v66, v74
    v_mul_f32 v75, v67, v75
    v_add_f32 v1, 1.0, v1
    v_add_f32 v2, 1.0, v2
    v_add_f32 v3, 1.0, v3
    v_add_f32 v4, 1.0, v4
    v_rcp_f32 v1, v1
    v_rcp_f32 v2, v2
    v_rcp_f32 v3, v3
    v_rcp_f32 v4, v4
    v_mul_f32 v72, v72, v1
    v_mul_f32 v73, v73, v2
    v_mul_f32 v74, v74, v3
    v_mul_f32 v75, v75, v4
    v_cvt_pk_bf16_f32 v136, v72, v73
    v_cvt_pk_bf16_f32 v137, v74, v75
    v_mul_f32 v1, v68, v68
    v_mul_f32 v2, v69, v69
    v_mul_f32 v3, v70, v70
    v_mul_f32 v4, v71, v71
    v_fmamk_f32 v1, v1, 0xbdd2d3e8, v15
    v_fmamk_f32 v2, v2, 0xbdd2d3e8, v15
    v_fmamk_f32 v3, v3, 0xbdd2d3e8, v15
    v_fmamk_f32 v4, v4, 0xbdd2d3e8, v15
    v_mul_f32 v1, v1, v68
    v_mul_f32 v2, v2, v69
    v_mul_f32 v3, v3, v70
    v_mul_f32 v4, v4, v71
    v_exp_f32 v1, v1
    v_exp_f32 v2, v2
    v_exp_f32 v3, v3
    v_exp_f32 v4, v4
    v_mul_f32 v76, v68, v76
    v_mul_f32 v77, v69, v77
    v_mul_f32 v78, v70, v78
    v_mul_f32 v79, v71, v79
    v_add_f32 v1, 1.0, v1
    v_add_f32 v2, 1.0, v2
    v_add_f32 v3, 1.0, v3
    v_add_f32 v4, 1.0, v4
    v_rcp_f32 v1, v1
    v_rcp_f32 v2, v2
    v_rcp_f32 v3, v3
    v_rcp_f32 v4, v4
    v_mul_f32 v76, v76, v1
    v_mul_f32 v77, v77, v2
    v_mul_f32 v78, v78, v3
    v_mul_f32 v79, v79, v4
    v_cvt_pk_bf16_f32 v138, v76, v77
    v_cvt_pk_bf16_f32 v139, v78, v79
    s_nop 0
    v_permlane16_swap_b32 v136, v138
    v_permlane16_swap_b32 v137, v139
    v_mul_f32 v1, v80, v80
    v_mul_f32 v2, v81, v81
    v_mul_f32 v3, v82, v82
    v_mul_f32 v4, v83, v83
    v_fmamk_f32 v1, v1, 0xbdd2d3e8, v15
    v_fmamk_f32 v2, v2, 0xbdd2d3e8, v15
    v_fmamk_f32 v3, v3, 0xbdd2d3e8, v15
    v_fmamk_f32 v4, v4, 0xbdd2d3e8, v15
    v_mul_f32 v1, v1, v80
    v_mul_f32 v2, v2, v81
    v_mul_f32 v3, v3, v82
    v_mul_f32 v4, v4, v83
    v_exp_f32 v1, v1
    v_exp_f32 v2, v2
    v_exp_f32 v3, v3
    v_exp_f32 v4, v4
    v_mul_f32 v88, v80, v88
    v_mul_f32 v89, v81, v89
    v_mul_f32 v90, v82, v90
    v_mul_f32 v91, v83, v91
    v_add_f32 v1, 1.0, v1
    v_add_f32 v2, 1.0, v2
    v_add_f32 v3, 1.0, v3
    v_add_f32 v4, 1.0, v4
    v_rcp_f32 v1, v1
    v_rcp_f32 v2, v2
    v_rcp_f32 v3, v3
    v_rcp_f32 v4, v4
    v_mul_f32 v88, v88, v1
    v_mul_f32 v89, v89, v2
    v_mul_f32 v90, v90, v3
    v_mul_f32 v91, v91, v4
    v_cvt_pk_bf16_f32 v140, v88, v89
    v_cvt_pk_bf16_f32 v141, v90, v91
    v_mul_f32 v1, v84, v84
    v_mul_f32 v2, v85, v85
    v_mul_f32 v3, v86, v86
    v_mul_f32 v4, v87, v87
    v_fmamk_f32 v1, v1, 0xbdd2d3e8, v15
    v_fmamk_f32 v2, v2, 0xbdd2d3e8, v15
    v_fmamk_f32 v3, v3, 0xbdd2d3e8, v15
    v_fmamk_f32 v4, v4, 0xbdd2d3e8, v15
    v_mul_f32 v1, v1, v84
    v_mul_f32 v2, v2, v85
    v_mul_f32 v3, v3, v86
    v_mul_f32 v4, v4, v87
    v_exp_f32 v1, v1
    v_exp_f32 v2, v2
    v_exp_f32 v3, v3
    v_exp_f32 v4, v4
    v_mul_f32 v92, v84, v92
    v_mul_f32 v93, v85, v93
    v_mul_f32 v94, v86, v94
    v_mul_f32 v95, v87, v95
    v_add_f32 v1, 1.0, v1
    v_add_f32 v2, 1.0, v2
    v_add_f32 v3, 1.0, v3
    v_add_f32 v4, 1.0, v4
    v_rcp_f32 v1, v1
    v_rcp_f32 v2, v2
    v_rcp_f32 v3, v3
    v_rcp_f32 v4, v4
    v_mul_f32 v92, v92, v1
    v_mul_f32 v93, v93, v2
    v_mul_f32 v94, v94, v3
    v_mul_f32 v95, v95, v4
    v_cvt_pk_bf16_f32 v142, v92, v93
    v_cvt_pk_bf16_f32 v143, v94, v95
    s_nop 0
    v_permlane16_swap_b32 v140, v142
    v_permlane16_swap_b32 v141, v143
    s_add_u32 s59, s63, 4096
    buffer_store_dwordx4 v[136:139], v134, s[28:31], s59 offen sc1
    s_add_u32 s59, s63, 5120
    buffer_store_dwordx4 v[140:143], v134, s[28:31], s59 offen sc1
    s_setprio 2
    s_and_b32 s0, s2, 7
    s_lshr_b32 s1, s2, 3
    s_lshl_b32 s66, s0, 1
    s_lshr_b32 s67, s2, 7
    s_add_u32 s66, s66, s67
    s_and_b32 s67, s1, 15
    s_and_b32 s70, s26, 3
    s_lshl_b32 s0, s26, 8
    s_add_u32 s0, s0, 155648
    v_lshl_add_u32 v14, v0, 2, s0
    s_mov_b32 s76, s8
    s_mov_b32 s77, s9
    s_mov_b32 s78, 401408
    s_mov_b32 s79, 0x00020000
    s_and_b32 s1, s70, 1
    s_lshl_b32 s1, s1, 3
    v_and_b32 v5, 1, v0
    v_lshlrev_b32 v5, 2, v5
    v_bfe_u32 v6, v0, 1, 1
    v_add_u32 v5, v5, v6
    v_bfe_u32 v6, v0, 4, 1
    v_lshl_add_u32 v5, v6, 1, v5
    v_and_b32 v6, 8, v0
    v_xor_b32 v5, v5, v6
    v_xor_b32 v5, s1, v5
    v_lshrrev_b32 v6, 5, v0
    v_bfe_u32 v7, v0, 2, 2
    v_lshl_add_u32 v6, v6, 2, v7
    v_lshlrev_b32 v6, 7, v6
    v_lshl_add_u32 v11, v5, 3, v6
    s_lshl_b32 s0, s69, 7
    s_mul_i32 s83, s70, 100352
    s_add_u32 s83, s83, s0
    s_and_b32 s1, s70, 1
    s_lshl_b32 s86, s1, 6
    s_add_u32 s86, s86, s0
    s_lshr_b32 s0, s70, 1
    s_lshl_b32 s1, s68, 1
    s_add_u32 s0, s0, s1
    s_lshl_b32 s85, s0, 7
    s_add_u32 s85, s85, 14942208
    s_mul_i32 s0, s0, 28672
    s_add_u32 s86, s86, s0
    s_mul_i32 s84, s68, 229376
    s_mul_i32 s0, s70, 28672
    s_add_u32 s84, s84, s0
    s_add_u32 s84, s84, 5505024
    s_lshr_b32 s0, s68, 1
    s_lshl_b32 s0, s0, 4
    s_mul_i32 s1, s70, 7
    s_lshr_b32 s1, s1, 1
    s_add_u32 s0, s0, s1
    s_lshl_b32 s0, s0, 7
    s_add_u32 s0, s0, 15728640
    v_and_b32 v5, 3, v0
    v_lshl_add_u32 v12, v5, 7, s0
    v_and_b32 v8, 3, v0
    v_lshlrev_b32 v8, 6, v8
    buffer_load_dword v7, v8, s[48:51], 0 offen sc1
    s_waitcnt vmcnt(1)
gated_mix__mha_block__glu_gated_geglu__prompt_kernel_g_go:
    ds_write_b32 v14, v14
    v_mov_b32 v15, v13
    v_xor_b32 v5, 64, v11
    v_add_u32 v244, s80, v11
    v_add_u32 v245, s80, v5
    v_and_b32 v13, 7, v0
    v_lshlrev_b32 v13, 8, v13
    v_add_u32 v13, 155648, v13
    ds_read_b64_tr_b16 v[160:161], v244 offset:0
    ds_read_b64_tr_b16 v[162:163], v244 offset:1024
    ds_read_b64_tr_b16 v[164:165], v245 offset:0
    ds_read_b64_tr_b16 v[166:167], v245 offset:1024
    ds_read_b64_tr_b16 v[168:169], v244 offset:2048
    ds_read_b64_tr_b16 v[170:171], v244 offset:3072
    ds_read_b64_tr_b16 v[172:173], v245 offset:2048
    ds_read_b64_tr_b16 v[174:175], v245 offset:3072
    ds_read_b64_tr_b16 v[176:177], v244 offset:4096
    ds_read_b64_tr_b16 v[178:179], v244 offset:5120
    ds_read_b64_tr_b16 v[180:181], v245 offset:4096
    ds_read_b64_tr_b16 v[182:183], v245 offset:5120
    ds_read_b64_tr_b16 v[184:185], v244 offset:6144
    ds_read_b64_tr_b16 v[186:187], v244 offset:7168
    ds_read_b64_tr_b16 v[188:189], v245 offset:6144
    ds_read_b64_tr_b16 v[190:191], v245 offset:7168
    ds_read_b64_tr_b16 v[192:193], v244 offset:8192
    ds_read_b64_tr_b16 v[194:195], v244 offset:9216
    ds_read_b64_tr_b16 v[196:197], v245 offset:8192
    ds_read_b64_tr_b16 v[198:199], v245 offset:9216
    ds_read_b64_tr_b16 v[200:201], v244 offset:10240
    ds_read_b64_tr_b16 v[202:203], v244 offset:11264
    ds_read_b64_tr_b16 v[204:205], v245 offset:10240
    ds_read_b64_tr_b16 v[206:207], v245 offset:11264
    v_mov_b32 v1, v134
    v_add_u32 v246, s81, v11
    v_add_u32 v247, s81, v5
    s_lshr_b32 s56, s70, 1
    s_mul_i32 s56, s56, 114688
    v_add_u32 v242, s56, v1
    s_sub_u32 s56, 114688, s56
    v_add_u32 v243, s56, v1
    s_lshl_b32 s56, s70, 8
    s_add_u32 s56, s56, 158720
    v_lshl_add_u32 v2, v0, 2, s56
    v_and_b32 v3, 3, v0
    v_lshlrev_b32 v3, 8, v3
    v_add_u32 v3, 158720, v3
    ds_read_b32 v6, v13
    s_waitcnt lgkmcnt(0)
    v_cmp_eq_u32 vcc, 0, v6
    s_nop 0
    s_cbranch_vccz gated_mix__mha_block__glu_gated_geglu__prompt_kernel_ok38
    s_mov_b32 s3, 131072
gated_mix__mha_block__glu_gated_geglu__prompt_kernel_again39:
    s_sleep 1
    ds_read_b32 v6, v13
    s_waitcnt lgkmcnt(0)
    v_cmp_eq_u32 vcc, 0, v6
    s_nop 0
    s_cbranch_vccz gated_mix__mha_block__glu_gated_geglu__prompt_kernel_ok38
    s_sub_u32 s3, s3, 1
    s_cbranch_scc0 gated_mix__mha_block__glu_gated_geglu__prompt_kernel_again39
gated_mix__mha_block__glu_gated_geglu__prompt_kernel_ok38:
    s_cmp_lg_u32 s26, 4
    s_cbranch_scc1 gated_mix__mha_block__glu_gated_geglu__prompt_kernel_skip40
    v_mov_b32 v5, 2
    s_mov_b64 exec, 1
    buffer_store_dword v5, off, s[28:31], s27 sc1
    s_mov_b64 exec, -1
gated_mix__mha_block__glu_gated_geglu__prompt_kernel_skip40:
    s_cmp_ge_u32 s69, 7
    s_cbranch_scc1 gated_mix__mha_block__glu_gated_geglu__prompt_kernel_exit
    s_waitcnt vmcnt(0)
    v_cmp_gt_u32 vcc, 64, v7
    s_nop 0
    s_cbranch_vccz gated_mix__mha_block__glu_gated_geglu__prompt_kernel_ok41
    s_mov_b32 s3, 131072
gated_mix__mha_block__glu_gated_geglu__prompt_kernel_again42:
    buffer_load_dword v7, v8, s[48:51], 0 offen sc1
    s_waitcnt vmcnt(0)
    v_cmp_gt_u32 vcc, 64, v7
    s_nop 0
    s_cbranch_vccz gated_mix__mha_block__glu_gated_geglu__prompt_kernel_ok41
    s_sub_u32 s3, s3, 1
    s_cbranch_scc0 gated_mix__mha_block__glu_gated_geglu__prompt_kernel_again42
gated_mix__mha_block__glu_gated_geglu__prompt_kernel_ok41:
    v_and_b32 v5, 31, v0
    v_lshlrev_b32 v5, 2, v5
    buffer_load_dword v248, v5, s[28:31], s85 offen sc1
    v_add_u32 v240, s80, v1
    v_subrev_u32 v241, 1024, v3
    s_xor_b32 s56, s70, 1
    s_mul_i32 s56, s56, 12288
    s_add_u32 s56, s56, 57344
    v_add_u32 v250, s56, v1
    s_xor_b32 s56, s70, 2
    s_mul_i32 s56, s56, 12288
    s_add_u32 s56, s56, 61440
    v_add_u32 v251, s56, v1
    s_xor_b32 s56, s70, 3
    s_mul_i32 s56, s56, 12288
    s_add_u32 s56, s56, 65536
    v_add_u32 v252, s56, v1
    s_lshl_b32 s56, s68, 5
    s_add_u32 s56, s56, s70
    s_lshl_b32 s54, s56, 7
    s_add_u32 s54, s54, 15763456
    v_lshlrev_b32 v254, 9, v0
    s_lshl_b32 s10, s56, 11
    s_add_u32 s10, s10, 12877824
    s_lshl_b32 s11, s70, 11
    s_mov_b32 s48, s20
    s_mov_b32 s49, s21
    s_mov_b32 s50, 1835008
    s_mov_b32 s51, 0x00020000
    s_lshr_b32 s56, s70, 1
    s_lshl_b32 s60, s56, 15
    s_add_u32 s60, s60, 57344
    v_add_u32 v14, s60, v1
    s_mul_i32 s56, s70, 2560
    s_add_u32 s56, s56, 131072
    v_and_b32 v7, 31, v0
    v_mul_u32_u24 v7, 80, v7
    v_lshrrev_b32 v8, 5, v0
    v_lshl_add_u32 v7, v8, 5, v7
    v_add_u32 v7, s56, v7
    v_lshrrev_b32 v4, 2, v0
    v_and_b32 v15, 3, v0
    v_lshlrev_b32 v15, 4, v15
    v_mul_u32_u24 v8, 80, v4
    v_add_u32 v8, v8, v15
    v_add_u32 v8, s56, v8
    v_mul_u32_u24 v4, 896, v4
    v_add_u32 v253, v4, v15
    s_add_u32 s60, s86, 14336
    s_add_u32 m0, s81, 0
    s_add_u32 s0, s82, 86016
    buffer_load_dwordx4 v9, s[72:75], s0 offen lds
    buffer_load_dwordx4 v10, s[72:75], s0 offen offset:1024 lds
    s_add_u32 m0, s81, 2048
    s_add_u32 s0, s82, 100352
    buffer_load_dwordx4 v9, s[72:75], s0 offen lds
    buffer_load_dwordx4 v10, s[72:75], s0 offen offset:1024 lds
    s_add_u32 m0, s81, 4096
    s_add_u32 s0, s82, 114688
    buffer_load_dwordx4 v9, s[72:75], s0 offen lds
    buffer_load_dwordx4 v10, s[72:75], s0 offen offset:1024 lds
    s_waitcnt vmcnt(4)
    s_add_u32 m0, s81, 6144
    s_add_u32 s0, s82, 129024
    buffer_load_dwordx4 v9, s[72:75], s0 offen lds
    buffer_load_dwordx4 v10, s[72:75], s0 offen offset:1024 lds
    s_waitcnt vmcnt(4)
    s_add_u32 m0, s81, 8192
    s_add_u32 s0, s82, 143360
    buffer_load_dwordx4 v9, s[72:75], s0 offen lds
    buffer_load_dwordx4 v10, s[72:75], s0 offen offset:1024 lds
    s_waitcnt vmcnt(4)
    s_add_u32 m0, s81, 10240
    s_add_u32 s0, s82, 157696
    buffer_load_dwordx4 v9, s[72:75], s0 offen lds
    buffer_load_dwordx4 v10, s[72:75], s0 offen offset:1024 lds
    s_waitcnt vmcnt(4)
    s_add_u32 m0, s81, 12288
    s_add_u32 s0, s82, 172032
    buffer_load_dwordx4 v9, s[72:75], s0 offen lds
    buffer_load_dwordx4 v10, s[72:75], s0 offen offset:1024 lds
    ds_read_b64_tr_b16 v[208:209], v246 offset:0
    ds_read_b64_tr_b16 v[210:211], v246 offset:1024
    ds_read_b64_tr_b16 v[212:213], v247 offset:0
    ds_read_b64_tr_b16 v[214:215], v247 offset:1024
    s_waitcnt vmcnt(4)
    s_add_u32 m0, s80, 0
    s_add_u32 s0, s82, 186368
    buffer_load_dwordx4 v9, s[72:75], s0 offen lds
    buffer_load_dwordx4 v10, s[72:75], s0 offen offset:1024 lds
    ds_read_b64_tr_b16 v[216:217], v246 offset:2048
    ds_read_b64_tr_b16 v[218:219], v246 offset:3072
    ds_read_b64_tr_b16 v[220:221], v247 offset:2048
    ds_read_b64_tr_b16 v[222:223], v247 offset:3072
    s_waitcnt vmcnt(4)
    s_add_u32 m0, s80, 2048
    s_add_u32 s0, s82, 200704
    buffer_load_dwordx4 v9, s[72:75], s0 offen lds
    buffer_load_dwordx4 v10, s[72:75], s0 offen offset:1024 lds
    ds_read_b64_tr_b16 v[224:225], v246 offset:4096
    ds_read_b64_tr_b16 v[226:227], v246 offset:5120
    ds_read_b64_tr_b16 v[228:229], v247 offset:4096
    ds_read_b64_tr_b16 v[230:231], v247 offset:5120
    s_waitcnt vmcnt(4)
    s_add_u32 m0, s80, 4096
    s_add_u32 s0, s82, 215040
    buffer_load_dwordx4 v9, s[72:75], s0 offen lds
    buffer_load_dwordx4 v10, s[72:75], s0 offen offset:1024 lds
    ds_read_b64_tr_b16 v[232:233], v246 offset:6144
    ds_read_b64_tr_b16 v[234:235], v246 offset:7168
    ds_read_b64_tr_b16 v[236:237], v247 offset:6144
    ds_read_b64_tr_b16 v[238:239], v247 offset:7168
    s_waitcnt vmcnt(4)
    s_add_u32 m0, s80, 6144
    s_add_u32 s0, s82, 229376
    buffer_load_dwordx4 v9, s[72:75], s0 offen lds
    buffer_load_dwordx4 v10, s[72:75], s0 offen offset:1024 lds
    s_waitcnt vmcnt(4)
    s_add_u32 m0, s80, 8192
    s_add_u32 s0, s82, 243712
    buffer_load_dwordx4 v9, s[72:75], s0 offen lds
    buffer_load_dwordx4 v10, s[72:75], s0 offen offset:1024 lds
    s_waitcnt vmcnt(4)
    s_add_u32 m0, s80, 10240
    s_add_u32 s0, s82, 258048
    buffer_load_dwordx4 v9, s[72:75], s0 offen lds
    buffer_load_dwordx4 v10, s[72:75], s0 offen offset:1024 lds
    s_waitcnt vmcnt(4)
    s_waitcnt lgkmcnt(12)
    s_add_u32 m0, s81, 0
    s_add_u32 s0, s82, 272384
    buffer_load_dwordx4 v9, s[72:75], s0 offen lds
    buffer_load_dwordx4 v10, s[72:75], s0 offen offset:1024 lds
    s_waitcnt vmcnt(4)
    s_waitcnt lgkmcnt(8)
    s_add_u32 m0, s81, 2048
    s_add_u32 s0, s82, 286720
    buffer_load_dwordx4 v9, s[72:75], s0 offen lds
    buffer_load_dwordx4 v10, s[72:75], s0 offen offset:1024 lds
    s_waitcnt vmcnt(4)
    s_waitcnt lgkmcnt(4)
    s_add_u32 m0, s81, 4096
    s_add_u32 s0, s82, 301056
    buffer_load_dwordx4 v9, s[72:75], s0 offen lds
    buffer_load_dwordx4 v10, s[72:75], s0 offen offset:1024 lds
    s_waitcnt vmcnt(4)
    s_waitcnt lgkmcnt(0)
    s_add_u32 m0, s81, 6144
    s_add_u32 s0, s82, 315392
    buffer_load_dwordx4 v9, s[72:75], s0 offen lds
    buffer_load_dwordx4 v10, s[72:75], s0 offen offset:1024 lds
    s_mov_b64 exec, 15
    buffer_load_dword v6, v12, s[28:31], 0 offen sc1
    s_mov_b64 exec, -1
    s_waitcnt vmcnt(0)
    s_mov_b64 exec, 15
    v_cmp_ne_u32 vcc, 2, v6
    s_nop 0
    s_cbranch_vccz gated_mix__mha_block__glu_gated_geglu__prompt_kernel_ok43
    s_mov_b32 s3, 131072
gated_mix__mha_block__glu_gated_geglu__prompt_kernel_again44:
    s_sleep 2
    buffer_load_dword v6, v12, s[28:31], 0 offen sc1
    s_waitcnt vmcnt(0)
    v_cmp_ne_u32 vcc, 2, v6
    s_nop 0
    s_cbranch_vccz gated_mix__mha_block__glu_gated_geglu__prompt_kernel_ok43
    s_sub_u32 s3, s3, 1
    s_cbranch_scc0 gated_mix__mha_block__glu_gated_geglu__prompt_kernel_again44
gated_mix__mha_block__glu_gated_geglu__prompt_kernel_ok43:
    s_mov_b64 exec, -1
    v_sub_f32 v248, 1.0, v248
    s_setprio 0
    s_add_u32 s56, s84, 0
    buffer_load_dwordx4 v[80:83], v242, s[28:31], s56 offen sc1
    buffer_load_dwordx4 v[84:87], v243, s[28:31], s56 offen sc1
    s_add_u32 s56, s84, 1024
    buffer_load_dwordx4 v[88:91], v242, s[28:31], s56 offen sc1
    buffer_load_dwordx4 v[92:95], v243, s[28:31], s56 offen sc1
    s_waitcnt vmcnt(3)
    v_mfma_f32_32x32x16_bf16 v[16:31], v[160:163], v[80:83], 0
    v_mfma_f32_32x32x16_bf16 v[32:47], v[164:167], v[80:83], 0
    s_waitcnt vmcnt(2)
    v_mfma_f32_32x32x16_bf16 v[48:63], v[160:163], v[84:87], 0
    v_mfma_f32_32x32x16_bf16 v[64:79], v[164:167], v[84:87], 0
    s_add_u32 s56, s84, 2048
    buffer_load_dwordx4 v[96:99], v242, s[28:31], s56 offen sc1
    buffer_load_dwordx4 v[100:103], v243, s[28:31], s56 offen sc1
    ds_read_b64_tr_b16 v[160:161], v246 offset:8192
    ds_read_b64_tr_b16 v[162:163], v246 offset:9216
    ds_read_b64_tr_b16 v[164:165], v247 offset:8192
    ds_read_b64_tr_b16 v[166:167], v247 offset:9216
    s_waitcnt vmcnt(3)
    v_mfma_f32_32x32x16_bf16 v[16:31], v[168:171], v[88:91], v[16:31]
    v_mfma_f32_32x32x16_bf16 v[32:47], v[172:175], v[88:91], v[32:47]
    s_waitcnt vmcnt(2)
    v_mfma_f32_32x32x16_bf16 v[48:63], v[168:171], v[92:95], v[48:63]
    v_mfma_f32_32x32x16_bf16 v[64:79], v[172:175], v[92:95], v[64:79]
    s_add_u32 s56, s84, 3072
    buffer_load_dwordx4 v[104:107], v242, s[28:31], s56 offen sc1
    buffer_load_dwordx4 v[108:111], v243, s[28:31], s56 offen sc1
    ds_read_b64_tr_b16 v[168:169], v246 offset:10240
    ds_read_b64_tr_b16 v[170:171], v246 offset:11264
    ds_read_b64_tr_b16 v[172:173], v247 offset:10240
    ds_read_b64_tr_b16 v[174:175], v247 offset:11264
    s_waitcnt lgkmcnt(4)
    s_add_u32 m0, s81, 8192
    s_add_u32 s0, s82, 329728
    buffer_load_dwordx4 v9, s[72:75], s0 offen lds
    buffer_load_dwordx4 v10, s[72:75], s0 offen offset:1024 lds
    s_waitcnt vmcnt(5)
    v_mfma_f32_32x32x16_bf16 v[16:31], v[176:179], v[96:99], v[16:31]
    v_mfma_f32_32x32x16_bf16 v[32:47], v[180:183], v[96:99], v[32:47]
    s_waitcnt vmcnt(4)
    v_mfma_f32_32x32x16_bf16 v[48:63], v[176:179], v[100:103], v[48:63]
    v_mfma_f32_32x32x16_bf16 v[64:79], v[180:183], v[100:103], v[64:79]
    s_add_u32 s56, s84, 4096
    buffer_load_dwordx4 v[112:115], v242, s[28:31], s56 offen sc1
    buffer_load_dwordx4 v[116:119], v243, s[28:31], s56 offen sc1
    ds_read_b64_tr_b16 v[176:177], v246 offset:12288
    ds_read_b64_tr_b16 v[178:179], v246 offset:13312
    ds_read_b64_tr_b16 v[180:181], v247 offset:12288
    ds_read_b64_tr_b16 v[182:183], v247 offset:13312
    s_waitcnt lgkmcnt(4)
    s_add_u32 m0, s81, 10240
    s_add_u32 s0, s82, 344064
    buffer_load_dwordx4 v9, s[72:75], s0 offen lds
    buffer_load_dwordx4 v10, s[72:75], s0 offen offset:1024 lds
    s_waitcnt vmcnt(7)
    v_mfma_f32_32x32x16_bf16 v[16:31], v[184:187], v[104:107], v[16:31]
    v_mfma_f32_32x32x16_bf16 v[32:47], v[188:191], v[104:107], v[32:47]
    s_waitcnt vmcnt(6)
    v_mfma_f32_32x32x16_bf16 v[48:63], v[184:187], v[108:111], v[48:63]
    v_mfma_f32_32x32x16_bf16 v[64:79], v[188:191], v[108:111], v[64:79]
    s_add_u32 s56, s84, 5120
    buffer_load_dwordx4 v[120:123], v242, s[28:31], s56 offen sc1
    buffer_load_dwordx4 v[124:127], v243, s[28:31], s56 offen sc1
    ds_read_b64_tr_b16 v[184:185], v244 offset:0
    ds_read_b64_tr_b16 v[186:187], v244 offset:1024
    ds_read_b64_tr_b16 v[188:189], v245 offset:0
    ds_read_b64_tr_b16 v[190:191], v245 offset:1024
    s_waitcnt lgkmcnt(4)
    s_add_u32 m0, s81, 12288
    s_add_u32 s0, s82, 358400
    buffer_load_dwordx4 v9, s[72:75], s0 offen lds
    buffer_load_dwordx4 v10, s[72:75], s0 offen offset:1024 lds
    s_waitcnt vmcnt(7)
    v_mfma_f32_32x32x16_bf16 v[16:31], v[192:195], v[112:115], v[16:31]
    v_mfma_f32_32x32x16_bf16 v[32:47], v[196:199], v[112:115], v[32:47]
    s_waitcnt vmcnt(6)
    v_mfma_f32_32x32x16_bf16 v[48:63], v[192:195], v[116:119], v[48:63]
    v_mfma_f32_32x32x16_bf16 v[64:79], v[196:199], v[116:119], v[64:79]
    s_add_u32 s56, s84, 6144
    buffer_load_dwordx4 v[128:131], v242, s[28:31], s56 offen sc1
    buffer_load_dwordx4 v[132:135], v243, s[28:31], s56 offen sc1
    ds_read_b64_tr_b16 v[192:193], v244 offset:2048
    ds_read_b64_tr_b16 v[194:195], v244 offset:3072
    ds_read_b64_tr_b16 v[196:197], v245 offset:2048
    ds_read_b64_tr_b16 v[198:199], v245 offset:3072
    s_waitcnt lgkmcnt(4)
    s_add_u32 m0, s80, 0
    s_add_u32 s0, s82, 372736
    buffer_load_dwordx4 v9, s[72:75], s0 offen lds
    buffer_load_dwordx4 v10, s[72:75], s0 offen offset:1024 lds
    s_waitcnt vmcnt(7)
    v_mfma_f32_32x32x16_bf16 v[16:31], v[200:203], v[120:123], v[16:31]
    v_mfma_f32_32x32x16_bf16 v[32:47], v[204:207], v[120:123], v[32:47]
    s_waitcnt vmcnt(6)
    v_mfma_f32_32x32x16_bf16 v[48:63], v[200:203], v[124:127], v[48:63]
    v_mfma_f32_32x32x16_bf16 v[64:79], v[204:207], v[124:127], v[64:79]
    s_add_u32 s56, s84, 7168
    buffer_load_dwordx4 v[136:139], v242, s[28:31], s56 offen sc1
    buffer_load_dwordx4 v[140:143], v243, s[28:31], s56 offen sc1
    ds_read_b64_tr_b16 v[200:201], v244 offset:4096
    ds_read_b64_tr_b16 v[202:203], v244 offset:5120
    ds_read_b64_tr_b16 v[204:205], v245 offset:4096
    ds_read_b64_tr_b16 v[206:207], v245 offset:5120
    s_waitcnt lgkmcnt(4)
    s_add_u32 m0, s80, 2048
    s_add_u32 s0, s82, 387072
    buffer_load_dwordx4 v9, s[72:75], s0 offen lds
    buffer_load_dwordx4 v10, s[72:75], s0 offen offset:1024 lds
    s_waitcnt vmcnt(7)
    v_mfma_f32_32x32x16_bf16 v[16:31], v[208:211], v[128:131], v[16:31]
    v_mfma_f32_32x32x16_bf16 v[32:47], v[212:215], v[128:131], v[32:47]
    s_waitcnt vmcnt(6)
    v_mfma_f32_32x32x16_bf16 v[48:63], v[208:211], v[132:135], v[48:63]
    v_mfma_f32_32x32x16_bf16 v[64:79], v[212:215], v[132:135], v[64:79]
    s_add_u32 s56, s84, 8192
    buffer_load_dwordx4 v[144:147], v242, s[28:31], s56 offen sc1
    buffer_load_dwordx4 v[148:151], v243, s[28:31], s56 offen sc1
    ds_read_b64_tr_b16 v[208:209], v244 offset:6144
    ds_read_b64_tr_b16 v[210:211], v244 offset:7168
    ds_read_b64_tr_b16 v[212:213], v245 offset:6144
    ds_read_b64_tr_b16 v[214:215], v245 offset:7168
    s_waitcnt vmcnt(5)
    v_mfma_f32_32x32x16_bf16 v[16:31], v[216:219], v[136:139], v[16:31]
    v_mfma_f32_32x32x16_bf16 v[32:47], v[220:223], v[136:139], v[32:47]
    s_waitcnt vmcnt(4)
    v_mfma_f32_32x32x16_bf16 v[48:63], v[216:219], v[140:143], v[48:63]
    v_mfma_f32_32x32x16_bf16 v[64:79], v[220:223], v[140:143], v[64:79]
    s_add_u32 s56, s84, 9216
    buffer_load_dwordx4 v[152:155], v242, s[28:31], s56 offen sc1
    buffer_load_dwordx4 v[156:159], v243, s[28:31], s56 offen sc1
    ds_read_b64_tr_b16 v[216:217], v244 offset:8192
    ds_read_b64_tr_b16 v[218:219], v244 offset:9216
    ds_read_b64_tr_b16 v[220:221], v245 offset:8192
    ds_read_b64_tr_b16 v[222:223], v245 offset:9216
    s_waitcnt vmcnt(3)
    v_mfma_f32_32x32x16_bf16 v[16:31], v[224:227], v[144:147], v[16:31]
    v_mfma_f32_32x32x16_bf16 v[32:47], v[228:231], v[144:147], v[32:47]
    s_waitcnt vmcnt(2)
    v_mfma_f32_32x32x16_bf16 v[48:63], v[224:227], v[148:151], v[48:63]
    v_mfma_f32_32x32x16_bf16 v[64:79], v[228:231], v[148:151], v[64:79]
    s_add_u32 s56, s84, 10240
    buffer_load_dwordx4 v[80:83], v242, s[28:31], s56 offen sc1
    buffer_load_dwordx4 v[84:87], v243, s[28:31], s56 offen sc1
    ds_read_b64_tr_b16 v[224:225], v244 offset:10240
    ds_read_b64_tr_b16 v[226:227], v244 offset:11264
    ds_read_b64_tr_b16 v[228:229], v245 offset:10240
    ds_read_b64_tr_b16 v[230:231], v245 offset:11264
    s_waitcnt vmcnt(3)
    v_mfma_f32_32x32x16_bf16 v[16:31], v[232:235], v[152:155], v[16:31]
    v_mfma_f32_32x32x16_bf16 v[32:47], v[236:239], v[152:155], v[32:47]
    s_waitcnt vmcnt(2)
    v_mfma_f32_32x32x16_bf16 v[48:63], v[232:235], v[156:159], v[48:63]
    v_mfma_f32_32x32x16_bf16 v[64:79], v[236:239], v[156:159], v[64:79]
    s_add_u32 s56, s84, 11264
    buffer_load_dwordx4 v[88:91], v242, s[28:31], s56 offen sc1
    buffer_load_dwordx4 v[92:95], v243, s[28:31], s56 offen sc1
    ds_read_b64_tr_b16 v[232:233], v246 offset:0
    ds_read_b64_tr_b16 v[234:235], v246 offset:1024
    ds_read_b64_tr_b16 v[236:237], v247 offset:0
    ds_read_b64_tr_b16 v[238:239], v247 offset:1024
    s_waitcnt vmcnt(3)
    v_mfma_f32_32x32x16_bf16 v[16:31], v[160:163], v[80:83], v[16:31]
    v_mfma_f32_32x32x16_bf16 v[32:47], v[164:167], v[80:83], v[32:47]
    s_waitcnt vmcnt(2)
    v_mfma_f32_32x32x16_bf16 v[48:63], v[160:163], v[84:87], v[48:63]
    v_mfma_f32_32x32x16_bf16 v[64:79], v[164:167], v[84:87], v[64:79]
    s_add_u32 s56, s84, 12288
    buffer_load_dwordx4 v[96:99], v242, s[28:31], s56 offen sc1
    buffer_load_dwordx4 v[100:103], v243, s[28:31], s56 offen sc1
    s_add_u32 s56, s84, 13312
    buffer_load_dwordx4 v[104:107], v242, s[28:31], s56 offen sc1
    buffer_load_dwordx4 v[108:111], v243, s[28:31], s56 offen sc1
    ds_read_b64_tr_b16 v[160:161], v246 offset:2048
    ds_read_b64_tr_b16 v[162:163], v246 offset:3072
    ds_read_b64_tr_b16 v[164:165], v247 offset:2048
    ds_read_b64_tr_b16 v[166:167], v247 offset:3072
    s_waitcnt vmcnt(5)
    v_mfma_f32_32x32x16_bf16 v[16:31], v[168:171], v[88:91], v[16:31]
    v_mfma_f32_32x32x16_bf16 v[32:47], v[172:175], v[88:91], v[32:47]
    s_waitcnt vmcnt(4)
    v_mfma_f32_32x32x16_bf16 v[48:63], v[168:171], v[92:95], v[48:63]
    v_mfma_f32_32x32x16_bf16 v[64:79], v[172:175], v[92:95], v[64:79]
    s_add_u32 s56, s84, 14336
    buffer_load_dwordx4 v[112:115], v242, s[28:31], s56 offen sc1
    buffer_load_dwordx4 v[116:119], v243, s[28:31], s56 offen sc1
    s_add_u32 s56, s84, 15360
    buffer_load_dwordx4 v[120:123], v242, s[28:31], s56 offen sc1
    buffer_load_dwordx4 v[124:127], v243, s[28:31], s56 offen sc1
    ds_read_b64_tr_b16 v[168:169], v246 offset:4096
    ds_read_b64_tr_b16 v[170:171], v246 offset:5120
    ds_read_b64_tr_b16 v[172:173], v247 offset:4096
    ds_read_b64_tr_b16 v[174:175], v247 offset:5120
    s_waitcnt vmcnt(7)
    v_mfma_f32_32x32x16_bf16 v[16:31], v[176:179], v[96:99], v[16:31]
    v_mfma_f32_32x32x16_bf16 v[32:47], v[180:183], v[96:99], v[32:47]
    s_waitcnt vmcnt(6)
    v_mfma_f32_32x32x16_bf16 v[48:63], v[176:179], v[100:103], v[48:63]
    v_mfma_f32_32x32x16_bf16 v[64:79], v[180:183], v[100:103], v[64:79]
    s_add_u32 s56, s84, 16384
    buffer_load_dwordx4 v[128:131], v242, s[28:31], s56 offen sc1
    buffer_load_dwordx4 v[132:135], v243, s[28:31], s56 offen sc1
    s_add_u32 s56, s84, 17408
    buffer_load_dwordx4 v[136:139], v242, s[28:31], s56 offen sc1
    buffer_load_dwordx4 v[140:143], v243, s[28:31], s56 offen sc1
    ds_read_b64_tr_b16 v[176:177], v246 offset:6144
    ds_read_b64_tr_b16 v[178:179], v246 offset:7168
    ds_read_b64_tr_b16 v[180:181], v247 offset:6144
    ds_read_b64_tr_b16 v[182:183], v247 offset:7168
    s_waitcnt vmcnt(9)
    v_mfma_f32_32x32x16_bf16 v[16:31], v[184:187], v[104:107], v[16:31]
    v_mfma_f32_32x32x16_bf16 v[32:47], v[188:191], v[104:107], v[32:47]
    s_waitcnt vmcnt(8)
    v_mfma_f32_32x32x16_bf16 v[48:63], v[184:187], v[108:111], v[48:63]
    v_mfma_f32_32x32x16_bf16 v[64:79], v[188:191], v[108:111], v[64:79]
    s_add_u32 s56, s84, 18432
    buffer_load_dwordx4 v[144:147], v242, s[28:31], s56 offen sc1
    buffer_load_dwordx4 v[148:151], v243, s[28:31], s56 offen sc1
    s_add_u32 s56, s84, 19456
    buffer_load_dwordx4 v[152:155], v242, s[28:31], s56 offen sc1
    buffer_load_dwordx4 v[156:159], v243, s[28:31], s56 offen sc1
    ds_read_b64_tr_b16 v[184:185], v246 offset:8192
    ds_read_b64_tr_b16 v[186:187], v246 offset:9216
    ds_read_b64_tr_b16 v[188:189], v247 offset:8192
    ds_read_b64_tr_b16 v[190:191], v247 offset:9216
    s_waitcnt vmcnt(11)
    v_mfma_f32_32x32x16_bf16 v[16:31], v[192:195], v[112:115], v[16:31]
    v_mfma_f32_32x32x16_bf16 v[32:47], v[196:199], v[112:115], v[32:47]
    s_waitcnt vmcnt(10)
    v_mfma_f32_32x32x16_bf16 v[48:63], v[192:195], v[116:119], v[48:63]
    v_mfma_f32_32x32x16_bf16 v[64:79], v[196:199], v[116:119], v[64:79]
    s_add_u32 s56, s84, 20480
    buffer_load_dwordx4 v[80:83], v242, s[28:31], s56 offen sc1
    buffer_load_dwordx4 v[84:87], v243, s[28:31], s56 offen sc1
    s_add_u32 s56, s84, 21504
    buffer_load_dwordx4 v[88:91], v242, s[28:31], s56 offen sc1
    buffer_load_dwordx4 v[92:95], v243, s[28:31], s56 offen sc1
    ds_read_b64_tr_b16 v[192:193], v246 offset:10240
    ds_read_b64_tr_b16 v[194:195], v246 offset:11264
    ds_read_b64_tr_b16 v[196:197], v247 offset:10240
    ds_read_b64_tr_b16 v[198:199], v247 offset:11264
    s_waitcnt vmcnt(13) lgkmcnt(15)
    v_mfma_f32_32x32x16_bf16 v[16:31], v[200:203], v[120:123], v[16:31]
    v_mfma_f32_32x32x16_bf16 v[32:47], v[204:207], v[120:123], v[32:47]
    s_waitcnt vmcnt(12)
    v_mfma_f32_32x32x16_bf16 v[48:63], v[200:203], v[124:127], v[48:63]
    v_mfma_f32_32x32x16_bf16 v[64:79], v[204:207], v[124:127], v[64:79]
    s_add_u32 s56, s84, 22528
    buffer_load_dwordx4 v[96:99], v242, s[28:31], s56 offen sc1
    buffer_load_dwordx4 v[100:103], v243, s[28:31], s56 offen sc1
    s_add_u32 s56, s84, 23552
    buffer_load_dwordx4 v[104:107], v242, s[28:31], s56 offen sc1
    buffer_load_dwordx4 v[108:111], v243, s[28:31], s56 offen sc1
    ds_read_b64_tr_b16 v[200:201], v246 offset:12288
    ds_read_b64_tr_b16 v[202:203], v246 offset:13312
    ds_read_b64_tr_b16 v[204:205], v247 offset:12288
    ds_read_b64_tr_b16 v[206:207], v247 offset:13312
    s_waitcnt vmcnt(15)
    v_mfma_f32_32x32x16_bf16 v[16:31], v[208:211], v[128:131], v[16:31]
    v_mfma_f32_32x32x16_bf16 v[32:47], v[212:215], v[128:131], v[32:47]
    s_waitcnt vmcnt(14)
    v_mfma_f32_32x32x16_bf16 v[48:63], v[208:211], v[132:135], v[48:63]
    v_mfma_f32_32x32x16_bf16 v[64:79], v[212:215], v[132:135], v[64:79]
    s_add_u32 s56, s84, 24576
    buffer_load_dwordx4 v[112:115], v242, s[28:31], s56 offen sc1
    buffer_load_dwordx4 v[116:119], v243, s[28:31], s56 offen sc1
    s_add_u32 s56, s84, 25600
    buffer_load_dwordx4 v[120:123], v242, s[28:31], s56 offen sc1
    buffer_load_dwordx4 v[124:127], v243, s[28:31], s56 offen sc1
    ds_read_b64_tr_b16 v[208:209], v244 offset:0
    ds_read_b64_tr_b16 v[210:211], v244 offset:1024
    ds_read_b64_tr_b16 v[212:213], v245 offset:0
    ds_read_b64_tr_b16 v[214:215], v245 offset:1024
    s_waitcnt vmcnt(17)
    v_mfma_f32_32x32x16_bf16 v[16:31], v[216:219], v[136:139], v[16:31]
    v_mfma_f32_32x32x16_bf16 v[32:47], v[220:223], v[136:139], v[32:47]
    s_waitcnt vmcnt(16)
    v_mfma_f32_32x32x16_bf16 v[48:63], v[216:219], v[140:143], v[48:63]
    v_mfma_f32_32x32x16_bf16 v[64:79], v[220:223], v[140:143], v[64:79]
    s_add_u32 s56, s84, 26624
    buffer_load_dwordx4 v[128:131], v242, s[28:31], s56 offen sc1
    buffer_load_dwordx4 v[132:135], v243, s[28:31], s56 offen sc1
    s_add_u32 s56, s84, 27648
    buffer_load_dwordx4 v[136:139], v242, s[28:31], s56 offen sc1
    buffer_load_dwordx4 v[140:143], v243, s[28:31], s56 offen sc1
    ds_read_b64_tr_b16 v[216:217], v244 offset:2048
    ds_read_b64_tr_b16 v[218:219], v244 offset:3072
    ds_read_b64_tr_b16 v[220:221], v245 offset:2048
    ds_read_b64_tr_b16 v[222:223], v245 offset:3072
    s_waitcnt lgkmcnt(8)
    s_add_u32 m0, s81, 0
    s_add_u32 s56, s83, 0
    buffer_load_dwordx4 v9, s[76:79], s56 offen lds
    buffer_load_dwordx4 v10, s[76:79], s56 offen offset:1024 lds
    s_add_u32 m0, s81, 2048
    s_add_u32 s56, s83, 14336
    buffer_load_dwordx4 v9, s[76:79], s56 offen lds
    buffer_load_dwordx4 v10, s[76:79], s56 offen offset:1024 lds
    s_add_u32 m0, s81, 4096
    s_add_u32 s56, s83, 28672
    buffer_load_dwordx4 v9, s[76:79], s56 offen lds
    buffer_load_dwordx4 v10, s[76:79], s56 offen offset:1024 lds
    s_add_u32 m0, s81, 6144
    s_add_u32 s56, s83, 43008
    buffer_load_dwordx4 v9, s[76:79], s56 offen lds
    buffer_load_dwordx4 v10, s[76:79], s56 offen offset:1024 lds
    s_add_u32 m0, s81, 8192
    s_add_u32 s56, s83, 57344
    buffer_load_dwordx4 v9, s[76:79], s56 offen lds
    buffer_load_dwordx4 v10, s[76:79], s56 offen offset:1024 lds
    s_add_u32 m0, s81, 10240
    s_add_u32 s56, s83, 71680
    buffer_load_dwordx4 v9, s[76:79], s56 offen lds
    buffer_load_dwordx4 v10, s[76:79], s56 offen offset:1024 lds
    s_add_u32 m0, s81, 12288
    s_add_u32 s56, s83, 86016
    buffer_load_dwordx4 v9, s[76:79], s56 offen lds
    buffer_load_dwordx4 v10, s[76:79], s56 offen offset:1024 lds
    s_waitcnt lgkmcnt(0)
    ds_read_b32 v6, v241
    s_waitcnt lgkmcnt(0)
    v_cmp_eq_u32 vcc, 0, v6
    s_nop 0
    s_cbranch_vccz gated_mix__mha_block__glu_gated_geglu__prompt_kernel_ok45
    s_mov_b32 s3, 131072
gated_mix__mha_block__glu_gated_geglu__prompt_kernel_again46:
    s_sleep 2
    ds_read_b32 v6, v241
    s_waitcnt lgkmcnt(0)
    v_cmp_eq_u32 vcc, 0, v6
    s_nop 0
    s_cbranch_vccz gated_mix__mha_block__glu_gated_geglu__prompt_kernel_ok45
    s_sub_u32 s3, s3, 1
    s_cbranch_scc0 gated_mix__mha_block__glu_gated_geglu__prompt_kernel_again46
gated_mix__mha_block__glu_gated_geglu__prompt_kernel_ok45:
    s_waitcnt vmcnt(33)
    v_mfma_f32_32x32x16_bf16 v[32:47], v[228:231], v[144:147], v[32:47]
    s_waitcnt vmcnt(31)
    v_mfma_f32_32x32x16_bf16 v[32:47], v[236:239], v[152:155], v[32:47]
    s_waitcnt vmcnt(29)
    v_mfma_f32_32x32x16_bf16 v[32:47], v[164:167], v[80:83], v[32:47]
    s_waitcnt vmcnt(27)
    v_mfma_f32_32x32x16_bf16 v[32:47], v[172:175], v[88:91], v[32:47]
    s_waitcnt vmcnt(25)
    v_mfma_f32_32x32x16_bf16 v[32:47], v[180:183], v[96:99], v[32:47]
    s_waitcnt vmcnt(23)
    v_mfma_f32_32x32x16_bf16 v[32:47], v[188:191], v[104:107], v[32:47]
    s_waitcnt vmcnt(21)
    v_mfma_f32_32x32x16_bf16 v[32:47], v[196:199], v[112:115], v[32:47]
    s_waitcnt vmcnt(19)
    v_mfma_f32_32x32x16_bf16 v[32:47], v[204:207], v[120:123], v[32:47]
    s_waitcnt vmcnt(17)
    v_mfma_f32_32x32x16_bf16 v[32:47], v[212:215], v[128:131], v[32:47]
    s_waitcnt vmcnt(15)
    v_mfma_f32_32x32x16_bf16 v[32:47], v[220:223], v[136:139], v[32:47]
    v_mfma_f32_32x32x16_bf16 v[48:63], v[224:227], v[148:151], v[48:63]
    v_mfma_f32_32x32x16_bf16 v[48:63], v[232:235], v[156:159], v[48:63]
    v_mfma_f32_32x32x16_bf16 v[48:63], v[160:163], v[84:87], v[48:63]
    s_nop 8
    ds_write_b128 v240, v[32:35] offset:0
    v_mfma_f32_32x32x16_bf16 v[48:63], v[168:171], v[92:95], v[48:63]
    ds_write_b128 v240, v[36:39] offset:1024
    v_mfma_f32_32x32x16_bf16 v[48:63], v[176:179], v[100:103], v[48:63]
    ds_write_b128 v240, v[40:43] offset:2048
    v_mfma_f32_32x32x16_bf16 v[48:63], v[184:187], v[108:111], v[48:63]
    ds_write_b128 v240, v[44:47] offset:3072
    v_mfma_f32_32x32x16_bf16 v[48:63], v[192:195], v[116:119], v[48:63]
    v_mfma_f32_32x32x16_bf16 v[48:63], v[200:203], v[124:127], v[48:63]
    v_mfma_f32_32x32x16_bf16 v[48:63], v[208:211], v[132:135], v[48:63]
    s_waitcnt vmcnt(14)
    v_mfma_f32_32x32x16_bf16 v[48:63], v[216:219], v[140:143], v[48:63]
    v_mfma_f32_32x32x16_bf16 v[64:79], v[228:231], v[148:151], v[64:79]
    v_mfma_f32_32x32x16_bf16 v[64:79], v[236:239], v[156:159], v[64:79]
    v_mfma_f32_32x32x16_bf16 v[64:79], v[164:167], v[84:87], v[64:79]
    s_nop 8
    ds_write_b128 v240, v[48:51] offset:4096
    v_mfma_f32_32x32x16_bf16 v[64:79], v[172:175], v[92:95], v[64:79]
    ds_write_b128 v240, v[52:55] offset:5120
    v_mfma_f32_32x32x16_bf16 v[64:79], v[180:183], v[100:103], v[64:79]
    ds_write_b128 v240, v[56:59] offset:6144
    v_mfma_f32_32x32x16_bf16 v[64:79], v[188:191], v[108:111], v[64:79]
    ds_write_b128 v240, v[60:63] offset:7168
    v_mfma_f32_32x32x16_bf16 v[64:79], v[196:199], v[116:119], v[64:79]
    v_mfma_f32_32x32x16_bf16 v[64:79], v[204:207], v[124:127], v[64:79]
    v_mfma_f32_32x32x16_bf16 v[64:79], v[212:215], v[132:135], v[64:79]
    v_mfma_f32_32x32x16_bf16 v[64:79], v[220:223], v[140:143], v[64:79]
    v_mfma_f32_32x32x16_bf16 v[16:31], v[224:227], v[144:147], v[16:31]
    v_mfma_f32_32x32x16_bf16 v[16:31], v[232:235], v[152:155], v[16:31]
    v_mfma_f32_32x32x16_bf16 v[16:31], v[160:163], v[80:83], v[16:31]
    s_nop 8
    ds_write_b128 v240, v[64:67] offset:8192
    v_mfma_f32_32x32x16_bf16 v[16:31], v[168:171], v[88:91], v[16:31]
    ds_write_b128 v240, v[68:71] offset:9216
    v_mfma_f32_32x32x16_bf16 v[16:31], v[176:179], v[96:99], v[16:31]
    ds_write_b128 v240, v[72:75] offset:10240
    v_mfma_f32_32x32x16_bf16 v[16:31], v[184:187], v[104:107], v[16:31]
    ds_write_b128 v240, v[76:79] offset:11264
    v_mfma_f32_32x32x16_bf16 v[16:31], v[192:195], v[112:115], v[16:31]
    ds_write_b32 v2, v2
    v_mfma_f32_32x32x16_bf16 v[16:31], v[200:203], v[120:123], v[16:31]
    v_mfma_f32_32x32x16_bf16 v[16:31], v[208:211], v[128:131], v[16:31]
    v_mfma_f32_32x32x16_bf16 v[16:31], v[216:219], v[136:139], v[16:31]
    ds_read_b32 v6, v3
    s_waitcnt lgkmcnt(0)
    v_cmp_eq_u32 vcc, 0, v6
    s_nop 0
    s_cbranch_vccz gated_mix__mha_block__glu_gated_geglu__prompt_kernel_ok47
    s_mov_b32 s3, 131072
gated_mix__mha_block__glu_gated_geglu__prompt_kernel_again48:
    ds_read_b32 v6, v3
    s_waitcnt lgkmcnt(0)
    v_cmp_eq_u32 vcc, 0, v6
    s_nop 0
    s_cbranch_vccz gated_mix__mha_block__glu_gated_geglu__prompt_kernel_ok47
    s_sub_u32 s3, s3, 1
    s_cbranch_scc0 gated_mix__mha_block__glu_gated_geglu__prompt_kernel_again48
gated_mix__mha_block__glu_gated_geglu__prompt_kernel_ok47:
    ds_read_b128 v[32:35], v250 offset:0
    ds_read_b128 v[48:51], v251 offset:0
    ds_read_b128 v[64:67], v252 offset:0
    ds_read_b128 v[36:39], v250 offset:1024
    ds_read_b128 v[52:55], v251 offset:1024
    ds_read_b128 v[68:71], v252 offset:1024
    ds_read_b128 v[40:43], v250 offset:2048
    ds_read_b128 v[56:59], v251 offset:2048
    ds_read_b128 v[72:75], v252 offset:2048
    ds_read_b128 v[44:47], v250 offset:3072
    ds_read_b128 v[60:63], v251 offset:3072
    ds_read_b128 v[76:79], v252 offset:3072
    s_waitcnt lgkmcnt(10)
    v_pk_add_f32 v[32:33], v[32:33], v[48:49]
    v_pk_add_f32 v[34:35], v[34:35], v[50:51]
    s_waitcnt lgkmcnt(9)
    v_pk_add_f32 v[16:17], v[16:17], v[64:65]
    v_pk_add_f32 v[18:19], v[18:19], v[66:67]
    v_pk_add_f32 v[16:17], v[16:17], v[32:33]
    v_pk_add_f32 v[18:19], v[18:19], v[34:35]
    v_pk_mul_f32 v[16:17], v[16:17], v[248:249] op_sel_hi:[1,0]
    v_pk_mul_f32 v[18:19], v[18:19], v[248:249] op_sel_hi:[1,0]
    s_waitcnt lgkmcnt(7)
    v_pk_add_f32 v[36:37], v[36:37], v[52:53]
    v_pk_add_f32 v[38:39], v[38:39], v[54:55]
    s_waitcnt lgkmcnt(6)
    v_pk_add_f32 v[20:21], v[20:21], v[68:69]
    v_pk_add_f32 v[22:23], v[22:23], v[70:71]
    v_pk_add_f32 v[20:21], v[20:21], v[36:37]
    v_pk_add_f32 v[22:23], v[22:23], v[38:39]
    v_pk_mul_f32 v[20:21], v[20:21], v[248:249] op_sel_hi:[1,0]
    v_pk_mul_f32 v[22:23], v[22:23], v[248:249] op_sel_hi:[1,0]
    s_waitcnt lgkmcnt(4)
    v_pk_add_f32 v[40:41], v[40:41], v[56:57]
    v_pk_add_f32 v[42:43], v[42:43], v[58:59]
    s_waitcnt lgkmcnt(3)
    v_pk_add_f32 v[24:25], v[24:25], v[72:73]
    v_pk_add_f32 v[26:27], v[26:27], v[74:75]
    v_pk_add_f32 v[24:25], v[24:25], v[40:41]
    v_pk_add_f32 v[26:27], v[26:27], v[42:43]
    v_pk_mul_f32 v[24:25], v[24:25], v[248:249] op_sel_hi:[1,0]
    v_pk_mul_f32 v[26:27], v[26:27], v[248:249] op_sel_hi:[1,0]
    s_waitcnt lgkmcnt(1)
    v_pk_add_f32 v[44:45], v[44:45], v[60:61]
    v_pk_add_f32 v[46:47], v[46:47], v[62:63]
    s_waitcnt lgkmcnt(0)
    v_pk_add_f32 v[28:29], v[28:29], v[76:77]
    v_pk_add_f32 v[30:31], v[30:31], v[78:79]
    v_pk_add_f32 v[28:29], v[28:29], v[44:45]
    v_pk_add_f32 v[30:31], v[30:31], v[46:47]
    v_pk_mul_f32 v[28:29], v[28:29], v[248:249] op_sel_hi:[1,0]
    v_pk_mul_f32 v[30:31], v[30:31], v[248:249] op_sel_hi:[1,0]
    s_waitcnt vmcnt(0)
    s_mov_b64 exec, 15
    buffer_load_dword v6, v254, s[28:31], s54 offen sc1
    s_mov_b64 exec, -1
    s_waitcnt lgkmcnt(0)
    s_barrier
    s_waitcnt vmcnt(0)
    s_mov_b64 exec, 15
    v_cmp_ne_u32 vcc, 1, v6
    s_nop 0
    s_cbranch_vccz gated_mix__mha_block__glu_gated_geglu__prompt_kernel_ok49
    s_mov_b32 s3, 131072
gated_mix__mha_block__glu_gated_geglu__prompt_kernel_again50:
    buffer_load_dword v6, v254, s[28:31], s54 offen sc1
    s_waitcnt vmcnt(0)
    v_cmp_ne_u32 vcc, 1, v6
    s_nop 0
    s_cbranch_vccz gated_mix__mha_block__glu_gated_geglu__prompt_kernel_ok49
    s_sub_u32 s3, s3, 1
    s_cbranch_scc0 gated_mix__mha_block__glu_gated_geglu__prompt_kernel_again50
gated_mix__mha_block__glu_gated_geglu__prompt_kernel_ok49:
    s_mov_b64 exec, -1
    s_add_u32 m0, s11, 90112
    s_add_u32 s56, s10, 0
    buffer_load_dwordx4 v1, s[28:31], s56 offen offset:0 sc1 lds
    buffer_load_dwordx4 v1, s[28:31], s56 offen offset:1024 sc1 lds
    s_add_u32 m0, s11, 98304
    s_add_u32 s56, s10, 8192
    buffer_load_dwordx4 v1, s[28:31], s56 offen offset:0 sc1 lds
    buffer_load_dwordx4 v1, s[28:31], s56 offen offset:1024 sc1 lds
    s_add_u32 m0, s11, 106496
    s_add_u32 s56, s10, 16384
    buffer_load_dwordx4 v1, s[28:31], s56 offen offset:0 sc1 lds
    buffer_load_dwordx4 v1, s[28:31], s56 offen offset:1024 sc1 lds
    s_add_u32 m0, s11, 114688
    s_add_u32 s56, s10, 24576
    buffer_load_dwordx4 v1, s[28:31], s56 offen offset:0 sc1 lds
    buffer_load_dwordx4 v1, s[28:31], s56 offen offset:1024 sc1 lds
    s_waitcnt vmcnt(6)
    s_barrier
    ds_read_b128 v[96:99], v14 offset:0
    ds_read_b64_tr_b16 v[112:113], v11 offset:0
    ds_read_b64_tr_b16 v[114:115], v11 offset:1024
    ds_read_b128 v[100:103], v14 offset:1024
    ds_read_b64_tr_b16 v[116:117], v11 offset:2048
    ds_read_b64_tr_b16 v[118:119], v11 offset:3072
    ds_read_b128 v[104:107], v14 offset:2048
    ds_read_b64_tr_b16 v[120:121], v11 offset:3584
    ds_read_b64_tr_b16 v[122:123], v11 offset:4608
    s_waitcnt lgkmcnt(6)
    v_mfma_f32_32x32x16_bf16 v[16:31], v[112:115], v[96:99], v[16:31]
    ds_read_b128 v[108:111], v14 offset:3072
    ds_read_b64_tr_b16 v[124:125], v11 offset:5632
    ds_read_b64_tr_b16 v[126:127], v11 offset:6656
    s_waitcnt lgkmcnt(6)
    v_mfma_f32_32x32x16_bf16 v[16:31], v[116:119], v[100:103], v[16:31]
    ds_read_b128 v[96:99], v14 offset:4096
    ds_read_b64_tr_b16 v[112:113], v11 offset:7168
    ds_read_b64_tr_b16 v[114:115], v11 offset:8192
    s_waitcnt lgkmcnt(6)
    v_mfma_f32_32x32x16_bf16 v[16:31], v[120:123], v[104:107], v[16:31]
    ds_read_b128 v[100:103], v14 offset:5120
    ds_read_b64_tr_b16 v[116:117], v11 offset:9216
    ds_read_b64_tr_b16 v[118:119], v11 offset:10240
    s_waitcnt lgkmcnt(6)
    v_mfma_f32_32x32x16_bf16 v[16:31], v[124:127], v[108:111], v[16:31]
    ds_read_b128 v[104:107], v14 offset:6144
    ds_read_b64_tr_b16 v[120:121], v11 offset:10752
    ds_read_b64_tr_b16 v[122:123], v11 offset:11776
    s_waitcnt lgkmcnt(6)
    v_mfma_f32_32x32x16_bf16 v[16:31], v[112:115], v[96:99], v[16:31]
    ds_read_b128 v[108:111], v14 offset:7168
    ds_read_b64_tr_b16 v[124:125], v11 offset:12800
    ds_read_b64_tr_b16 v[126:127], v11 offset:13824
    s_waitcnt lgkmcnt(6)
    v_mfma_f32_32x32x16_bf16 v[16:31], v[116:119], v[100:103], v[16:31]
    s_waitcnt vmcnt(4)
    s_barrier
    ds_read_b128 v[96:99], v14 offset:8192
    ds_read_b64_tr_b16 v[112:113], v11 offset:14336
    ds_read_b64_tr_b16 v[114:115], v11 offset:15360
    s_waitcnt lgkmcnt(6)
    v_mfma_f32_32x32x16_bf16 v[16:31], v[120:123], v[104:107], v[16:31]
    ds_read_b128 v[100:103], v14 offset:9216
    ds_read_b64_tr_b16 v[116:117], v11 offset:16384
    ds_read_b64_tr_b16 v[118:119], v11 offset:17408
    s_waitcnt lgkmcnt(6)
    v_mfma_f32_32x32x16_bf16 v[16:31], v[124:127], v[108:111], v[16:31]
    ds_read_b128 v[104:107], v14 offset:10240
    ds_read_b64_tr_b16 v[120:121], v11 offset:17920
    ds_read_b64_tr_b16 v[122:123], v11 offset:18944
    s_waitcnt lgkmcnt(6)
    v_mfma_f32_32x32x16_bf16 v[16:31], v[112:115], v[96:99], v[16:31]
    ds_read_b128 v[108:111], v14 offset:11264
    ds_read_b64_tr_b16 v[124:125], v11 offset:19968
    ds_read_b64_tr_b16 v[126:127], v11 offset:20992
    s_waitcnt lgkmcnt(6)
    v_mfma_f32_32x32x16_bf16 v[16:31], v[116:119], v[100:103], v[16:31]
    ds_read_b128 v[96:99], v14 offset:12288
    ds_read_b64_tr_b16 v[112:113], v11 offset:21504
    ds_read_b64_tr_b16 v[114:115], v11 offset:22528
    s_waitcnt lgkmcnt(6)
    v_mfma_f32_32x32x16_bf16 v[16:31], v[120:123], v[104:107], v[16:31]
    ds_read_b128 v[100:103], v14 offset:13312
    ds_read_b64_tr_b16 v[116:117], v11 offset:23552
    ds_read_b64_tr_b16 v[118:119], v11 offset:24576
    s_waitcnt lgkmcnt(6)
    v_mfma_f32_32x32x16_bf16 v[16:31], v[124:127], v[108:111], v[16:31]
    ds_read_b128 v[104:107], v14 offset:14336
    ds_read_b64_tr_b16 v[120:121], v11 offset:25088
    ds_read_b64_tr_b16 v[122:123], v11 offset:26112
    s_waitcnt lgkmcnt(6)
    v_mfma_f32_32x32x16_bf16 v[16:31], v[112:115], v[96:99], v[16:31]
    ds_read_b128 v[108:111], v14 offset:15360
    ds_read_b64_tr_b16 v[124:125], v11 offset:27136
    ds_read_b64_tr_b16 v[126:127], v11 offset:28160
    s_waitcnt lgkmcnt(6)
    v_mfma_f32_32x32x16_bf16 v[16:31], v[116:119], v[100:103], v[16:31]
    s_waitcnt vmcnt(2)
    s_barrier
    ds_read_b128 v[96:99], v14 offset:16384
    ds_read_b64_tr_b16 v[112:113], v11 offset:28672
    ds_read_b64_tr_b16 v[114:115], v11 offset:29696
    s_waitcnt lgkmcnt(6)
    v_mfma_f32_32x32x16_bf16 v[16:31], v[120:123], v[104:107], v[16:31]
    ds_read_b128 v[100:103], v14 offset:17408
    ds_read_b64_tr_b16 v[116:117], v11 offset:30720
    ds_read_b64_tr_b16 v[118:119], v11 offset:31744
    s_waitcnt lgkmcnt(6)
    v_mfma_f32_32x32x16_bf16 v[16:31], v[124:127], v[108:111], v[16:31]
    ds_read_b128 v[104:107], v14 offset:18432
    ds_read_b64_tr_b16 v[120:121], v11 offset:32256
    ds_read_b64_tr_b16 v[122:123], v11 offset:33280
    s_waitcnt lgkmcnt(6)
    v_mfma_f32_32x32x16_bf16 v[16:31], v[112:115], v[96:99], v[16:31]
    ds_read_b128 v[108:111], v14 offset:19456
    ds_read_b64_tr_b16 v[124:125], v11 offset:34304
    ds_read_b64_tr_b16 v[126:127], v11 offset:35328
    s_waitcnt lgkmcnt(6)
    v_mfma_f32_32x32x16_bf16 v[16:31], v[116:119], v[100:103], v[16:31]
    ds_read_b128 v[96:99], v14 offset:20480
    ds_read_b64_tr_b16 v[112:113], v11 offset:35840
    ds_read_b64_tr_b16 v[114:115], v11 offset:36864
    s_waitcnt lgkmcnt(6)
    v_mfma_f32_32x32x16_bf16 v[16:31], v[120:123], v[104:107], v[16:31]
    ds_read_b128 v[100:103], v14 offset:21504
    ds_read_b64_tr_b16 v[116:117], v11 offset:37888
    ds_read_b64_tr_b16 v[118:119], v11 offset:38912
    s_waitcnt lgkmcnt(6)
    v_mfma_f32_32x32x16_bf16 v[16:31], v[124:127], v[108:111], v[16:31]
    ds_read_b128 v[104:107], v14 offset:22528
    ds_read_b64_tr_b16 v[120:121], v11 offset:39424
    ds_read_b64_tr_b16 v[122:123], v11 offset:40448
    s_waitcnt lgkmcnt(6)
    v_mfma_f32_32x32x16_bf16 v[16:31], v[112:115], v[96:99], v[16:31]
    ds_read_b128 v[108:111], v14 offset:23552
    ds_read_b64_tr_b16 v[124:125], v11 offset:41472
    ds_read_b64_tr_b16 v[126:127], v11 offset:42496
    s_waitcnt lgkmcnt(6)
    v_mfma_f32_32x32x16_bf16 v[16:31], v[116:119], v[100:103], v[16:31]
    s_waitcnt vmcnt(0)
    s_barrier
    ds_read_b128 v[96:99], v14 offset:24576
    ds_read_b64_tr_b16 v[112:113], v11 offset:43008
    ds_read_b64_tr_b16 v[114:115], v11 offset:44032
    s_waitcnt lgkmcnt(6)
    v_mfma_f32_32x32x16_bf16 v[16:31], v[120:123], v[104:107], v[16:31]
    ds_read_b128 v[100:103], v14 offset:25600
    ds_read_b64_tr_b16 v[116:117], v11 offset:45056
    ds_read_b64_tr_b16 v[118:119], v11 offset:46080
    s_waitcnt lgkmcnt(6)
    v_mfma_f32_32x32x16_bf16 v[16:31], v[124:127], v[108:111], v[16:31]
    ds_read_b128 v[104:107], v14 offset:26624
    ds_read_b64_tr_b16 v[120:121], v11 offset:46592
    ds_read_b64_tr_b16 v[122:123], v11 offset:47616
    s_waitcnt lgkmcnt(6)
    v_mfma_f32_32x32x16_bf16 v[16:31], v[112:115], v[96:99], v[16:31]
    ds_read_b128 v[108:111], v14 offset:27648
    ds_read_b64_tr_b16 v[124:125], v11 offset:48640
    ds_read_b64_tr_b16 v[126:127], v11 offset:49664
    s_waitcnt lgkmcnt(6)
    v_mfma_f32_32x32x16_bf16 v[16:31], v[116:119], v[100:103], v[16:31]
    ds_read_b128 v[96:99], v14 offset:28672
    ds_read_b64_tr_b16 v[112:113], v11 offset:50176
    ds_read_b64_tr_b16 v[114:115], v11 offset:51200
    s_waitcnt lgkmcnt(6)
    v_mfma_f32_32x32x16_bf16 v[16:31], v[120:123], v[104:107], v[16:31]
    ds_read_b128 v[100:103], v14 offset:29696
    ds_read_b64_tr_b16 v[116:117], v11 offset:52224
    ds_read_b64_tr_b16 v[118:119], v11 offset:53248
    s_waitcnt lgkmcnt(6)
    v_mfma_f32_32x32x16_bf16 v[16:31], v[124:127], v[108:111], v[16:31]
    ds_read_b128 v[104:107], v14 offset:30720
    ds_read_b64_tr_b16 v[120:121], v11 offset:53760
    ds_read_b64_tr_b16 v[122:123], v11 offset:54784
    s_waitcnt lgkmcnt(6)
    v_mfma_f32_32x32x16_bf16 v[16:31], v[112:115], v[96:99], v[16:31]
    ds_read_b128 v[108:111], v14 offset:31744
    ds_read_b64_tr_b16 v[124:125], v11 offset:55808
    ds_read_b64_tr_b16 v[126:127], v11 offset:56832
    s_waitcnt lgkmcnt(6)
    v_mfma_f32_32x32x16_bf16 v[16:31], v[116:119], v[100:103], v[16:31]
    s_waitcnt lgkmcnt(3)
    v_mfma_f32_32x32x16_bf16 v[16:31], v[120:123], v[104:107], v[16:31]
    s_waitcnt lgkmcnt(0)
    v_mfma_f32_32x32x16_bf16 v[16:31], v[124:127], v[108:111], v[16:31]
    s_nop 11
    v_cvt_pk_bf16_f32 v112, v16, v17
    v_cvt_pk_bf16_f32 v113, v18, v19
    v_cvt_pk_bf16_f32 v114, v20, v21
    v_cvt_pk_bf16_f32 v115, v22, v23
    ds_write_b128 v7, v[112:115] offset:0
    v_cvt_pk_bf16_f32 v116, v24, v25
    v_cvt_pk_bf16_f32 v117, v26, v27
    v_cvt_pk_bf16_f32 v118, v28, v29
    v_cvt_pk_bf16_f32 v119, v30, v31
    ds_write_b128 v7, v[116:119] offset:16
    ds_read_b128 v[96:99], v8 offset:0
    ds_read_b128 v[100:103], v8 offset:1280
    s_waitcnt lgkmcnt(1)
    buffer_store_dwordx4 v[96:99], v253, s[48:51], s86 offen
    s_waitcnt lgkmcnt(0)
    buffer_store_dwordx4 v[100:103], v253, s[48:51], s60 offen
    s_endpgm
gated_mix__mha_block__glu_gated_geglu__prompt_kernel_slow:
    s_waitcnt vmcnt(0) lgkmcnt(0)
    s_mul_i32 s56, s70, 458752
    s_sub_u32 s72, s72, s56
    s_subb_u32 s73, s73, 0
    s_mov_b32 s74, 1835008
    s_sub_u32 s76, s76, s56
    s_subb_u32 s77, s77, 0
    s_mov_b32 s78, 1835008
    v_mov_b32 v160, v13
    v_mov_b32 v161, v13
    v_mov_b32 v162, v13
    v_mov_b32 v163, v13
    v_mov_b32 v164, v13
    v_mov_b32 v165, v13
    v_mov_b32 v166, v13
    v_mov_b32 v167, v13
    v_mov_b32 v1, 0xff800000
    s_mov_b32 s60, 0
gated_mix__mha_block__glu_gated_geglu__prompt_kernel_slowloop51:
    buffer_load_dwordx4 v[192:195], v134, s[72:75], s60 offen sc1
    buffer_load_dwordx4 v[196:199], v134, s[72:75], s60 offen offset:1024 sc1
    s_waitcnt vmcnt(1)
    v_mfma_f32_32x32x16_bf16 v[80:95], v[192:195], v[248:251], 0
    s_waitcnt vmcnt(0)
    v_mfma_f32_32x32x16_bf16 v[80:95], v[196:199], v[252:255], v[80:95]
    s_nop 11
    v_max3_f32 v1, v80, v81, v1
    v_max3_f32 v1, v82, v83, v1
    v_max3_f32 v1, v84, v85, v1
    v_max3_f32 v1, v86, v87, v1
    v_max3_f32 v1, v88, v89, v1
    v_max3_f32 v1, v90, v91, v1
    v_max3_f32 v1, v92, v93, v1
    v_max3_f32 v1, v94, v95, v1
    s_add_u32 s60, s60, 28672
    s_cmp_lt_u32 s60, 1835008
    s_cbranch_scc1 gated_mix__mha_block__glu_gated_geglu__prompt_kernel_slowloop51
    v_mov_b32 v9, v1
    s_nop 1
    v_permlane32_swap_b32 v9, v1
    v_max_f32 v1, v9, v1
    s_mov_b32 s60, 0
    v_mov_b32 v64, 0
    v_mov_b32 v65, 0
    v_mov_b32 v66, 0
    v_mov_b32 v67, 0
    v_mov_b32 v68, 0
    v_mov_b32 v69, 0
    v_mov_b32 v70, 0
    v_mov_b32 v71, 0
    v_mov_b32 v72, 0
    v_mov_b32 v73, 0
    v_mov_b32 v74, 0
    v_mov_b32 v75, 0
    v_mov_b32 v76, 0
    v_mov_b32 v77, 0
    v_mov_b32 v78, 0
    v_mov_b32 v79, 0
gated_mix__mha_block__glu_gated_geglu__prompt_kernel_slowloop52:
    buffer_load_dwordx4 v[192:195], v134, s[72:75], s60 offen sc1
    buffer_load_dwordx4 v[196:199], v134, s[72:75], s60 offen offset:1024 sc1
    s_mov_b64 exec, s[84:85]
    buffer_load_dwordx4 v[160:163], v10, s[76:79], s60 offen sc1
    buffer_load_dwordx4 v[164:167], v147, s[76:79], s60 offen sc1
    s_mov_b64 exec, -1
    s_waitcnt vmcnt(3)
    v_mfma_f32_32x32x16_bf16 v[80:95], v[192:195], v[248:251], 0
    s_waitcnt vmcnt(2)
    v_mfma_f32_32x32x16_bf16 v[80:95], v[196:199], v[252:255], v[80:95]
    s_nop 11
    v_sub_f32 v80, v80, v1
    v_sub_f32 v81, v81, v1
    v_sub_f32 v82, v82, v1
    v_sub_f32 v83, v83, v1
    v_sub_f32 v84, v84, v1
    v_sub_f32 v85, v85, v1
    v_sub_f32 v86, v86, v1
    v_sub_f32 v87, v87, v1
    v_sub_f32 v88, v88, v1
    v_sub_f32 v89, v89, v1
    v_sub_f32 v90, v90, v1
    v_sub_f32 v91, v91, v1
    v_sub_f32 v92, v92, v1
    v_sub_f32 v93, v93, v1
    v_sub_f32 v94, v94, v1
    v_sub_f32 v95, v95, v1
    v_exp_f32 v80, v80
    v_exp_f32 v81, v81
    v_exp_f32 v82, v82
    v_exp_f32 v83, v83
    v_cvt_pk_bf16_f32 v112, v80, v81
    v_cvt_pk_bf16_f32 v113, v82, v83
    v_exp_f32 v84, v84
    v_exp_f32 v85, v85
    v_exp_f32 v86, v86
    v_exp_f32 v87, v87
    v_cvt_pk_bf16_f32 v114, v84, v85
    v_cvt_pk_bf16_f32 v115, v86, v87
    v_exp_f32 v88, v88
    v_exp_f32 v89, v89
    v_exp_f32 v90, v90
    v_exp_f32 v91, v91
    v_cvt_pk_bf16_f32 v116, v88, v89
    v_cvt_pk_bf16_f32 v117, v90, v91
    v_exp_f32 v92, v92
    v_exp_f32 v93, v93
    v_exp_f32 v94, v94
    v_exp_f32 v95, v95
    v_cvt_pk_bf16_f32 v118, v92, v93
    v_cvt_pk_bf16_f32 v119, v94, v95
    s_waitcnt vmcnt(1)
    v_mfma_f32_32x32x16_bf16 v[64:79], v[160:163], v[112:115], v[64:79]
    s_waitcnt vmcnt(0)
    v_mfma_f32_32x32x16_bf16 v[64:79], v[164:167], v[116:119], v[64:79]
    s_add_u32 s60, s60, 28672
    s_cmp_lt_u32 s60, 1835008
    s_cbranch_scc1 gated_mix__mha_block__glu_gated_geglu__prompt_kernel_slowloop52
    s_nop 8
    v_mov_b32 v8, v76
    v_mov_b32 v9, v76
    s_nop 1
    v_permlane32_swap_b32 v8, v9
    v_rcp_f32 v12, v9
    s_nop 0
    v_mul_f32 v12, v12, v11
    s_branch gated_mix__mha_block__glu_gated_geglu__prompt_kernel_a_fin
gated_mix__mha_block__glu_gated_geglu__prompt_kernel_exit:
    s_endpgm
.section .rodata,"a"
.p2align 6
.amdhsa_kernel gated_mix__mha_block__glu_gated_geglu__prompt_kernel
  .amdhsa_next_free_vgpr 256
  .amdhsa_next_free_sgpr 102
  .amdhsa_accum_offset 256
  .amdhsa_group_segment_fixed_size 0
  .amdhsa_kernarg_size 88
  .amdhsa_user_sgpr_count 2
  .amdhsa_user_sgpr_kernarg_segment_ptr 1
  .amdhsa_system_sgpr_workgroup_id_x 1
  .amdhsa_float_denorm_mode_32 3
.end_amdhsa_kernel
```
